```python
import torch

def _softmax(x, axis=-1):
    return torch.softmax(x, dim=axis)
def _gelu(x):
    return torch.nn.functional.gelu(x, approximate="tanh")
def _silu(x):
    return torch.nn.functional.silu(x)
def _sigmoid(x):
    return torch.sigmoid(x)
def _layernorm(x, axis=-1, eps=1e-5):
    m = x.mean(dim=axis, keepdim=True)
    v = x.var(dim=axis, keepdim=True, unbiased=False)
    return (x - m) / torch.sqrt(v + eps)
def _scatter_add(tgt, idx, src, axis=0):
    return tgt.clone().index_add_(axis, idx, src)
def _segment_sum(src, seg, n):
    out = torch.zeros((n,) + src.shape[1:], dtype=src.dtype)
    return out.index_add_(0, seg, src)
def _pad(x, pw):
    flat = tuple(v for pair in reversed(pw) for v in pair)
    return torch.nn.functional.pad(x, flat)

kernel_name = 'concat_heads__mha_block_cached__mha_block_cached__near_ridge'

def setup_inputs():

    _w = (lambda a: (lambda t: t.to(torch.bfloat16) if t.is_floating_point() else t)(torch.as_tensor(a)))
    def _A_setup():
        B, Sq, D = 8, 224, 1024
        H, Sk, Dh = 32, 1024, 128
        return {
            "x": _w((lambda *s: torch.randn(*s, dtype=torch.bfloat16) * 0.8)(B, Sq, D)),
            "k_cache": _w((lambda *s: torch.randn(*s, dtype=torch.bfloat16) * 0.8)(B, H, Sk, Dh)),
            "v_cache": _w((lambda *s: torch.randn(*s, dtype=torch.bfloat16) * 0.05)(B, H, Sk, Dh)),
            "wq": _w((lambda *s: torch.randn(*s, dtype=torch.bfloat16) * 0.8)(D, H * Dh) * (D ** -0.5)),
            "wo": _w((lambda *s: torch.randn(*s, dtype=torch.bfloat16) * 0.05)(H * Dh, D) * ((H * Dh) ** -0.5)),
        }
    _A_in = _A_setup()

    def _B_setup():
        B, Sq, D = 8, 224, 1024
        H, Sk, Dh = 32, 1024, 128
        return {
            "x": _w((lambda *s: torch.randn(*s, dtype=torch.bfloat16) * 0.8)(B, Sq, D)),
            "k_cache": _w((lambda *s: torch.randn(*s, dtype=torch.bfloat16) * 0.8)(B, H, Sk, Dh)),
            "v_cache": _w((lambda *s: torch.randn(*s, dtype=torch.bfloat16) * 0.05)(B, H, Sk, Dh)),
            "wq": _w((lambda *s: torch.randn(*s, dtype=torch.bfloat16) * 0.8)(D, H * Dh) * (D ** -0.5)),
            "wo": _w((lambda *s: torch.randn(*s, dtype=torch.bfloat16) * 0.05)(H * Dh, D) * ((H * Dh) ** -0.5)),
        }
    _B_in = _B_setup()

    return {
        "A_x": _A_in["x"],
        "A_k_cache": _A_in["k_cache"],
        "A_v_cache": _A_in["v_cache"],
        "A_wq": _A_in["wq"],
        "A_wo": _A_in["wo"],
        "B_x": _B_in["x"],
        "B_k_cache": _B_in["k_cache"],
        "B_v_cache": _B_in["v_cache"],
        "B_wq": _B_in["wq"],
        "B_wo": _B_in["wo"],
    }

def reference(A_x, A_k_cache, A_v_cache, A_wq, A_wo, B_x, B_k_cache, B_v_cache, B_wq, B_wo):
    def _A_ref(x, k_cache, v_cache, wq, wo):
        B, Sq, D = x.shape
        H, Dh = 32, 128
        q = (lambda x, *d: x.permute(*d))((x @ wq).reshape(B, Sq, H, Dh), 0, 2, 1, 3)
        scores = torch.einsum("bhqd,bhkd->bhqk", q, k_cache) * (Dh ** -0.5)
        p = _softmax(scores, axis=-1)
        o = torch.einsum("bhqk,bhkd->bhqd", p, v_cache)
        return (lambda x, *d: x.permute(*d))(o, 0, 2, 1, 3).reshape(B, Sq, H * Dh) @ wo

    def _B_ref(x, k_cache, v_cache, wq, wo):
        B, Sq, D = x.shape
        H, Dh = 32, 128
        q = (lambda x, *d: x.permute(*d))((x @ wq).reshape(B, Sq, H, Dh), 0, 2, 1, 3)
        scores = torch.einsum("bhqd,bhkd->bhqk", q, k_cache) * (Dh ** -0.5)
        p = _softmax(scores, axis=-1)
        o = torch.einsum("bhqk,bhkd->bhqd", p, v_cache)
        return (lambda x, *d: x.permute(*d))(o, 0, 2, 1, 3).reshape(B, Sq, H * Dh) @ wo

    a = _A_ref(A_x, A_k_cache, A_v_cache, A_wq, A_wo)
    b = _B_ref(B_x, B_k_cache, B_v_cache, B_wq, B_wo)
    return torch.concatenate([a, b], axis=-1)
```

```asm
; @launch grid=(256,1,1) block=(256,1,1) lds=163840
.amdgcn_target "amdgcn-amd-amdhsa--gfx950"
.text
.globl concat_heads__mha_block_cached__mha_block_cached__near_ridge_kernel
.p2align 8
.type concat_heads__mha_block_cached__mha_block_cached__near_ridge_kernel,@function
concat_heads__mha_block_cached__mha_block_cached__near_ridge_kernel:
    s_cmp_ge_u32 s2, 256
    s_cbranch_scc1 L_end
    s_load_dwordx16 s[36:51], s[0:1], 0
    s_load_dwordx8 s[52:59], s[0:1], 64
    s_load_dwordx2 s[60:61], s[0:1], 96
    v_lshrrev_b32 v12, 6, v0
    v_and_b32 v28, 63, v0
    v_readfirstlane_b32 s24, v12
    v_and_b32 v29, 15, v28
    v_lshrrev_b32 v30, 4, v28
    s_lshr_b32 s25, s24, 1
    s_and_b32 s26, s24, 1
    s_and_b32 s65, s2, 7
    s_lshr_b32 s64, s2, 3
    s_lshr_b32 s72, s65, 2
    s_and_b32 s73, s65, 1
    s_lshl_b32 s73, s73, 2
    s_and_b32 s66, s64, 3
    s_add_u32 s73, s73, s66
    s_bfe_u32 s74, s65, 0x10001
    s_lshl_b32 s74, s74, 3
    s_lshr_b32 s66, s64, 2
    s_add_u32 s74, s74, s66
    s_lshl_b32 s78, s72, 3
    s_add_u32 s78, s78, s73
    s_lshl_b32 s78, s78, 4
    s_add_u32 s78, s78, s74
    s_lshl_b32 s77, s64, 2
    s_and_b32 s66, s2, 3
    s_add_u32 s77, s77, s66
    s_lshl_b32 s77, s77, 2
    s_add_u32 s77, s77, s24
    s_lshl_b32 s77, s77, 14
    s_mul_i32 s65, s25, 40960
    s_lshl_b32 s66, s26, 12
    s_add_u32 s31, s65, s66
    s_add_u32 s31, s31, 90112
    s_mul_i32 s67, s26, 7168
    s_add_u32 s30, s65, s67
    s_add_u32 s30, s30, 8192
    s_mul_i32 s67, s26, 81920
    s_add_u32 s32, s65, s67
    s_mul_i32 s33, s24, 40960
    s_lshl_b32 s68, s26, 4
    v_add_u32 v12, s68, v30
    v_lshlrev_b32 v12, 13, v12
    s_lshl_b32 s68, s25, 8
    v_add_u32 v12, s68, v12
    v_lshlrev_b32 v1, 1, v30
    v_xor_b32 v1, v1, v29
    v_lshlrev_b32 v2, 4, v1
    v_xor_b32 v3, 128, v2
    v_add_u32 v24, v12, v2
    v_add_u32 v24, 0, v24
    v_add_u32 v25, v12, v2
    v_add_u32 v25, 31744, v25
    v_add_u32 v26, v12, v3
    v_add_u32 v26, 63488, v26
    v_add_u32 v27, v12, v3
    v_add_u32 v27, 95232, v27
    v_lshrrev_b32 v12, 3, v28
    s_mul_i32 s67, s25, 112
    s_mul_i32 s68, s26, 56
    s_add_u32 s67, s67, s68
    v_add_u32 v12, s67, v12
    v_lshlrev_b32 v12, 11, v12
    v_and_b32 v1, 7, v28
    v_xor_b32 v1, v1, v30
    s_lshl_b32 s68, s26, 2
    v_xor_b32 v1, s68, v1
    v_lshlrev_b32 v2, 4, v1
    v_xor_b32 v3, 64, v2
    v_add_u32 v17, v12, v2
    v_add_u32 v17, 0, v17
    v_add_u32 v18, v12, v3
    v_add_u32 v18, 15360, v18
    v_add_u32 v19, v12, v2
    v_add_u32 v19, 30720, v19
    v_add_u32 v20, v12, v3
    v_add_u32 v20, 46080, v20
    v_add_u32 v21, v12, v2
    v_add_u32 v21, 65536, v21
    v_add_u32 v22, v12, v3
    v_add_u32 v22, 80896, v22
    v_add_u32 v23, v12, v2
    v_add_u32 v23, 96256, v23
    s_mov_b32 s27, 0
    s_mov_b32 s28, 0
    v_mov_b32 v15, 0
    s_waitcnt lgkmcnt(0)
    s_cmp_eq_u32 s72, 0
    s_cselect_b32 s42, s42, s52
    s_cselect_b32 s43, s43, s53
    s_cselect_b32 s36, s36, s46
    s_cselect_b32 s37, s37, s47
    s_cselect_b32 s38, s38, s48
    s_cselect_b32 s39, s39, s49
    s_cselect_b32 s40, s40, s50
    s_cselect_b32 s41, s41, s51
    s_cselect_b32 s44, s44, s54
    s_cselect_b32 s45, s45, s55
    s_lshl_b32 s65, s74, 9
    s_sub_u32 s67, 8388608, s65
    s_add_u32 s8, s42, s65
    s_addc_u32 s9, s43, 0
    s_mov_b32 s10, s67
    s_mov_b32 s11, 0x20000
    s_mul_i32 s65, s73, 458752
    s_add_u32 s4, s36, s65
    s_addc_u32 s5, s37, 0
    s_mov_b32 s6, 458752
    s_mov_b32 s7, 0x20000
    s_add_u32 m0, s31, 0
    s_nop 0
    buffer_load_dwordx4 v24, s[8:11], s28 offen lds
    buffer_load_dwordx4 v25, s[8:11], s28 offen offset:1024 lds
    buffer_load_dwordx4 v26, s[8:11], s28 offen offset:2048 lds
    buffer_load_dwordx4 v27, s[8:11], s28 offen offset:3072 lds
    s_add_u32 s28, s28, 262144
    s_add_u32 m0, s30, 0
    s_nop 0
    buffer_load_dwordx4 v17, s[4:7], s27 offen lds
    buffer_load_dwordx4 v18, s[4:7], s27 offen offset:1024 lds
    buffer_load_dwordx4 v19, s[4:7], s27 offen offset:2048 lds
    buffer_load_dwordx4 v20, s[4:7], s27 offen offset:3072 lds
    s_add_u32 m0, s30, 4096
    s_nop 0
    buffer_load_dwordx4 v21, s[4:7], s27 offen lds
    buffer_load_dwordx4 v22, s[4:7], s27 offen offset:1024 lds
    buffer_load_dwordx4 v23, s[4:7], s27 offen offset:2048 lds
    s_add_u32 s27, s27, 128
    s_add_u32 s16, s60, 33554432
    s_addc_u32 s17, s61, 0
    s_mov_b32 s18, 36864
    s_mov_b32 s19, 0x20000
    s_or_b32 s65, s78, s24
    s_cmp_lg_u32 s65, 0
    s_cbranch_scc1 L_ep1
    buffer_load_dword v16, v15, s[16:19], 0 offen sc1
L_ep1:
    s_add_u32 m0, s31, 8192
    s_nop 0
    buffer_load_dwordx4 v24, s[8:11], s28 offen lds
    buffer_load_dwordx4 v25, s[8:11], s28 offen offset:1024 lds
    buffer_load_dwordx4 v26, s[8:11], s28 offen offset:2048 lds
    buffer_load_dwordx4 v27, s[8:11], s28 offen offset:3072 lds
    s_add_u32 s28, s28, 262144
    s_add_u32 m0, s30, 18432
    s_nop 0
    buffer_load_dwordx4 v17, s[4:7], s27 offen lds
    buffer_load_dwordx4 v18, s[4:7], s27 offen offset:1024 lds
    buffer_load_dwordx4 v19, s[4:7], s27 offen offset:2048 lds
    buffer_load_dwordx4 v20, s[4:7], s27 offen offset:3072 lds
    s_add_u32 m0, s30, 22528
    s_nop 0
    buffer_load_dwordx4 v21, s[4:7], s27 offen lds
    buffer_load_dwordx4 v22, s[4:7], s27 offen offset:1024 lds
    buffer_load_dwordx4 v23, s[4:7], s27 offen offset:2048 lds
    s_add_u32 s27, s27, 128
    s_add_u32 m0, s31, 16384
    s_nop 0
    buffer_load_dwordx4 v24, s[8:11], s28 offen lds
    buffer_load_dwordx4 v25, s[8:11], s28 offen offset:1024 lds
    buffer_load_dwordx4 v26, s[8:11], s28 offen offset:2048 lds
    buffer_load_dwordx4 v27, s[8:11], s28 offen offset:3072 lds
    s_add_u32 s28, s28, 262144
    s_add_u32 m0, s31, 24576
    s_nop 0
    buffer_load_dwordx4 v24, s[8:11], s28 offen lds
    buffer_load_dwordx4 v25, s[8:11], s28 offen offset:1024 lds
    buffer_load_dwordx4 v26, s[8:11], s28 offen offset:2048 lds
    buffer_load_dwordx4 v27, s[8:11], s28 offen offset:3072 lds
    s_add_u32 s28, s28, 262144
    v_and_b32 v1, 2, v30
    v_lshlrev_b32 v1, 1, v1
    v_and_b32 v2, 1, v30
    v_or_b32 v1, v1, v2
    v_lshlrev_b32 v2, 1, v30
    s_cmp_eq_u32 s26, 0
    s_cselect_b64 vcc, -1, 0
    v_cndmask_b32 v1, v2, v1, vcc
    v_xor_b32 v1, v1, v29
    v_lshlrev_b32 v1, 4, v1
    v_lshl_add_u32 v13, v30, 8, v1
    v_xor_b32 v14, 128, v13
    s_cselect_b32 s38, s38, s40
    s_cselect_b32 s39, s39, s41
    s_lshl_b32 s65, s73, 5
    s_lshl_b32 s67, s74, 1
    s_add_u32 s65, s65, s67
    s_add_u32 s65, s65, s25
    s_lshl_b32 s65, s65, 18
    s_add_u32 s12, s38, s65
    s_addc_u32 s13, s39, 0
    s_mov_b32 s14, 262144
    s_mov_b32 s15, 0x20000
    s_lshr_b32 s65, s78, 4
    s_lshl_b32 s65, s65, 1
    s_add_u32 s65, s65, s26
    s_lshl_b32 s65, s65, 5
    s_lshl_b32 s67, s74, 1
    s_add_u32 s65, s65, s67
    s_add_u32 s65, s65, s25
    s_mul_i32 s65, s65, 28672
    s_add_u32 s20, s60, s65
    s_addc_u32 s21, s61, 0
    s_mov_b32 s22, 28672
    s_mov_b32 s23, 0x20000
    s_getreg_b32 s79, hwreg(HW_REG_XCC_ID, 0, 4)
    s_mov_b32 s35, 0
    s_mov_b32 s62, 0x3e0293ee
    s_mov_b32 s63, 0x7fff
    s_mov_b32 s75, 1024
    v_lshrrev_b32 v12, 1, v29
    v_xor_b32 v12, v12, v30
    v_lshlrev_b32 v12, 4, v12
    v_lshlrev_b32 v1, 7, v29
    s_mul_i32 s65, s26, 40960
    s_add_u32 s65, s65, 8192
    v_add_u32 v1, s65, v1
    v_add_u32 v9, v1, v12
    v_xor_b32 v12, 64, v12
    v_add_u32 v10, v1, v12
    v_bfe_u32 v31, v28, 2, 2
    v_and_b32 v11, 3, v28
    s_mul_i32 s65, s25, 40960
    s_add_u32 s66, s65, 90112
    v_lshl_add_u32 v12, v30, 3, v31
    v_lshlrev_b32 v12, 8, v12
    v_lshl_add_u32 v12, v11, 3, v12
    v_add_u32 v12, s66, v12
    v_and_b32 v33, 1, v30
    v_lshl_add_u32 v33, v33, 2, v31
    v_lshlrev_b32 v33, 5, v33
    v_xor_b32 v1, 0, v33
    v_add_u32 v1, v12, v1
    v_xor_b32 v2, 32, v33
    v_add_u32 v2, v12, v2
    v_xor_b32 v3, 64, v33
    v_add_u32 v3, v12, v3
    v_xor_b32 v4, 96, v33
    v_add_u32 v4, v12, v4
    v_xor_b32 v5, 128, v33
    v_add_u32 v5, v12, v5
    v_xor_b32 v6, 160, v33
    v_add_u32 v6, v12, v6
    v_xor_b32 v7, 192, v33
    v_add_u32 v7, v12, v7
    v_xor_b32 v8, 224, v33
    v_add_u32 v8, v12, v8
    v_lshl_add_u32 v33, v30, 2, v31
    v_lshlrev_b32 v33, 8, v33
    v_lshl_add_u32 v33, v11, 3, v33
    s_add_u32 s66, s65, 81920
    v_add_u32 v31, s66, v33
    v_and_b32 v33, 1, v30
    v_lshlrev_b32 v33, 1, v33
    v_lshrrev_b32 v34, 1, v30
    v_or_b32 v33, v33, v34
    v_and_b32 v34, 1, v29
    v_xor_b32 v33, v33, v34
    v_and_b32 v34, 6, v29
    v_lshlrev_b32 v34, 1, v34
    v_xor_b32 v33, v33, v34
    v_lshlrev_b32 v28, 4, v33
    v_lshlrev_b32 v34, 8, v29
    v_add_u32 v29, s65, v34
    v_mov_b64 v[32:33], 0
    v_mov_b64 v[34:35], 0
    v_mov_b64 v[36:37], 0
    v_mov_b64 v[38:39], 0
    v_mov_b64 v[40:41], 0
    v_mov_b64 v[42:43], 0
    v_mov_b64 v[44:45], 0
    v_mov_b64 v[46:47], 0
    v_mov_b64 v[48:49], 0
    v_mov_b64 v[50:51], 0
    v_mov_b64 v[52:53], 0
    v_mov_b64 v[54:55], 0
    v_mov_b64 v[56:57], 0
    v_mov_b64 v[58:59], 0
    v_mov_b64 v[60:61], 0
    v_mov_b64 v[62:63], 0
    v_mov_b64 v[64:65], 0
    v_mov_b64 v[66:67], 0
    v_mov_b64 v[68:69], 0
    v_mov_b64 v[70:71], 0
    v_mov_b64 v[72:73], 0
    v_mov_b64 v[74:75], 0
    v_mov_b64 v[76:77], 0
    v_mov_b64 v[78:79], 0
    v_mov_b64 v[80:81], 0
    v_mov_b64 v[82:83], 0
    v_mov_b64 v[84:85], 0
    v_mov_b64 v[86:87], 0
    v_mov_b64 v[88:89], 0
    v_mov_b64 v[90:91], 0
    v_mov_b64 v[92:93], 0
    v_mov_b64 v[94:95], 0
    v_mov_b64 v[96:97], 0
    v_mov_b64 v[98:99], 0
    v_mov_b64 v[100:101], 0
    v_mov_b64 v[102:103], 0
    v_mov_b64 v[104:105], 0
    v_mov_b64 v[106:107], 0
    v_mov_b64 v[108:109], 0
    v_mov_b64 v[110:111], 0
    v_mov_b64 v[112:113], 0
    v_mov_b64 v[114:115], 0
    v_mov_b64 v[116:117], 0
    v_mov_b64 v[118:119], 0
    v_mov_b64 v[120:121], 0
    v_mov_b64 v[122:123], 0
    v_mov_b64 v[124:125], 0
    v_mov_b64 v[126:127], 0
    v_mov_b64 v[128:129], 0
    v_mov_b64 v[130:131], 0
    v_mov_b64 v[132:133], 0
    v_mov_b64 v[134:135], 0
    v_mov_b64 v[136:137], 0
    v_mov_b64 v[138:139], 0
    v_mov_b64 v[140:141], 0
    v_mov_b64 v[142:143], 0
    v_mov_b64 v[144:145], 0
    v_mov_b64 v[146:147], 0
    v_mov_b64 v[148:149], 0
    v_mov_b64 v[150:151], 0
    v_mov_b64 v[152:153], 0
    v_mov_b64 v[154:155], 0
    v_mov_b64 v[156:157], 0
    v_mov_b64 v[158:159], 0
    v_mov_b64 v[160:161], 0
    v_mov_b64 v[162:163], 0
    v_mov_b64 v[164:165], 0
    v_mov_b64 v[166:167], 0
    v_mov_b64 v[168:169], 0
    v_mov_b64 v[170:171], 0
    v_mov_b64 v[172:173], 0
    v_mov_b64 v[174:175], 0
    v_mov_b64 v[176:177], 0
    v_mov_b64 v[178:179], 0
    v_mov_b64 v[180:181], 0
    v_mov_b64 v[182:183], 0
    v_mov_b64 v[184:185], 0
    v_mov_b64 v[186:187], 0
    v_mov_b64 v[188:189], 0
    v_mov_b64 v[190:191], 0
    v_mov_b64 v[192:193], 0
    v_mov_b64 v[194:195], 0
    v_mov_b64 v[196:197], 0
    v_mov_b64 v[198:199], 0
    v_mov_b64 v[200:201], 0
    v_mov_b64 v[202:203], 0
    v_mov_b64 v[204:205], 0
    v_mov_b64 v[206:207], 0
    v_mov_b64 v[208:209], 0
    v_mov_b64 v[210:211], 0
    v_mov_b64 v[212:213], 0
    v_mov_b64 v[214:215], 0
    v_mov_b64 v[216:217], 0
    v_mov_b64 v[218:219], 0
    v_mov_b64 v[220:221], 0
    v_mov_b64 v[222:223], 0
    v_mov_b64 v[224:225], 0
    v_mov_b64 v[226:227], 0
    v_mov_b64 v[228:229], 0
    v_mov_b64 v[230:231], 0
    v_mov_b64 v[232:233], 0
    v_mov_b64 v[234:235], 0
    v_mov_b64 v[236:237], 0
    v_mov_b64 v[238:239], 0
    v_mov_b64 v[240:241], 0
    v_mov_b64 v[242:243], 0
    v_mov_b64 v[244:245], 0
    v_mov_b64 v[246:247], 0
    v_mov_b64 v[248:249], 0
    v_mov_b64 v[250:251], 0
    v_mov_b64 v[252:253], 0
    v_mov_b64 v[254:255], 0
    s_mov_b32 s34, 7
    s_mov_b32 s69, 0
    s_mov_b32 s71, 0
    s_mov_b32 s70, 0x40000000
    s_mov_b32 s76, 0
    s_or_b32 s65, s78, s24
    s_cmp_lg_u32 s65, 0
    s_cbranch_scc1 L_ep2
    s_add_u32 s64, s58, 0
    s_addc_u32 s65, s59, 0
    s_mov_b32 s66, 256
    s_mov_b32 s67, 0x20000
    s_waitcnt vmcnt(19)
    v_add_u32 v16, 1, v16
    v_max_u32 v16, 1, v16
    s_mov_b64 exec, 1
    buffer_store_dword v16, v15, s[16:19], 0 offen sc1
    buffer_store_dword v16, v15, s[64:67], 0 offen sc1
    s_mov_b64 exec, -1
L_ep2:
    s_waitcnt vmcnt(19)
    s_barrier
    ds_read_b128 a[208:211], v9
    ds_read_b128 a[212:215], v9 offset:2048
    ds_read_b128 a[216:219], v9 offset:4096
    ds_read_b128 a[220:223], v9 offset:6144
    ds_read_b128 a[224:227], v9 offset:8192
    ds_read_b128 a[228:231], v9 offset:10240
    ds_read_b128 a[232:235], v9 offset:12288
    ds_read_b64_tr_b16 a[176:177], v1
    ds_read_b64_tr_b16 a[178:179], v1 offset:1024
    ds_read_b64_tr_b16 a[180:181], v2
    ds_read_b64_tr_b16 a[182:183], v2 offset:1024
    ds_read_b64_tr_b16 a[184:185], v3
    ds_read_b64_tr_b16 a[186:187], v3 offset:1024
    ds_read_b64_tr_b16 a[188:189], v4
    ds_read_b64_tr_b16 a[190:191], v4 offset:1024
    ds_read_b64_tr_b16 a[192:193], v5
    ds_read_b64_tr_b16 a[194:195], v5 offset:1024
    ds_read_b64_tr_b16 a[196:197], v6
    ds_read_b64_tr_b16 a[198:199], v6 offset:1024
    ds_read_b64_tr_b16 a[200:201], v7
    ds_read_b64_tr_b16 a[202:203], v7 offset:1024
    ds_read_b64_tr_b16 a[204:205], v8
    ds_read_b64_tr_b16 a[206:207], v8 offset:1024
L_qp:
    s_waitcnt lgkmcnt(14)
    v_mfma_f32_16x16x32_bf16 v[32:35], a[176:179], a[208:211], v[32:35]
    v_mfma_f32_16x16x32_bf16 v[64:67], a[176:179], a[212:215], v[64:67]
    v_mfma_f32_16x16x32_bf16 v[96:99], a[176:179], a[216:219], v[96:99]
    s_waitcnt lgkmcnt(11)
    v_mfma_f32_16x16x32_bf16 v[128:131], a[176:179], a[220:223], v[128:131]
    s_waitcnt lgkmcnt(8)
    v_mfma_f32_16x16x32_bf16 v[160:163], a[176:179], a[224:227], v[160:163]
    s_waitcnt lgkmcnt(5)
    v_mfma_f32_16x16x32_bf16 v[192:195], a[176:179], a[228:231], v[192:195]
    s_waitcnt vmcnt(15)
    s_waitcnt lgkmcnt(0)
    v_mfma_f32_16x16x32_bf16 v[224:227], a[176:179], a[232:235], v[224:227]
    s_barrier
    ds_read_b64_tr_b16 a[176:177], v1 offset:8192
    ds_read_b64_tr_b16 a[178:179], v1 offset:9216
    v_mfma_f32_16x16x32_bf16 v[36:39], a[180:183], a[208:211], v[36:39]
    v_mfma_f32_16x16x32_bf16 v[68:71], a[180:183], a[212:215], v[68:71]
    s_add_u32 m0, s32, s69
    ds_read_b128 a[0:3], v10
    v_mfma_f32_16x16x32_bf16 v[100:103], a[180:183], a[216:219], v[100:103]
    buffer_load_dwordx4 v13, s[12:15], s70 offen lds
    v_mfma_f32_16x16x32_bf16 v[132:135], a[180:183], a[220:223], v[132:135]
    v_mfma_f32_16x16x32_bf16 v[164:167], a[180:183], a[224:227], v[164:167]
    v_mfma_f32_16x16x32_bf16 v[196:199], a[180:183], a[228:231], v[196:199]
    v_mfma_f32_16x16x32_bf16 v[228:231], a[180:183], a[232:235], v[228:231]
    ds_read_b64_tr_b16 a[180:181], v2 offset:8192
    ds_read_b64_tr_b16 a[182:183], v2 offset:9216
    v_mfma_f32_16x16x32_bf16 v[40:43], a[184:187], a[208:211], v[40:43]
    v_mfma_f32_16x16x32_bf16 v[72:75], a[184:187], a[212:215], v[72:75]
    s_add_u32 s69, s69, s71
    s_add_u32 s70, s70, s76
    s_add_u32 m0, s32, s69
    ds_read_b128 a[4:7], v10 offset:2048
    v_mfma_f32_16x16x32_bf16 v[104:107], a[184:187], a[216:219], v[104:107]
    buffer_load_dwordx4 v14, s[12:15], s70 offen lds
    v_mfma_f32_16x16x32_bf16 v[136:139], a[184:187], a[220:223], v[136:139]
    v_mfma_f32_16x16x32_bf16 v[168:171], a[184:187], a[224:227], v[168:171]
    v_mfma_f32_16x16x32_bf16 v[200:203], a[184:187], a[228:231], v[200:203]
    v_mfma_f32_16x16x32_bf16 v[232:235], a[184:187], a[232:235], v[232:235]
    ds_read_b64_tr_b16 a[184:185], v3 offset:8192
    ds_read_b64_tr_b16 a[186:187], v3 offset:9216
    v_mfma_f32_16x16x32_bf16 v[44:47], a[188:191], a[208:211], v[44:47]
    v_mfma_f32_16x16x32_bf16 v[76:79], a[188:191], a[212:215], v[76:79]
    ds_read_b128 a[8:11], v10 offset:4096
    v_mfma_f32_16x16x32_bf16 v[108:111], a[188:191], a[216:219], v[108:111]
    s_add_u32 s69, s69, s71
    s_add_u32 s70, s70, s76
    s_add_u32 m0, s31, 0
    v_mfma_f32_16x16x32_bf16 v[140:143], a[188:191], a[220:223], v[140:143]
    buffer_load_dwordx4 v24, s[8:11], s28 offen lds
    v_mfma_f32_16x16x32_bf16 v[172:175], a[188:191], a[224:227], v[172:175]
    v_mfma_f32_16x16x32_bf16 v[204:207], a[188:191], a[228:231], v[204:207]
    v_mfma_f32_16x16x32_bf16 v[236:239], a[188:191], a[232:235], v[236:239]
    ds_read_b64_tr_b16 a[188:189], v4 offset:8192
    ds_read_b64_tr_b16 a[190:191], v4 offset:9216
    v_mfma_f32_16x16x32_bf16 v[48:51], a[192:195], a[208:211], v[48:51]
    v_mfma_f32_16x16x32_bf16 v[80:83], a[192:195], a[212:215], v[80:83]
    ds_read_b128 a[12:15], v10 offset:6144
    v_mfma_f32_16x16x32_bf16 v[112:115], a[192:195], a[216:219], v[112:115]
    v_mfma_f32_16x16x32_bf16 v[144:147], a[192:195], a[220:223], v[144:147]
    v_mfma_f32_16x16x32_bf16 v[176:179], a[192:195], a[224:227], v[176:179]
    buffer_load_dwordx4 v25, s[8:11], s28 offen offset:1024 lds
    v_mfma_f32_16x16x32_bf16 v[208:211], a[192:195], a[228:231], v[208:211]
    v_mfma_f32_16x16x32_bf16 v[240:243], a[192:195], a[232:235], v[240:243]
    ds_read_b64_tr_b16 a[192:193], v5 offset:8192
    ds_read_b64_tr_b16 a[194:195], v5 offset:9216
    v_mfma_f32_16x16x32_bf16 v[52:55], a[196:199], a[208:211], v[52:55]
    v_mfma_f32_16x16x32_bf16 v[84:87], a[196:199], a[212:215], v[84:87]
    ds_read_b128 a[16:19], v10 offset:8192
    v_mfma_f32_16x16x32_bf16 v[116:119], a[196:199], a[216:219], v[116:119]
    v_mfma_f32_16x16x32_bf16 v[148:151], a[196:199], a[220:223], v[148:151]
    v_mfma_f32_16x16x32_bf16 v[180:183], a[196:199], a[224:227], v[180:183]
    buffer_load_dwordx4 v26, s[8:11], s28 offen offset:2048 lds
    v_mfma_f32_16x16x32_bf16 v[212:215], a[196:199], a[228:231], v[212:215]
    v_mfma_f32_16x16x32_bf16 v[244:247], a[196:199], a[232:235], v[244:247]
    ds_read_b64_tr_b16 a[196:197], v6 offset:8192
    ds_read_b64_tr_b16 a[198:199], v6 offset:9216
    v_mfma_f32_16x16x32_bf16 v[56:59], a[200:203], a[208:211], v[56:59]
    v_mfma_f32_16x16x32_bf16 v[88:91], a[200:203], a[212:215], v[88:91]
    ds_read_b128 a[20:23], v10 offset:10240
    v_mfma_f32_16x16x32_bf16 v[120:123], a[200:203], a[216:219], v[120:123]
    v_mfma_f32_16x16x32_bf16 v[152:155], a[200:203], a[220:223], v[152:155]
    v_mfma_f32_16x16x32_bf16 v[184:187], a[200:203], a[224:227], v[184:187]
    v_mfma_f32_16x16x32_bf16 v[216:219], a[200:203], a[228:231], v[216:219]
    buffer_load_dwordx4 v27, s[8:11], s28 offen offset:3072 lds
    v_mfma_f32_16x16x32_bf16 v[248:251], a[200:203], a[232:235], v[248:251]
    s_add_u32 s28, s28, 262144
    ds_read_b64_tr_b16 a[200:201], v7 offset:8192
    ds_read_b64_tr_b16 a[202:203], v7 offset:9216
    v_mfma_f32_16x16x32_bf16 v[60:63], a[204:207], a[208:211], v[60:63]
    v_mfma_f32_16x16x32_bf16 v[92:95], a[204:207], a[212:215], v[92:95]
    ds_read_b128 a[24:27], v10 offset:12288
    v_mfma_f32_16x16x32_bf16 v[124:127], a[204:207], a[216:219], v[124:127]
    v_mfma_f32_16x16x32_bf16 v[156:159], a[204:207], a[220:223], v[156:159]
    v_mfma_f32_16x16x32_bf16 v[188:191], a[204:207], a[224:227], v[188:191]
    v_mfma_f32_16x16x32_bf16 v[220:223], a[204:207], a[228:231], v[220:223]
    v_mfma_f32_16x16x32_bf16 v[252:255], a[204:207], a[232:235], v[252:255]
    s_waitcnt lgkmcnt(15)
    ds_read_b64_tr_b16 a[204:205], v8 offset:8192
    ds_read_b64_tr_b16 a[206:207], v8 offset:9216
    v_mfma_f32_16x16x32_bf16 v[32:35], a[176:179], a[0:3], v[32:35]
    v_mfma_f32_16x16x32_bf16 v[64:67], a[176:179], a[4:7], v[64:67]
    s_waitcnt lgkmcnt(14)
    v_mfma_f32_16x16x32_bf16 v[96:99], a[176:179], a[8:11], v[96:99]
    s_waitcnt lgkmcnt(11)
    v_mfma_f32_16x16x32_bf16 v[128:131], a[176:179], a[12:15], v[128:131]
    s_waitcnt lgkmcnt(8)
    v_mfma_f32_16x16x32_bf16 v[160:163], a[176:179], a[16:19], v[160:163]
    s_waitcnt lgkmcnt(5)
    v_mfma_f32_16x16x32_bf16 v[192:195], a[176:179], a[20:23], v[192:195]
    s_waitcnt vmcnt(10)
    s_waitcnt lgkmcnt(0)
    v_mfma_f32_16x16x32_bf16 v[224:227], a[176:179], a[24:27], v[224:227]
    s_barrier
    ds_read_b64_tr_b16 a[176:177], v1 offset:16384
    ds_read_b64_tr_b16 a[178:179], v1 offset:17408
    v_mfma_f32_16x16x32_bf16 v[36:39], a[180:183], a[0:3], v[36:39]
    v_mfma_f32_16x16x32_bf16 v[68:71], a[180:183], a[4:7], v[68:71]
    s_add_u32 m0, s30, 0
    ds_read_b128 a[208:211], v9 offset:18432
    v_mfma_f32_16x16x32_bf16 v[100:103], a[180:183], a[8:11], v[100:103]
    buffer_load_dwordx4 v17, s[4:7], s27 offen lds
    v_mfma_f32_16x16x32_bf16 v[132:135], a[180:183], a[12:15], v[132:135]
    v_mfma_f32_16x16x32_bf16 v[164:167], a[180:183], a[16:19], v[164:167]
    v_mfma_f32_16x16x32_bf16 v[196:199], a[180:183], a[20:23], v[196:199]
    buffer_load_dwordx4 v18, s[4:7], s27 offen offset:1024 lds
    v_mfma_f32_16x16x32_bf16 v[228:231], a[180:183], a[24:27], v[228:231]
    ds_read_b64_tr_b16 a[180:181], v2 offset:16384
    ds_read_b64_tr_b16 a[182:183], v2 offset:17408
    v_mfma_f32_16x16x32_bf16 v[40:43], a[184:187], a[0:3], v[40:43]
    v_mfma_f32_16x16x32_bf16 v[72:75], a[184:187], a[4:7], v[72:75]
    ds_read_b128 a[212:215], v9 offset:20480
    v_mfma_f32_16x16x32_bf16 v[104:107], a[184:187], a[8:11], v[104:107]
    v_mfma_f32_16x16x32_bf16 v[136:139], a[184:187], a[12:15], v[136:139]
    buffer_load_dwordx4 v19, s[4:7], s27 offen offset:2048 lds
    v_mfma_f32_16x16x32_bf16 v[168:171], a[184:187], a[16:19], v[168:171]
    v_mfma_f32_16x16x32_bf16 v[200:203], a[184:187], a[20:23], v[200:203]
    v_mfma_f32_16x16x32_bf16 v[232:235], a[184:187], a[24:27], v[232:235]
    ds_read_b64_tr_b16 a[184:185], v3 offset:16384
    ds_read_b64_tr_b16 a[186:187], v3 offset:17408
    v_mfma_f32_16x16x32_bf16 v[44:47], a[188:191], a[0:3], v[44:47]
    buffer_load_dwordx4 v20, s[4:7], s27 offen offset:3072 lds
    v_mfma_f32_16x16x32_bf16 v[76:79], a[188:191], a[4:7], v[76:79]
    ds_read_b128 a[216:219], v9 offset:22528
    v_mfma_f32_16x16x32_bf16 v[108:111], a[188:191], a[8:11], v[108:111]
    v_mfma_f32_16x16x32_bf16 v[140:143], a[188:191], a[12:15], v[140:143]
    s_add_u32 m0, s30, 4096
    v_mfma_f32_16x16x32_bf16 v[172:175], a[188:191], a[16:19], v[172:175]
    buffer_load_dwordx4 v21, s[4:7], s27 offen lds
    v_mfma_f32_16x16x32_bf16 v[204:207], a[188:191], a[20:23], v[204:207]
    v_mfma_f32_16x16x32_bf16 v[236:239], a[188:191], a[24:27], v[236:239]
    ds_read_b64_tr_b16 a[188:189], v4 offset:16384
    ds_read_b64_tr_b16 a[190:191], v4 offset:17408
    v_mfma_f32_16x16x32_bf16 v[48:51], a[192:195], a[0:3], v[48:51]
    v_mfma_f32_16x16x32_bf16 v[80:83], a[192:195], a[4:7], v[80:83]
    ds_read_b128 a[220:223], v9 offset:24576
    v_mfma_f32_16x16x32_bf16 v[112:115], a[192:195], a[8:11], v[112:115]
    buffer_load_dwordx4 v22, s[4:7], s27 offen offset:1024 lds
    v_mfma_f32_16x16x32_bf16 v[144:147], a[192:195], a[12:15], v[144:147]
    v_mfma_f32_16x16x32_bf16 v[176:179], a[192:195], a[16:19], v[176:179]
    v_mfma_f32_16x16x32_bf16 v[208:211], a[192:195], a[20:23], v[208:211]
    buffer_load_dwordx4 v23, s[4:7], s27 offen offset:2048 lds
    v_mfma_f32_16x16x32_bf16 v[240:243], a[192:195], a[24:27], v[240:243]
    ds_read_b64_tr_b16 a[192:193], v5 offset:16384
    ds_read_b64_tr_b16 a[194:195], v5 offset:17408
    v_mfma_f32_16x16x32_bf16 v[52:55], a[196:199], a[0:3], v[52:55]
    v_mfma_f32_16x16x32_bf16 v[84:87], a[196:199], a[4:7], v[84:87]
    ds_read_b128 a[224:227], v9 offset:26624
    v_mfma_f32_16x16x32_bf16 v[116:119], a[196:199], a[8:11], v[116:119]
    s_add_u32 s27, s27, 128
    s_add_u32 m0, s31, 8192
    v_mfma_f32_16x16x32_bf16 v[148:151], a[196:199], a[12:15], v[148:151]
    buffer_load_dwordx4 v24, s[8:11], s28 offen lds
    v_mfma_f32_16x16x32_bf16 v[180:183], a[196:199], a[16:19], v[180:183]
    v_mfma_f32_16x16x32_bf16 v[212:215], a[196:199], a[20:23], v[212:215]
    v_mfma_f32_16x16x32_bf16 v[244:247], a[196:199], a[24:27], v[244:247]
    ds_read_b64_tr_b16 a[196:197], v6 offset:16384
    ds_read_b64_tr_b16 a[198:199], v6 offset:17408
    v_mfma_f32_16x16x32_bf16 v[56:59], a[200:203], a[0:3], v[56:59]
    buffer_load_dwordx4 v25, s[8:11], s28 offen offset:1024 lds
    v_mfma_f32_16x16x32_bf16 v[88:91], a[200:203], a[4:7], v[88:91]
    ds_read_b128 a[228:231], v9 offset:28672
    v_mfma_f32_16x16x32_bf16 v[120:123], a[200:203], a[8:11], v[120:123]
    v_mfma_f32_16x16x32_bf16 v[152:155], a[200:203], a[12:15], v[152:155]
    v_mfma_f32_16x16x32_bf16 v[184:187], a[200:203], a[16:19], v[184:187]
    buffer_load_dwordx4 v26, s[8:11], s28 offen offset:2048 lds
    v_mfma_f32_16x16x32_bf16 v[216:219], a[200:203], a[20:23], v[216:219]
    v_mfma_f32_16x16x32_bf16 v[248:251], a[200:203], a[24:27], v[248:251]
    ds_read_b64_tr_b16 a[200:201], v7 offset:16384
    ds_read_b64_tr_b16 a[202:203], v7 offset:17408
    v_mfma_f32_16x16x32_bf16 v[60:63], a[204:207], a[0:3], v[60:63]
    v_mfma_f32_16x16x32_bf16 v[92:95], a[204:207], a[4:7], v[92:95]
    ds_read_b128 a[232:235], v9 offset:30720
    v_mfma_f32_16x16x32_bf16 v[124:127], a[204:207], a[8:11], v[124:127]
    buffer_load_dwordx4 v27, s[8:11], s28 offen offset:3072 lds
    v_mfma_f32_16x16x32_bf16 v[156:159], a[204:207], a[12:15], v[156:159]
    s_add_u32 s28, s28, 262144
    v_mfma_f32_16x16x32_bf16 v[188:191], a[204:207], a[16:19], v[188:191]
    v_mfma_f32_16x16x32_bf16 v[220:223], a[204:207], a[20:23], v[220:223]
    v_mfma_f32_16x16x32_bf16 v[252:255], a[204:207], a[24:27], v[252:255]
    s_waitcnt lgkmcnt(15)
    ds_read_b64_tr_b16 a[204:205], v8 offset:16384
    ds_read_b64_tr_b16 a[206:207], v8 offset:17408
    v_mfma_f32_16x16x32_bf16 v[32:35], a[176:179], a[208:211], v[32:35]
    v_mfma_f32_16x16x32_bf16 v[64:67], a[176:179], a[212:215], v[64:67]
    s_waitcnt lgkmcnt(14)
    v_mfma_f32_16x16x32_bf16 v[96:99], a[176:179], a[216:219], v[96:99]
    s_waitcnt lgkmcnt(11)
    v_mfma_f32_16x16x32_bf16 v[128:131], a[176:179], a[220:223], v[128:131]
    s_waitcnt lgkmcnt(8)
    v_mfma_f32_16x16x32_bf16 v[160:163], a[176:179], a[224:227], v[160:163]
    s_waitcnt lgkmcnt(5)
    v_mfma_f32_16x16x32_bf16 v[192:195], a[176:179], a[228:231], v[192:195]
    s_waitcnt vmcnt(17)
    s_waitcnt lgkmcnt(0)
    v_mfma_f32_16x16x32_bf16 v[224:227], a[176:179], a[232:235], v[224:227]
    s_barrier
    ds_read_b64_tr_b16 a[176:177], v1 offset:24576
    ds_read_b64_tr_b16 a[178:179], v1 offset:25600
    v_mfma_f32_16x16x32_bf16 v[36:39], a[180:183], a[208:211], v[36:39]
    v_mfma_f32_16x16x32_bf16 v[68:71], a[180:183], a[212:215], v[68:71]
    s_add_u32 m0, s32, s69
    ds_read_b128 a[0:3], v10 offset:18432
    v_mfma_f32_16x16x32_bf16 v[100:103], a[180:183], a[216:219], v[100:103]
    buffer_load_dwordx4 v13, s[12:15], s70 offen lds
    v_mfma_f32_16x16x32_bf16 v[132:135], a[180:183], a[220:223], v[132:135]
    v_mfma_f32_16x16x32_bf16 v[164:167], a[180:183], a[224:227], v[164:167]
    v_mfma_f32_16x16x32_bf16 v[196:199], a[180:183], a[228:231], v[196:199]
    v_mfma_f32_16x16x32_bf16 v[228:231], a[180:183], a[232:235], v[228:231]
    ds_read_b64_tr_b16 a[180:181], v2 offset:24576
    ds_read_b64_tr_b16 a[182:183], v2 offset:25600
    v_mfma_f32_16x16x32_bf16 v[40:43], a[184:187], a[208:211], v[40:43]
    v_mfma_f32_16x16x32_bf16 v[72:75], a[184:187], a[212:215], v[72:75]
    s_add_u32 s69, s69, s71
    s_add_u32 s70, s70, s76
    s_add_u32 m0, s32, s69
    ds_read_b128 a[4:7], v10 offset:20480
    v_mfma_f32_16x16x32_bf16 v[104:107], a[184:187], a[216:219], v[104:107]
    buffer_load_dwordx4 v14, s[12:15], s70 offen lds
    v_mfma_f32_16x16x32_bf16 v[136:139], a[184:187], a[220:223], v[136:139]
    v_mfma_f32_16x16x32_bf16 v[168:171], a[184:187], a[224:227], v[168:171]
    v_mfma_f32_16x16x32_bf16 v[200:203], a[184:187], a[228:231], v[200:203]
    v_mfma_f32_16x16x32_bf16 v[232:235], a[184:187], a[232:235], v[232:235]
    ds_read_b64_tr_b16 a[184:185], v3 offset:24576
    ds_read_b64_tr_b16 a[186:187], v3 offset:25600
    v_mfma_f32_16x16x32_bf16 v[44:47], a[188:191], a[208:211], v[44:47]
    v_mfma_f32_16x16x32_bf16 v[76:79], a[188:191], a[212:215], v[76:79]
    ds_read_b128 a[8:11], v10 offset:22528
    v_mfma_f32_16x16x32_bf16 v[108:111], a[188:191], a[216:219], v[108:111]
    s_add_u32 s69, s69, s71
    s_add_u32 s70, s70, s76
    s_add_u32 m0, s31, 16384
    v_mfma_f32_16x16x32_bf16 v[140:143], a[188:191], a[220:223], v[140:143]
    buffer_load_dwordx4 v24, s[8:11], s28 offen lds
    v_mfma_f32_16x16x32_bf16 v[172:175], a[188:191], a[224:227], v[172:175]
    v_mfma_f32_16x16x32_bf16 v[204:207], a[188:191], a[228:231], v[204:207]
    v_mfma_f32_16x16x32_bf16 v[236:239], a[188:191], a[232:235], v[236:239]
    ds_read_b64_tr_b16 a[188:189], v4 offset:24576
    ds_read_b64_tr_b16 a[190:191], v4 offset:25600
    v_mfma_f32_16x16x32_bf16 v[48:51], a[192:195], a[208:211], v[48:51]
    v_mfma_f32_16x16x32_bf16 v[80:83], a[192:195], a[212:215], v[80:83]
    ds_read_b128 a[12:15], v10 offset:24576
    v_mfma_f32_16x16x32_bf16 v[112:115], a[192:195], a[216:219], v[112:115]
    v_mfma_f32_16x16x32_bf16 v[144:147], a[192:195], a[220:223], v[144:147]
    v_mfma_f32_16x16x32_bf16 v[176:179], a[192:195], a[224:227], v[176:179]
    buffer_load_dwordx4 v25, s[8:11], s28 offen offset:1024 lds
    v_mfma_f32_16x16x32_bf16 v[208:211], a[192:195], a[228:231], v[208:211]
    v_mfma_f32_16x16x32_bf16 v[240:243], a[192:195], a[232:235], v[240:243]
    ds_read_b64_tr_b16 a[192:193], v5 offset:24576
    ds_read_b64_tr_b16 a[194:195], v5 offset:25600
    v_mfma_f32_16x16x32_bf16 v[52:55], a[196:199], a[208:211], v[52:55]
    v_mfma_f32_16x16x32_bf16 v[84:87], a[196:199], a[212:215], v[84:87]
    ds_read_b128 a[16:19], v10 offset:26624
    v_mfma_f32_16x16x32_bf16 v[116:119], a[196:199], a[216:219], v[116:119]
    v_mfma_f32_16x16x32_bf16 v[148:151], a[196:199], a[220:223], v[148:151]
    v_mfma_f32_16x16x32_bf16 v[180:183], a[196:199], a[224:227], v[180:183]
    buffer_load_dwordx4 v26, s[8:11], s28 offen offset:2048 lds
    v_mfma_f32_16x16x32_bf16 v[212:215], a[196:199], a[228:231], v[212:215]
    v_mfma_f32_16x16x32_bf16 v[244:247], a[196:199], a[232:235], v[244:247]
    ds_read_b64_tr_b16 a[196:197], v6 offset:24576
    ds_read_b64_tr_b16 a[198:199], v6 offset:25600
    v_mfma_f32_16x16x32_bf16 v[56:59], a[200:203], a[208:211], v[56:59]
    v_mfma_f32_16x16x32_bf16 v[88:91], a[200:203], a[212:215], v[88:91]
    ds_read_b128 a[20:23], v10 offset:28672
    v_mfma_f32_16x16x32_bf16 v[120:123], a[200:203], a[216:219], v[120:123]
    v_mfma_f32_16x16x32_bf16 v[152:155], a[200:203], a[220:223], v[152:155]
    v_mfma_f32_16x16x32_bf16 v[184:187], a[200:203], a[224:227], v[184:187]
    v_mfma_f32_16x16x32_bf16 v[216:219], a[200:203], a[228:231], v[216:219]
    buffer_load_dwordx4 v27, s[8:11], s28 offen offset:3072 lds
    v_mfma_f32_16x16x32_bf16 v[248:251], a[200:203], a[232:235], v[248:251]
    s_add_u32 s28, s28, 262144
    ds_read_b64_tr_b16 a[200:201], v7 offset:24576
    ds_read_b64_tr_b16 a[202:203], v7 offset:25600
    v_mfma_f32_16x16x32_bf16 v[60:63], a[204:207], a[208:211], v[60:63]
    v_mfma_f32_16x16x32_bf16 v[92:95], a[204:207], a[212:215], v[92:95]
    ds_read_b128 a[24:27], v10 offset:30720
    v_mfma_f32_16x16x32_bf16 v[124:127], a[204:207], a[216:219], v[124:127]
    v_mfma_f32_16x16x32_bf16 v[156:159], a[204:207], a[220:223], v[156:159]
    v_mfma_f32_16x16x32_bf16 v[188:191], a[204:207], a[224:227], v[188:191]
    v_mfma_f32_16x16x32_bf16 v[220:223], a[204:207], a[228:231], v[220:223]
    v_mfma_f32_16x16x32_bf16 v[252:255], a[204:207], a[232:235], v[252:255]
    s_waitcnt lgkmcnt(15)
    ds_read_b64_tr_b16 a[204:205], v8 offset:24576
    ds_read_b64_tr_b16 a[206:207], v8 offset:25600
    v_mfma_f32_16x16x32_bf16 v[32:35], a[176:179], a[0:3], v[32:35]
    v_mfma_f32_16x16x32_bf16 v[64:67], a[176:179], a[4:7], v[64:67]
    s_waitcnt lgkmcnt(14)
    v_mfma_f32_16x16x32_bf16 v[96:99], a[176:179], a[8:11], v[96:99]
    s_waitcnt lgkmcnt(11)
    v_mfma_f32_16x16x32_bf16 v[128:131], a[176:179], a[12:15], v[128:131]
    s_waitcnt lgkmcnt(8)
    v_mfma_f32_16x16x32_bf16 v[160:163], a[176:179], a[16:19], v[160:163]
    s_waitcnt lgkmcnt(5)
    v_mfma_f32_16x16x32_bf16 v[192:195], a[176:179], a[20:23], v[192:195]
    s_waitcnt vmcnt(10)
    s_waitcnt lgkmcnt(0)
    v_mfma_f32_16x16x32_bf16 v[224:227], a[176:179], a[24:27], v[224:227]
    s_barrier
    ds_read_b64_tr_b16 a[176:177], v1
    ds_read_b64_tr_b16 a[178:179], v1 offset:1024
    v_mfma_f32_16x16x32_bf16 v[36:39], a[180:183], a[0:3], v[36:39]
    v_mfma_f32_16x16x32_bf16 v[68:71], a[180:183], a[4:7], v[68:71]
    s_add_u32 m0, s30, 18432
    ds_read_b128 a[208:211], v9
    v_mfma_f32_16x16x32_bf16 v[100:103], a[180:183], a[8:11], v[100:103]
    buffer_load_dwordx4 v17, s[4:7], s27 offen lds
    v_mfma_f32_16x16x32_bf16 v[132:135], a[180:183], a[12:15], v[132:135]
    v_mfma_f32_16x16x32_bf16 v[164:167], a[180:183], a[16:19], v[164:167]
    v_mfma_f32_16x16x32_bf16 v[196:199], a[180:183], a[20:23], v[196:199]
    buffer_load_dwordx4 v18, s[4:7], s27 offen offset:1024 lds
    v_mfma_f32_16x16x32_bf16 v[228:231], a[180:183], a[24:27], v[228:231]
    ds_read_b64_tr_b16 a[180:181], v2
    ds_read_b64_tr_b16 a[182:183], v2 offset:1024
    v_mfma_f32_16x16x32_bf16 v[40:43], a[184:187], a[0:3], v[40:43]
    v_mfma_f32_16x16x32_bf16 v[72:75], a[184:187], a[4:7], v[72:75]
    ds_read_b128 a[212:215], v9 offset:2048
    v_mfma_f32_16x16x32_bf16 v[104:107], a[184:187], a[8:11], v[104:107]
    v_mfma_f32_16x16x32_bf16 v[136:139], a[184:187], a[12:15], v[136:139]
    buffer_load_dwordx4 v19, s[4:7], s27 offen offset:2048 lds
    v_mfma_f32_16x16x32_bf16 v[168:171], a[184:187], a[16:19], v[168:171]
    v_mfma_f32_16x16x32_bf16 v[200:203], a[184:187], a[20:23], v[200:203]
    v_mfma_f32_16x16x32_bf16 v[232:235], a[184:187], a[24:27], v[232:235]
    ds_read_b64_tr_b16 a[184:185], v3
    ds_read_b64_tr_b16 a[186:187], v3 offset:1024
    v_mfma_f32_16x16x32_bf16 v[44:47], a[188:191], a[0:3], v[44:47]
    buffer_load_dwordx4 v20, s[4:7], s27 offen offset:3072 lds
    v_mfma_f32_16x16x32_bf16 v[76:79], a[188:191], a[4:7], v[76:79]
    ds_read_b128 a[216:219], v9 offset:4096
    v_mfma_f32_16x16x32_bf16 v[108:111], a[188:191], a[8:11], v[108:111]
    v_mfma_f32_16x16x32_bf16 v[140:143], a[188:191], a[12:15], v[140:143]
    s_add_u32 m0, s30, 22528
    v_mfma_f32_16x16x32_bf16 v[172:175], a[188:191], a[16:19], v[172:175]
    buffer_load_dwordx4 v21, s[4:7], s27 offen lds
    v_mfma_f32_16x16x32_bf16 v[204:207], a[188:191], a[20:23], v[204:207]
    v_mfma_f32_16x16x32_bf16 v[236:239], a[188:191], a[24:27], v[236:239]
    ds_read_b64_tr_b16 a[188:189], v4
    ds_read_b64_tr_b16 a[190:191], v4 offset:1024
    v_mfma_f32_16x16x32_bf16 v[48:51], a[192:195], a[0:3], v[48:51]
    v_mfma_f32_16x16x32_bf16 v[80:83], a[192:195], a[4:7], v[80:83]
    ds_read_b128 a[220:223], v9 offset:6144
    v_mfma_f32_16x16x32_bf16 v[112:115], a[192:195], a[8:11], v[112:115]
    buffer_load_dwordx4 v22, s[4:7], s27 offen offset:1024 lds
    v_mfma_f32_16x16x32_bf16 v[144:147], a[192:195], a[12:15], v[144:147]
    v_mfma_f32_16x16x32_bf16 v[176:179], a[192:195], a[16:19], v[176:179]
    v_mfma_f32_16x16x32_bf16 v[208:211], a[192:195], a[20:23], v[208:211]
    buffer_load_dwordx4 v23, s[4:7], s27 offen offset:2048 lds
    v_mfma_f32_16x16x32_bf16 v[240:243], a[192:195], a[24:27], v[240:243]
    ds_read_b64_tr_b16 a[192:193], v5
    ds_read_b64_tr_b16 a[194:195], v5 offset:1024
    v_mfma_f32_16x16x32_bf16 v[52:55], a[196:199], a[0:3], v[52:55]
    v_mfma_f32_16x16x32_bf16 v[84:87], a[196:199], a[4:7], v[84:87]
    ds_read_b128 a[224:227], v9 offset:8192
    v_mfma_f32_16x16x32_bf16 v[116:119], a[196:199], a[8:11], v[116:119]
    s_add_u32 s27, s27, 128
    s_add_u32 m0, s31, 24576
    v_mfma_f32_16x16x32_bf16 v[148:151], a[196:199], a[12:15], v[148:151]
    buffer_load_dwordx4 v24, s[8:11], s28 offen lds
    v_mfma_f32_16x16x32_bf16 v[180:183], a[196:199], a[16:19], v[180:183]
    v_mfma_f32_16x16x32_bf16 v[212:215], a[196:199], a[20:23], v[212:215]
    v_mfma_f32_16x16x32_bf16 v[244:247], a[196:199], a[24:27], v[244:247]
    ds_read_b64_tr_b16 a[196:197], v6
    ds_read_b64_tr_b16 a[198:199], v6 offset:1024
    v_mfma_f32_16x16x32_bf16 v[56:59], a[200:203], a[0:3], v[56:59]
    buffer_load_dwordx4 v25, s[8:11], s28 offen offset:1024 lds
    v_mfma_f32_16x16x32_bf16 v[88:91], a[200:203], a[4:7], v[88:91]
    ds_read_b128 a[228:231], v9 offset:10240
    v_mfma_f32_16x16x32_bf16 v[120:123], a[200:203], a[8:11], v[120:123]
    v_mfma_f32_16x16x32_bf16 v[152:155], a[200:203], a[12:15], v[152:155]
    v_mfma_f32_16x16x32_bf16 v[184:187], a[200:203], a[16:19], v[184:187]
    buffer_load_dwordx4 v26, s[8:11], s28 offen offset:2048 lds
    v_mfma_f32_16x16x32_bf16 v[216:219], a[200:203], a[20:23], v[216:219]
    v_mfma_f32_16x16x32_bf16 v[248:251], a[200:203], a[24:27], v[248:251]
    ds_read_b64_tr_b16 a[200:201], v7
    ds_read_b64_tr_b16 a[202:203], v7 offset:1024
    v_mfma_f32_16x16x32_bf16 v[60:63], a[204:207], a[0:3], v[60:63]
    v_mfma_f32_16x16x32_bf16 v[92:95], a[204:207], a[4:7], v[92:95]
    ds_read_b128 a[232:235], v9 offset:12288
    v_mfma_f32_16x16x32_bf16 v[124:127], a[204:207], a[8:11], v[124:127]
    buffer_load_dwordx4 v27, s[8:11], s28 offen offset:3072 lds
    v_mfma_f32_16x16x32_bf16 v[156:159], a[204:207], a[12:15], v[156:159]
    s_add_u32 s28, s28, 262144
    v_mfma_f32_16x16x32_bf16 v[188:191], a[204:207], a[16:19], v[188:191]
    v_mfma_f32_16x16x32_bf16 v[220:223], a[204:207], a[20:23], v[220:223]
    v_mfma_f32_16x16x32_bf16 v[252:255], a[204:207], a[24:27], v[252:255]
    ds_read_b64_tr_b16 a[204:205], v8
    ds_read_b64_tr_b16 a[206:207], v8 offset:1024
    s_cmp_eq_u32 s34, 3
    s_cselect_b32 s70, 0, s70
    s_cselect_b32 s76, 1024, s76
    s_cselect_b32 s71, 1024, s71
    s_sub_u32 s34, s34, 1
    s_cmp_lg_u32 s34, 0
    s_cbranch_scc1 L_qp
    s_add_u32 s64, s58, 0
    s_addc_u32 s65, s59, 0
    s_mov_b32 s66, 256
    s_mov_b32 s67, 0x20000
    s_mov_b32 s29, 8192
    buffer_load_dword v16, v15, s[64:67], 0 offen sc1
    s_waitcnt lgkmcnt(15)
    v_mfma_f32_16x16x32_bf16 v[32:35], a[176:179], a[208:211], v[32:35]
    v_mfma_f32_16x16x32_bf16 v[64:67], a[176:179], a[212:215], v[64:67]
    s_waitcnt lgkmcnt(14)
    v_mfma_f32_16x16x32_bf16 v[96:99], a[176:179], a[216:219], v[96:99]
    s_waitcnt lgkmcnt(11)
    v_mfma_f32_16x16x32_bf16 v[128:131], a[176:179], a[220:223], v[128:131]
    s_waitcnt lgkmcnt(8)
    v_mfma_f32_16x16x32_bf16 v[160:163], a[176:179], a[224:227], v[160:163]
    s_waitcnt lgkmcnt(5)
    v_mfma_f32_16x16x32_bf16 v[192:195], a[176:179], a[228:231], v[192:195]
    s_waitcnt vmcnt(18)
    s_waitcnt lgkmcnt(0)
    v_mfma_f32_16x16x32_bf16 v[224:227], a[176:179], a[232:235], v[224:227]
    s_barrier
    ds_read_b64_tr_b16 a[176:177], v1 offset:8192
    ds_read_b64_tr_b16 a[178:179], v1 offset:9216
    v_mfma_f32_16x16x32_bf16 v[36:39], a[180:183], a[208:211], v[36:39]
    v_mfma_f32_16x16x32_bf16 v[68:71], a[180:183], a[212:215], v[68:71]
    ds_read_b128 a[0:3], v10
    v_mfma_f32_16x16x32_bf16 v[100:103], a[180:183], a[216:219], v[100:103]
    v_mfma_f32_16x16x32_bf16 v[132:135], a[180:183], a[220:223], v[132:135]
    v_mfma_f32_16x16x32_bf16 v[164:167], a[180:183], a[224:227], v[164:167]
    v_mfma_f32_16x16x32_bf16 v[196:199], a[180:183], a[228:231], v[196:199]
    v_mfma_f32_16x16x32_bf16 v[228:231], a[180:183], a[232:235], v[228:231]
    ds_read_b64_tr_b16 a[180:181], v2 offset:8192
    ds_read_b64_tr_b16 a[182:183], v2 offset:9216
    v_mfma_f32_16x16x32_bf16 v[40:43], a[184:187], a[208:211], v[40:43]
    v_mfma_f32_16x16x32_bf16 v[72:75], a[184:187], a[212:215], v[72:75]
    ds_read_b128 a[4:7], v10 offset:2048
    v_mfma_f32_16x16x32_bf16 v[104:107], a[184:187], a[216:219], v[104:107]
    v_mfma_f32_16x16x32_bf16 v[136:139], a[184:187], a[220:223], v[136:139]
    v_mfma_f32_16x16x32_bf16 v[168:171], a[184:187], a[224:227], v[168:171]
    v_mfma_f32_16x16x32_bf16 v[200:203], a[184:187], a[228:231], v[200:203]
    v_mfma_f32_16x16x32_bf16 v[232:235], a[184:187], a[232:235], v[232:235]
    ds_read_b64_tr_b16 a[184:185], v3 offset:8192
    ds_read_b64_tr_b16 a[186:187], v3 offset:9216
    v_mfma_f32_16x16x32_bf16 v[44:47], a[188:191], a[208:211], v[44:47]
    v_mfma_f32_16x16x32_bf16 v[76:79], a[188:191], a[212:215], v[76:79]
    ds_read_b128 a[8:11], v10 offset:4096
    v_mfma_f32_16x16x32_bf16 v[108:111], a[188:191], a[216:219], v[108:111]
    v_mfma_f32_16x16x32_bf16 v[140:143], a[188:191], a[220:223], v[140:143]
    v_mfma_f32_16x16x32_bf16 v[172:175], a[188:191], a[224:227], v[172:175]
    v_mfma_f32_16x16x32_bf16 v[204:207], a[188:191], a[228:231], v[204:207]
    v_mfma_f32_16x16x32_bf16 v[236:239], a[188:191], a[232:235], v[236:239]
    ds_read_b64_tr_b16 a[188:189], v4 offset:8192
    ds_read_b64_tr_b16 a[190:191], v4 offset:9216
    v_mfma_f32_16x16x32_bf16 v[48:51], a[192:195], a[208:211], v[48:51]
    v_mfma_f32_16x16x32_bf16 v[80:83], a[192:195], a[212:215], v[80:83]
    ds_read_b128 a[12:15], v10 offset:6144
    v_mfma_f32_16x16x32_bf16 v[112:115], a[192:195], a[216:219], v[112:115]
    v_mfma_f32_16x16x32_bf16 v[144:147], a[192:195], a[220:223], v[144:147]
    v_mfma_f32_16x16x32_bf16 v[176:179], a[192:195], a[224:227], v[176:179]
    v_mfma_f32_16x16x32_bf16 v[208:211], a[192:195], a[228:231], v[208:211]
    v_mfma_f32_16x16x32_bf16 v[240:243], a[192:195], a[232:235], v[240:243]
    ds_read_b64_tr_b16 a[192:193], v5 offset:8192
    ds_read_b64_tr_b16 a[194:195], v5 offset:9216
    v_mfma_f32_16x16x32_bf16 v[52:55], a[196:199], a[208:211], v[52:55]
    v_mfma_f32_16x16x32_bf16 v[84:87], a[196:199], a[212:215], v[84:87]
    ds_read_b128 a[16:19], v10 offset:8192
    v_mfma_f32_16x16x32_bf16 v[116:119], a[196:199], a[216:219], v[116:119]
    v_mfma_f32_16x16x32_bf16 v[148:151], a[196:199], a[220:223], v[148:151]
    v_mfma_f32_16x16x32_bf16 v[180:183], a[196:199], a[224:227], v[180:183]
    v_mfma_f32_16x16x32_bf16 v[212:215], a[196:199], a[228:231], v[212:215]
    v_mfma_f32_16x16x32_bf16 v[244:247], a[196:199], a[232:235], v[244:247]
    ds_read_b64_tr_b16 a[196:197], v6 offset:8192
    ds_read_b64_tr_b16 a[198:199], v6 offset:9216
    v_mfma_f32_16x16x32_bf16 v[56:59], a[200:203], a[208:211], v[56:59]
    v_mfma_f32_16x16x32_bf16 v[88:91], a[200:203], a[212:215], v[88:91]
    ds_read_b128 a[20:23], v10 offset:10240
    v_mfma_f32_16x16x32_bf16 v[120:123], a[200:203], a[216:219], v[120:123]
    v_mfma_f32_16x16x32_bf16 v[152:155], a[200:203], a[220:223], v[152:155]
    v_mfma_f32_16x16x32_bf16 v[184:187], a[200:203], a[224:227], v[184:187]
    v_mfma_f32_16x16x32_bf16 v[216:219], a[200:203], a[228:231], v[216:219]
    v_mfma_f32_16x16x32_bf16 v[248:251], a[200:203], a[232:235], v[248:251]
    ds_read_b64_tr_b16 a[200:201], v7 offset:8192
    ds_read_b64_tr_b16 a[202:203], v7 offset:9216
    v_mfma_f32_16x16x32_bf16 v[60:63], a[204:207], a[208:211], v[60:63]
    v_mfma_f32_16x16x32_bf16 v[92:95], a[204:207], a[212:215], v[92:95]
    ds_read_b128 a[24:27], v10 offset:12288
    v_mfma_f32_16x16x32_bf16 v[124:127], a[204:207], a[216:219], v[124:127]
    v_mfma_f32_16x16x32_bf16 v[156:159], a[204:207], a[220:223], v[156:159]
    v_mfma_f32_16x16x32_bf16 v[188:191], a[204:207], a[224:227], v[188:191]
    v_mfma_f32_16x16x32_bf16 v[220:223], a[204:207], a[228:231], v[220:223]
    v_mfma_f32_16x16x32_bf16 v[252:255], a[204:207], a[232:235], v[252:255]
    ds_read_b64_tr_b16 a[204:205], v8 offset:8192
    ds_read_b64_tr_b16 a[206:207], v8 offset:9216
    s_waitcnt vmcnt(0)
    v_readfirstlane_b32 s71, v16
    s_mov_b32 s34, 0x200000
    s_nop 0
    s_cmp_lg_u32 s71, 0
    s_cbranch_scc1 L_tag
L_tagspin:
    s_sleep 4
    buffer_load_dword v16, v15, s[64:67], 0 offen sc1
    s_waitcnt vmcnt(0) lgkmcnt(0)
    v_readfirstlane_b32 s71, v16
    s_sub_u32 s34, s34, 1
    s_cmp_eq_u32 s34, 0
    s_cbranch_scc1 L_tag
    s_cmp_eq_u32 s71, 0
    s_cbranch_scc1 L_tagspin
L_tag:
    s_add_u32 s76, s79, 1
    s_lshl_b32 s76, s76, 24
    s_add_u32 s76, s76, s71
    s_lshl_b32 s78, s78, 7
    s_add_u32 s78, s78, 4096
    v_mov_b32 v16, s76
    s_cmp_lg_u32 s24, 0
    s_cbranch_scc1 L_nopub
    s_mov_b64 exec, 1
    buffer_store_dword v16, v15, s[16:19], s78 offen offset:4 sc1
    s_mov_b64 exec, -1
L_nopub:
    s_waitcnt lgkmcnt(15)
    v_mfma_f32_16x16x32_bf16 v[32:35], a[176:179], a[0:3], v[32:35]
    v_mfma_f32_16x16x32_bf16 v[64:67], a[176:179], a[4:7], v[64:67]
    s_waitcnt lgkmcnt(14)
    v_mfma_f32_16x16x32_bf16 v[96:99], a[176:179], a[8:11], v[96:99]
    s_waitcnt lgkmcnt(11)
    v_mfma_f32_16x16x32_bf16 v[128:131], a[176:179], a[12:15], v[128:131]
    s_waitcnt lgkmcnt(8)
    v_mfma_f32_16x16x32_bf16 v[160:163], a[176:179], a[16:19], v[160:163]
    s_waitcnt lgkmcnt(5)
    v_mfma_f32_16x16x32_bf16 v[192:195], a[176:179], a[20:23], v[192:195]
    s_waitcnt lgkmcnt(0)
    v_mfma_f32_16x16x32_bf16 v[224:227], a[176:179], a[24:27], v[224:227]
    s_barrier
    ds_read_b64_tr_b16 a[176:177], v1 offset:16384
    ds_read_b64_tr_b16 a[178:179], v1 offset:17408
    v_mfma_f32_16x16x32_bf16 v[36:39], a[180:183], a[0:3], v[36:39]
    v_mfma_f32_16x16x32_bf16 v[68:71], a[180:183], a[4:7], v[68:71]
    ds_read_b128 a[208:211], v9 offset:18432
    v_mfma_f32_16x16x32_bf16 v[100:103], a[180:183], a[8:11], v[100:103]
    s_and_b32 s69, s29, s63
    s_add_u32 m0, s32, s69
    ds_read_b64_tr_b16 a[28:29], v1 offset:24576
    ds_read_b64_tr_b16 a[30:31], v1 offset:25600
    v_mfma_f32_16x16x32_bf16 v[132:135], a[180:183], a[12:15], v[132:135]
    buffer_load_dwordx4 v13, s[12:15], s29 offen nt lds
    v_mfma_f32_16x16x32_bf16 v[164:167], a[180:183], a[16:19], v[164:167]
    ds_read_b128 a[236:239], v10 offset:18432
    v_mfma_f32_16x16x32_bf16 v[196:199], a[180:183], a[20:23], v[196:199]
    v_mfma_f32_16x16x32_bf16 v[228:231], a[180:183], a[24:27], v[228:231]
    s_add_u32 s29, s29, s75
    s_and_b32 s69, s29, s63
    s_add_u32 m0, s32, s69
    ds_read_b64_tr_b16 a[180:181], v2 offset:16384
    ds_read_b64_tr_b16 a[182:183], v2 offset:17408
    v_mfma_f32_16x16x32_bf16 v[40:43], a[184:187], a[0:3], v[40:43]
    buffer_load_dwordx4 v14, s[12:15], s29 offen nt lds
    v_mfma_f32_16x16x32_bf16 v[72:75], a[184:187], a[4:7], v[72:75]
    ds_read_b128 a[212:215], v9 offset:20480
    v_mfma_f32_16x16x32_bf16 v[104:107], a[184:187], a[8:11], v[104:107]
    ds_read_b64_tr_b16 a[32:33], v2 offset:24576
    ds_read_b64_tr_b16 a[34:35], v2 offset:25600
    v_mfma_f32_16x16x32_bf16 v[136:139], a[184:187], a[12:15], v[136:139]
    v_mfma_f32_16x16x32_bf16 v[168:171], a[184:187], a[16:19], v[168:171]
    s_add_u32 s29, s29, s75
    s_and_b32 s69, s29, s63
    s_add_u32 m0, s32, s69
    ds_read_b128 a[240:243], v10 offset:20480
    v_mfma_f32_16x16x32_bf16 v[200:203], a[184:187], a[20:23], v[200:203]
    buffer_load_dwordx4 v13, s[12:15], s29 offen nt lds
    v_mfma_f32_16x16x32_bf16 v[232:235], a[184:187], a[24:27], v[232:235]
    ds_read_b64_tr_b16 a[184:185], v3 offset:16384
    ds_read_b64_tr_b16 a[186:187], v3 offset:17408
    v_mfma_f32_16x16x32_bf16 v[44:47], a[188:191], a[0:3], v[44:47]
    v_mfma_f32_16x16x32_bf16 v[76:79], a[188:191], a[4:7], v[76:79]
    ds_read_b128 a[216:219], v9 offset:22528
    v_mfma_f32_16x16x32_bf16 v[108:111], a[188:191], a[8:11], v[108:111]
    ds_read_b64_tr_b16 a[36:37], v3 offset:24576
    ds_read_b64_tr_b16 a[38:39], v3 offset:25600
    v_mfma_f32_16x16x32_bf16 v[140:143], a[188:191], a[12:15], v[140:143]
    v_mfma_f32_16x16x32_bf16 v[172:175], a[188:191], a[16:19], v[172:175]
    s_add_u32 s29, s29, s75
    s_and_b32 s69, s29, s63
    s_add_u32 m0, s32, s69
    ds_read_b128 a[244:247], v10 offset:22528
    v_mfma_f32_16x16x32_bf16 v[204:207], a[188:191], a[20:23], v[204:207]
    buffer_load_dwordx4 v14, s[12:15], s29 offen nt lds
    v_mfma_f32_16x16x32_bf16 v[236:239], a[188:191], a[24:27], v[236:239]
    ds_read_b64_tr_b16 a[188:189], v4 offset:16384
    ds_read_b64_tr_b16 a[190:191], v4 offset:17408
    v_mfma_f32_16x16x32_bf16 v[48:51], a[192:195], a[0:3], v[48:51]
    v_mfma_f32_16x16x32_bf16 v[80:83], a[192:195], a[4:7], v[80:83]
    ds_read_b128 a[220:223], v9 offset:24576
    v_mfma_f32_16x16x32_bf16 v[112:115], a[192:195], a[8:11], v[112:115]
    s_add_u32 s29, s29, s75
    s_and_b32 s69, s29, s63
    s_add_u32 m0, s32, s69
    ds_read_b64_tr_b16 a[40:41], v4 offset:24576
    ds_read_b64_tr_b16 a[42:43], v4 offset:25600
    v_mfma_f32_16x16x32_bf16 v[144:147], a[192:195], a[12:15], v[144:147]
    buffer_load_dwordx4 v13, s[12:15], s29 offen nt lds
    v_mfma_f32_16x16x32_bf16 v[176:179], a[192:195], a[16:19], v[176:179]
    ds_read_b128 a[248:251], v10 offset:24576
    v_mfma_f32_16x16x32_bf16 v[208:211], a[192:195], a[20:23], v[208:211]
    v_mfma_f32_16x16x32_bf16 v[240:243], a[192:195], a[24:27], v[240:243]
    s_add_u32 s29, s29, s75
    s_and_b32 s69, s29, s63
    s_add_u32 m0, s32, s69
    ds_read_b64_tr_b16 a[192:193], v5 offset:16384
    ds_read_b64_tr_b16 a[194:195], v5 offset:17408
    v_mfma_f32_16x16x32_bf16 v[52:55], a[196:199], a[0:3], v[52:55]
    buffer_load_dwordx4 v14, s[12:15], s29 offen nt lds
    v_mfma_f32_16x16x32_bf16 v[84:87], a[196:199], a[4:7], v[84:87]
    ds_read_b128 a[224:227], v9 offset:26624
    v_mfma_f32_16x16x32_bf16 v[116:119], a[196:199], a[8:11], v[116:119]
    ds_read_b64_tr_b16 a[44:45], v5 offset:24576
    ds_read_b64_tr_b16 a[46:47], v5 offset:25600
    v_mfma_f32_16x16x32_bf16 v[148:151], a[196:199], a[12:15], v[148:151]
    v_mfma_f32_16x16x32_bf16 v[180:183], a[196:199], a[16:19], v[180:183]
    ds_read_b128 a[252:255], v10 offset:26624
    v_mfma_f32_16x16x32_bf16 v[212:215], a[196:199], a[20:23], v[212:215]
    v_mfma_f32_16x16x32_bf16 v[244:247], a[196:199], a[24:27], v[244:247]
    s_add_u32 s29, s29, s75
    s_and_b32 s69, s29, s63
    s_add_u32 m0, s32, s69
    ds_read_b64_tr_b16 a[196:197], v6 offset:16384
    ds_read_b64_tr_b16 a[198:199], v6 offset:17408
    v_mfma_f32_16x16x32_bf16 v[56:59], a[200:203], a[0:3], v[56:59]
    buffer_load_dwordx4 v13, s[12:15], s29 offen nt lds
    v_mfma_f32_16x16x32_bf16 v[88:91], a[200:203], a[4:7], v[88:91]
    ds_read_b128 a[228:231], v9 offset:28672
    v_mfma_f32_16x16x32_bf16 v[120:123], a[200:203], a[8:11], v[120:123]
    ds_read_b64_tr_b16 a[48:49], v6 offset:24576
    ds_read_b64_tr_b16 a[50:51], v6 offset:25600
    v_mfma_f32_16x16x32_bf16 v[152:155], a[200:203], a[12:15], v[152:155]
    v_mfma_f32_16x16x32_bf16 v[184:187], a[200:203], a[16:19], v[184:187]
    s_add_u32 s29, s29, s75
    s_and_b32 s69, s29, s63
    s_add_u32 m0, s32, s69
    ds_read_b128 a[60:63], v10 offset:28672
    v_mfma_f32_16x16x32_bf16 v[216:219], a[200:203], a[20:23], v[216:219]
    buffer_load_dwordx4 v14, s[12:15], s29 offen nt lds
    v_mfma_f32_16x16x32_bf16 v[248:251], a[200:203], a[24:27], v[248:251]
    s_add_u32 s29, s29, s75
    ds_read_b64_tr_b16 a[200:201], v7 offset:16384
    ds_read_b64_tr_b16 a[202:203], v7 offset:17408
    v_mfma_f32_16x16x32_bf16 v[60:63], a[204:207], a[0:3], v[60:63]
    v_mfma_f32_16x16x32_bf16 v[92:95], a[204:207], a[4:7], v[92:95]
    ds_read_b128 a[232:235], v9 offset:30720
    v_mfma_f32_16x16x32_bf16 v[124:127], a[204:207], a[8:11], v[124:127]
    ds_read_b64_tr_b16 a[52:53], v7 offset:24576
    ds_read_b64_tr_b16 a[54:55], v7 offset:25600
    v_mfma_f32_16x16x32_bf16 v[156:159], a[204:207], a[12:15], v[156:159]
    ds_read_b128 a[160:163], v10 offset:30720
    v_mfma_f32_16x16x32_bf16 v[188:191], a[204:207], a[16:19], v[188:191]
    ds_read_b64_tr_b16 a[56:57], v8 offset:24576
    ds_read_b64_tr_b16 a[58:59], v8 offset:25600
    v_mfma_f32_16x16x32_bf16 v[220:223], a[204:207], a[20:23], v[220:223]
    v_mfma_f32_16x16x32_bf16 v[252:255], a[204:207], a[24:27], v[252:255]
    s_waitcnt lgkmcnt(15)
    ds_read_b64_tr_b16 a[204:205], v8 offset:16384
    ds_read_b64_tr_b16 a[206:207], v8 offset:17408
    v_mfma_f32_16x16x32_bf16 v[32:35], a[176:179], a[208:211], v[32:35]
    v_mfma_f32_16x16x32_bf16 v[32:35], a[28:31], a[236:239], v[32:35]
    s_add_u32 s4, s44, 0
    s_addc_u32 s5, s45, 0
    v_xor_b32 v1, 0, v28
    v_add_u32 v1, v29, v1
    v_xor_b32 v2, 64, v28
    v_add_u32 v2, v29, v2
    v_xor_b32 v3, 128, v28
    v_mfma_f32_16x16x32_bf16 v[36:39], a[180:183], a[208:211], v[36:39]
    s_mov_b32 s6, 8388608
    s_mov_b32 s7, 0x20000
    v_add_u32 v3, v29, v3
    v_xor_b32 v4, 192, v28
    v_add_u32 v4, v29, v4
    v_lshrrev_b32 v28, 4, v0
    v_and_b32 v28, 1, v28
    v_mfma_f32_16x16x32_bf16 v[36:39], a[32:35], a[236:239], v[36:39]
    v_bfe_u32 v29, v0, 2, 2
    v_lshl_add_u32 v28, v28, 2, v29
    v_lshlrev_b32 v28, 5, v28
    v_xor_b32 v5, 0, v28
    v_add_u32 v5, v31, v5
    v_mfma_f32_16x16x32_bf16 v[40:43], a[184:187], a[208:211], v[40:43]
    v_xor_b32 v6, 32, v28
    v_add_u32 v6, v31, v6
    v_xor_b32 v7, 64, v28
    v_add_u32 v7, v31, v7
    v_xor_b32 v8, 96, v28
    v_mfma_f32_16x16x32_bf16 v[40:43], a[36:39], a[236:239], v[40:43]
    s_waitcnt lgkmcnt(0)
    v_add_u32 v8, v31, v8
    v_xor_b32 v9, 128, v28
    v_add_u32 v9, v31, v9
    v_xor_b32 v10, 160, v28
    v_add_u32 v10, v31, v10
    v_mfma_f32_16x16x32_bf16 v[44:47], a[188:191], a[208:211], v[44:47]
    s_barrier
    v_xor_b32 v11, 192, v28
    v_add_u32 v11, v31, v11
    v_xor_b32 v12, 224, v28
    v_add_u32 v12, v31, v12
    v_mov_b32 v17, 0
    v_mfma_f32_16x16x32_bf16 v[44:47], a[40:43], a[236:239], v[44:47]
    v_mov_b32 v18, 0
    v_mov_b32 v19, 0
    v_mov_b32 v20, 0
    v_mov_b32 v21, 0
    v_mov_b32 v22, 0
    v_mfma_f32_16x16x32_bf16 v[48:51], a[192:195], a[208:211], v[48:51]
    s_and_b32 s69, s29, s63
    s_add_u32 m0, s32, s69
    v_mov_b32 v23, 0
    v_mul_f32 v32, s62, v32
    v_mul_f32 v33, s62, v33
    v_mul_f32 v34, s62, v34
    v_mul_f32 v35, s62, v35
    v_mfma_f32_16x16x32_bf16 v[48:51], a[44:47], a[236:239], v[48:51]
    buffer_load_dwordx4 v13, s[12:15], s29 offen nt lds
    v_mul_f32 v36, s62, v36
    v_mul_f32 v37, s62, v37
    v_mul_f32 v38, s62, v38
    v_mfma_f32_16x16x32_bf16 v[52:55], a[196:199], a[208:211], v[52:55]
    v_mul_f32 v39, s62, v39
    v_mul_f32 v40, s62, v40
    v_mul_f32 v41, s62, v41
    v_mul_f32 v42, s62, v42
    v_mul_f32 v43, s62, v43
    v_mfma_f32_16x16x32_bf16 v[52:55], a[48:51], a[236:239], v[52:55]
    v_mul_f32 v44, s62, v44
    v_mul_f32 v45, s62, v45
    v_mul_f32 v46, s62, v46
    v_mul_f32 v47, s62, v47
    v_cvt_pk_bf16_f32 v32, v32, v33
    v_mfma_f32_16x16x32_bf16 v[56:59], a[200:203], a[208:211], v[56:59]
    v_cvt_pk_bf16_f32 v33, v34, v35
    v_cvt_pk_bf16_f32 v36, v36, v37
    v_cvt_pk_bf16_f32 v37, v38, v39
    v_mfma_f32_16x16x32_bf16 v[56:59], a[52:55], a[236:239], v[56:59]
    s_add_u32 s29, s29, s75
    s_and_b32 s69, s29, s63
    s_add_u32 m0, s32, s69
    v_mul_f32 v48, s62, v48
    v_mul_f32 v49, s62, v49
    v_mul_f32 v50, s62, v50
    v_mul_f32 v51, s62, v51
    v_mul_f32 v52, s62, v52
    v_mfma_f32_16x16x32_bf16 v[60:63], a[204:207], a[208:211], v[60:63]
    buffer_load_dwordx4 v14, s[12:15], s29 offen nt lds
    v_mul_f32 v53, s62, v53
    v_mul_f32 v54, s62, v54
    v_mul_f32 v55, s62, v55
    v_mfma_f32_16x16x32_bf16 v[60:63], a[56:59], a[236:239], v[60:63]
    v_cvt_pk_bf16_f32 v40, v40, v41
    v_cvt_pk_bf16_f32 v41, v42, v43
    v_cvt_pk_bf16_f32 v44, v44, v45
    v_cvt_pk_bf16_f32 v45, v46, v47
    v_permlane16_swap_b32 v32, v36
    v_mfma_f32_16x16x32_bf16 v[64:67], a[176:179], a[212:215], v[64:67]
    v_permlane16_swap_b32 v33, v37
    v_mfma_f32_16x16x32_bf16 v[64:67], a[28:31], a[240:243], v[64:67]
    v_mul_f32 v56, s62, v56
    v_mul_f32 v57, s62, v57
    v_mul_f32 v58, s62, v58
    v_mul_f32 v59, s62, v59
    v_mul_f32 v60, s62, v60
    v_mfma_f32_16x16x32_bf16 v[68:71], a[180:183], a[212:215], v[68:71]
    s_add_u32 s29, s29, s75
    s_and_b32 s69, s29, s63
    s_add_u32 m0, s32, s69
    v_mul_f32 v61, s62, v61
    v_mul_f32 v62, s62, v62
    v_mul_f32 v63, s62, v63
    v_cvt_pk_bf16_f32 v48, v48, v49
    v_cvt_pk_bf16_f32 v49, v50, v51
    v_mfma_f32_16x16x32_bf16 v[68:71], a[32:35], a[240:243], v[68:71]
    buffer_load_dwordx4 v13, s[12:15], s29 offen nt lds
    v_cvt_pk_bf16_f32 v52, v52, v53
    v_cvt_pk_bf16_f32 v53, v54, v55
    v_permlane16_swap_b32 v40, v44
    v_mfma_f32_16x16x32_bf16 v[72:75], a[184:187], a[212:215], v[72:75]
    v_permlane16_swap_b32 v41, v45
    v_accvgpr_write_b32 a64, v32
    v_accvgpr_write_b32 a65, v33
    v_accvgpr_write_b32 a66, v36
    v_accvgpr_write_b32 a67, v37
    v_mfma_f32_16x16x32_bf16 v[72:75], a[36:39], a[240:243], v[72:75]
    v_cvt_pk_bf16_f32 v56, v56, v57
    v_cvt_pk_bf16_f32 v57, v58, v59
    v_cvt_pk_bf16_f32 v60, v60, v61
    v_cvt_pk_bf16_f32 v61, v62, v63
    v_permlane16_swap_b32 v48, v52
    v_mfma_f32_16x16x32_bf16 v[76:79], a[188:191], a[212:215], v[76:79]
    v_permlane16_swap_b32 v49, v53
    v_accvgpr_write_b32 a68, v40
    v_accvgpr_write_b32 a69, v41
    v_accvgpr_write_b32 a70, v44
    v_accvgpr_write_b32 a71, v45
    v_mfma_f32_16x16x32_bf16 v[76:79], a[40:43], a[240:243], v[76:79]
    s_add_u32 s29, s29, s75
    s_and_b32 s69, s29, s63
    s_add_u32 m0, s32, s69
    v_permlane16_swap_b32 v56, v60
    v_permlane16_swap_b32 v57, v61
    v_accvgpr_write_b32 a72, v48
    v_accvgpr_write_b32 a73, v49
    v_accvgpr_write_b32 a74, v52
    v_mfma_f32_16x16x32_bf16 v[80:83], a[192:195], a[212:215], v[80:83]
    buffer_load_dwordx4 v14, s[12:15], s29 offen nt lds
    v_accvgpr_write_b32 a75, v53
    v_accvgpr_write_b32 a76, v56
    v_accvgpr_write_b32 a77, v57
    v_mfma_f32_16x16x32_bf16 v[80:83], a[44:47], a[240:243], v[80:83]
    v_accvgpr_write_b32 a78, v60
    v_accvgpr_write_b32 a79, v61
    v_mul_f32 v64, s62, v64
    v_mul_f32 v65, s62, v65
    v_mul_f32 v66, s62, v66
    v_mfma_f32_16x16x32_bf16 v[84:87], a[196:199], a[212:215], v[84:87]
    v_mul_f32 v67, s62, v67
    v_mul_f32 v68, s62, v68
    v_mul_f32 v69, s62, v69
    v_mul_f32 v70, s62, v70
    v_mul_f32 v71, s62, v71
    v_mfma_f32_16x16x32_bf16 v[84:87], a[48:51], a[240:243], v[84:87]
    v_mul_f32 v72, s62, v72
    v_mul_f32 v73, s62, v73
    v_mul_f32 v74, s62, v74
    v_mul_f32 v75, s62, v75
    v_mul_f32 v76, s62, v76
    v_mfma_f32_16x16x32_bf16 v[88:91], a[200:203], a[212:215], v[88:91]
    s_add_u32 s29, s29, s75
    s_and_b32 s69, s29, s63
    s_add_u32 m0, s32, s69
    v_mul_f32 v77, s62, v77
    v_mul_f32 v78, s62, v78
    v_mul_f32 v79, s62, v79
    v_cvt_pk_bf16_f32 v64, v64, v65
    v_cvt_pk_bf16_f32 v65, v66, v67
    v_mfma_f32_16x16x32_bf16 v[88:91], a[52:55], a[240:243], v[88:91]
    buffer_load_dwordx4 v13, s[12:15], s29 offen nt lds
    v_cvt_pk_bf16_f32 v68, v68, v69
    v_cvt_pk_bf16_f32 v69, v70, v71
    v_mul_f32 v80, s62, v80
    v_mfma_f32_16x16x32_bf16 v[92:95], a[204:207], a[212:215], v[92:95]
    v_mul_f32 v81, s62, v81
    v_mul_f32 v82, s62, v82
    v_mul_f32 v83, s62, v83
    v_mul_f32 v84, s62, v84
    v_mul_f32 v85, s62, v85
    v_mfma_f32_16x16x32_bf16 v[92:95], a[56:59], a[240:243], v[92:95]
    v_mul_f32 v86, s62, v86
    v_mul_f32 v87, s62, v87
    v_cvt_pk_bf16_f32 v72, v72, v73
    v_cvt_pk_bf16_f32 v73, v74, v75
    v_cvt_pk_bf16_f32 v76, v76, v77
    v_mfma_f32_16x16x32_bf16 v[96:99], a[176:179], a[216:219], v[96:99]
    v_cvt_pk_bf16_f32 v77, v78, v79
    v_permlane16_swap_b32 v64, v68
    v_permlane16_swap_b32 v65, v69
    v_mfma_f32_16x16x32_bf16 v[96:99], a[28:31], a[244:247], v[96:99]
    s_add_u32 s29, s29, s75
    s_and_b32 s69, s29, s63
    s_add_u32 m0, s32, s69
    v_mul_f32 v88, s62, v88
    v_mul_f32 v89, s62, v89
    v_mul_f32 v90, s62, v90
    v_mul_f32 v91, s62, v91
    v_mul_f32 v92, s62, v92
    v_mfma_f32_16x16x32_bf16 v[100:103], a[180:183], a[216:219], v[100:103]
    buffer_load_dwordx4 v14, s[12:15], s29 offen nt lds
    v_mul_f32 v93, s62, v93
    v_mul_f32 v94, s62, v94
    v_mul_f32 v95, s62, v95
    v_mfma_f32_16x16x32_bf16 v[100:103], a[32:35], a[244:247], v[100:103]
    v_cvt_pk_bf16_f32 v80, v80, v81
    v_cvt_pk_bf16_f32 v81, v82, v83
    v_cvt_pk_bf16_f32 v84, v84, v85
    v_cvt_pk_bf16_f32 v85, v86, v87
    v_permlane16_swap_b32 v72, v76
    v_mfma_f32_16x16x32_bf16 v[104:107], a[184:187], a[216:219], v[104:107]
    v_permlane16_swap_b32 v73, v77
    v_accvgpr_write_b32 a80, v64
    v_accvgpr_write_b32 a81, v65
    v_accvgpr_write_b32 a82, v68
    v_accvgpr_write_b32 a83, v69
    v_mfma_f32_16x16x32_bf16 v[104:107], a[36:39], a[244:247], v[104:107]
    v_cvt_pk_bf16_f32 v88, v88, v89
    v_cvt_pk_bf16_f32 v89, v90, v91
    v_cvt_pk_bf16_f32 v92, v92, v93
    v_cvt_pk_bf16_f32 v93, v94, v95
    v_permlane16_swap_b32 v80, v84
    v_mfma_f32_16x16x32_bf16 v[108:111], a[188:191], a[216:219], v[108:111]
    v_permlane16_swap_b32 v81, v85
    v_accvgpr_write_b32 a84, v72
    v_accvgpr_write_b32 a85, v73
    v_accvgpr_write_b32 a86, v76
    v_accvgpr_write_b32 a87, v77
    v_mfma_f32_16x16x32_bf16 v[108:111], a[40:43], a[244:247], v[108:111]
    s_add_u32 s29, s29, s75
    s_and_b32 s69, s29, s63
    s_add_u32 m0, s32, s69
    v_permlane16_swap_b32 v88, v92
    v_permlane16_swap_b32 v89, v93
    v_accvgpr_write_b32 a88, v80
    v_accvgpr_write_b32 a89, v81
    v_accvgpr_write_b32 a90, v84
    v_mfma_f32_16x16x32_bf16 v[112:115], a[192:195], a[216:219], v[112:115]
    buffer_load_dwordx4 v13, s[12:15], s29 offen nt lds
    v_accvgpr_write_b32 a91, v85
    v_accvgpr_write_b32 a92, v88
    v_accvgpr_write_b32 a93, v89
    v_mfma_f32_16x16x32_bf16 v[112:115], a[44:47], a[244:247], v[112:115]
    v_accvgpr_write_b32 a94, v92
    v_accvgpr_write_b32 a95, v93
    v_mov_b64 v[48:49], 0
    v_mov_b64 v[50:51], 0
    v_mov_b64 v[52:53], 0
    v_mfma_f32_16x16x32_bf16 v[116:119], a[196:199], a[216:219], v[116:119]
    v_mov_b64 v[54:55], 0
    v_mov_b64 v[56:57], 0
    v_mov_b64 v[58:59], 0
    v_mov_b64 v[60:61], 0
    v_mov_b64 v[62:63], 0
    v_mfma_f32_16x16x32_bf16 v[116:119], a[48:51], a[244:247], v[116:119]
    v_mov_b64 v[64:65], 0
    v_mov_b64 v[66:67], 0
    v_mov_b64 v[68:69], 0
    v_mov_b64 v[70:71], 0
    v_mov_b64 v[72:73], 0
    v_mfma_f32_16x16x32_bf16 v[120:123], a[200:203], a[216:219], v[120:123]
    s_add_u32 s29, s29, s75
    s_and_b32 s69, s29, s63
    s_add_u32 m0, s32, s69
    v_mov_b64 v[74:75], 0
    v_and_b32 v88, 63, v0
    v_and_b32 v81, 15, v0
    v_lshlrev_b32 v88, 7, v88
    v_lshlrev_b32 v81, 7, v81
    v_mfma_f32_16x16x32_bf16 v[120:123], a[52:55], a[244:247], v[120:123]
    buffer_load_dwordx4 v14, s[12:15], s29 offen nt lds
    v_mul_f32 v96, s62, v96
    v_mul_f32 v97, s62, v97
    v_mul_f32 v98, s62, v98
    v_mfma_f32_16x16x32_bf16 v[124:127], a[204:207], a[216:219], v[124:127]
    v_mul_f32 v99, s62, v99
    v_mul_f32 v100, s62, v100
    v_mul_f32 v101, s62, v101
    v_mul_f32 v102, s62, v102
    v_mul_f32 v103, s62, v103
    v_mfma_f32_16x16x32_bf16 v[124:127], a[56:59], a[244:247], v[124:127]
    v_mul_f32 v104, s62, v104
    v_mul_f32 v105, s62, v105
    v_mul_f32 v106, s62, v106
    v_mul_f32 v107, s62, v107
    v_mul_f32 v108, s62, v108
    v_mfma_f32_16x16x32_bf16 v[128:131], a[176:179], a[220:223], v[128:131]
    v_mul_f32 v109, s62, v109
    v_mul_f32 v110, s62, v110
    v_mul_f32 v111, s62, v111
    v_cvt_pk_bf16_f32 v96, v96, v97
    v_cvt_pk_bf16_f32 v97, v98, v99
    v_mfma_f32_16x16x32_bf16 v[128:131], a[28:31], a[248:251], v[128:131]
    s_add_u32 s29, s29, s75
    s_and_b32 s69, s29, s63
    s_add_u32 m0, s32, s69
    v_cvt_pk_bf16_f32 v100, v100, v101
    v_cvt_pk_bf16_f32 v101, v102, v103
    v_mul_f32 v112, s62, v112
    v_mul_f32 v113, s62, v113
    v_mul_f32 v114, s62, v114
    v_mfma_f32_16x16x32_bf16 v[132:135], a[180:183], a[220:223], v[132:135]
    buffer_load_dwordx4 v13, s[12:15], s29 offen nt lds
    v_mul_f32 v115, s62, v115
    v_mul_f32 v116, s62, v116
    v_mul_f32 v117, s62, v117
    v_mfma_f32_16x16x32_bf16 v[132:135], a[32:35], a[248:251], v[132:135]
    v_mul_f32 v118, s62, v118
    v_mul_f32 v119, s62, v119
    v_cvt_pk_bf16_f32 v104, v104, v105
    v_cvt_pk_bf16_f32 v105, v106, v107
    v_cvt_pk_bf16_f32 v108, v108, v109
    v_mfma_f32_16x16x32_bf16 v[136:139], a[184:187], a[220:223], v[136:139]
    v_cvt_pk_bf16_f32 v109, v110, v111
    v_permlane16_swap_b32 v96, v100
    v_permlane16_swap_b32 v97, v101
    v_mul_f32 v120, s62, v120
    v_mul_f32 v121, s62, v121
    v_mfma_f32_16x16x32_bf16 v[136:139], a[36:39], a[248:251], v[136:139]
    v_mul_f32 v122, s62, v122
    v_mul_f32 v123, s62, v123
    v_mul_f32 v124, s62, v124
    v_mul_f32 v125, s62, v125
    v_mul_f32 v126, s62, v126
    v_mfma_f32_16x16x32_bf16 v[140:143], a[188:191], a[220:223], v[140:143]
    s_add_u32 s29, s29, s75
    s_and_b32 s69, s29, s63
    s_add_u32 m0, s32, s69
    v_mul_f32 v127, s62, v127
    v_cvt_pk_bf16_f32 v112, v112, v113
    v_cvt_pk_bf16_f32 v113, v114, v115
    v_cvt_pk_bf16_f32 v116, v116, v117
    v_cvt_pk_bf16_f32 v117, v118, v119
    v_mfma_f32_16x16x32_bf16 v[140:143], a[40:43], a[248:251], v[140:143]
    buffer_load_dwordx4 v14, s[12:15], s29 offen nt lds
    v_permlane16_swap_b32 v104, v108
    v_permlane16_swap_b32 v105, v109
    v_accvgpr_write_b32 a96, v96
    v_mfma_f32_16x16x32_bf16 v[144:147], a[192:195], a[220:223], v[144:147]
    v_accvgpr_write_b32 a97, v97
    v_accvgpr_write_b32 a98, v100
    v_accvgpr_write_b32 a99, v101
    v_cvt_pk_bf16_f32 v120, v120, v121
    v_cvt_pk_bf16_f32 v121, v122, v123
    v_mfma_f32_16x16x32_bf16 v[144:147], a[44:47], a[248:251], v[144:147]
    v_cvt_pk_bf16_f32 v124, v124, v125
    v_cvt_pk_bf16_f32 v125, v126, v127
    v_permlane16_swap_b32 v112, v116
    v_permlane16_swap_b32 v113, v117
    v_accvgpr_write_b32 a100, v104
    v_mfma_f32_16x16x32_bf16 v[148:151], a[196:199], a[220:223], v[148:151]
    v_accvgpr_write_b32 a101, v105
    v_accvgpr_write_b32 a102, v108
    v_accvgpr_write_b32 a103, v109
    v_permlane16_swap_b32 v120, v124
    v_permlane16_swap_b32 v121, v125
    v_mfma_f32_16x16x32_bf16 v[148:151], a[48:51], a[248:251], v[148:151]
    s_add_u32 s29, s29, s75
    s_and_b32 s69, s29, s63
    s_add_u32 m0, s32, s69
    v_accvgpr_write_b32 a104, v112
    v_accvgpr_write_b32 a105, v113
    v_accvgpr_write_b32 a106, v116
    v_accvgpr_write_b32 a107, v117
    v_accvgpr_write_b32 a108, v120
    v_mfma_f32_16x16x32_bf16 v[152:155], a[200:203], a[220:223], v[152:155]
    buffer_load_dwordx4 v13, s[12:15], s29 offen nt lds
    v_accvgpr_write_b32 a109, v121
    v_accvgpr_write_b32 a110, v124
    v_accvgpr_write_b32 a111, v125
    v_mfma_f32_16x16x32_bf16 v[152:155], a[52:55], a[248:251], v[152:155]
    v_mul_f32 v128, s62, v128
    v_mul_f32 v129, s62, v129
    v_mul_f32 v130, s62, v130
    v_mul_f32 v131, s62, v131
    v_mul_f32 v132, s62, v132
    v_mfma_f32_16x16x32_bf16 v[156:159], a[204:207], a[220:223], v[156:159]
    v_mul_f32 v133, s62, v133
    v_mul_f32 v134, s62, v134
    v_mul_f32 v135, s62, v135
    v_mul_f32 v136, s62, v136
    v_mul_f32 v137, s62, v137
    v_mfma_f32_16x16x32_bf16 v[156:159], a[56:59], a[248:251], v[156:159]
    v_mul_f32 v138, s62, v138
    v_mul_f32 v139, s62, v139
    v_mul_f32 v140, s62, v140
    v_mul_f32 v141, s62, v141
    v_mul_f32 v142, s62, v142
    v_mfma_f32_16x16x32_bf16 v[160:163], a[176:179], a[224:227], v[160:163]
    v_mul_f32 v143, s62, v143
    v_cvt_pk_bf16_f32 v128, v128, v129
    v_cvt_pk_bf16_f32 v129, v130, v131
    v_cvt_pk_bf16_f32 v132, v132, v133
    v_cvt_pk_bf16_f32 v133, v134, v135
    v_mfma_f32_16x16x32_bf16 v[160:163], a[28:31], a[252:255], v[160:163]
    s_add_u32 s29, s29, s75
    s_and_b32 s69, s29, s63
    s_add_u32 m0, s32, s69
    v_mul_f32 v144, s62, v144
    v_mul_f32 v145, s62, v145
    v_mul_f32 v146, s62, v146
    v_mul_f32 v147, s62, v147
    v_mul_f32 v148, s62, v148
    v_mfma_f32_16x16x32_bf16 v[164:167], a[180:183], a[224:227], v[164:167]
    buffer_load_dwordx4 v14, s[12:15], s29 offen nt lds
    v_mul_f32 v149, s62, v149
    v_mul_f32 v150, s62, v150
    v_mul_f32 v151, s62, v151
    v_mfma_f32_16x16x32_bf16 v[164:167], a[32:35], a[252:255], v[164:167]
    v_cvt_pk_bf16_f32 v136, v136, v137
    v_cvt_pk_bf16_f32 v137, v138, v139
    v_cvt_pk_bf16_f32 v140, v140, v141
    v_cvt_pk_bf16_f32 v141, v142, v143
    v_permlane16_swap_b32 v128, v132
    v_mfma_f32_16x16x32_bf16 v[168:171], a[184:187], a[224:227], v[168:171]
    v_permlane16_swap_b32 v129, v133
    v_mul_f32 v152, s62, v152
    v_mul_f32 v153, s62, v153
    v_mul_f32 v154, s62, v154
    v_mul_f32 v155, s62, v155
    v_mfma_f32_16x16x32_bf16 v[168:171], a[36:39], a[252:255], v[168:171]
    v_mul_f32 v156, s62, v156
    v_mul_f32 v157, s62, v157
    v_mul_f32 v158, s62, v158
    v_mul_f32 v159, s62, v159
    v_cvt_pk_bf16_f32 v144, v144, v145
    v_mfma_f32_16x16x32_bf16 v[172:175], a[188:191], a[224:227], v[172:175]
    s_add_u32 s29, s29, s75
    s_and_b32 s69, s29, s63
    s_add_u32 m0, s32, s69
    v_cvt_pk_bf16_f32 v145, v146, v147
    v_cvt_pk_bf16_f32 v148, v148, v149
    v_cvt_pk_bf16_f32 v149, v150, v151
    v_permlane16_swap_b32 v136, v140
    v_permlane16_swap_b32 v137, v141
    v_mfma_f32_16x16x32_bf16 v[172:175], a[40:43], a[252:255], v[172:175]
    buffer_load_dwordx4 v13, s[12:15], s29 offen nt lds
    v_accvgpr_write_b32 a112, v128
    v_accvgpr_write_b32 a113, v129
    v_accvgpr_write_b32 a114, v132
    v_mfma_f32_16x16x32_bf16 v[176:179], a[192:195], a[224:227], v[176:179]
    v_accvgpr_write_b32 a115, v133
    v_cvt_pk_bf16_f32 v152, v152, v153
    v_cvt_pk_bf16_f32 v153, v154, v155
    v_cvt_pk_bf16_f32 v156, v156, v157
    v_cvt_pk_bf16_f32 v157, v158, v159
    v_mfma_f32_16x16x32_bf16 v[176:179], a[44:47], a[252:255], v[176:179]
    v_permlane16_swap_b32 v144, v148
    v_permlane16_swap_b32 v145, v149
    v_accvgpr_write_b32 a116, v136
    v_accvgpr_write_b32 a117, v137
    v_accvgpr_write_b32 a118, v140
    v_mfma_f32_16x16x32_bf16 v[180:183], a[196:199], a[224:227], v[180:183]
    v_accvgpr_write_b32 a119, v141
    v_permlane16_swap_b32 v152, v156
    v_permlane16_swap_b32 v153, v157
    v_accvgpr_write_b32 a120, v144
    v_accvgpr_write_b32 a121, v145
    v_mfma_f32_16x16x32_bf16 v[180:183], a[48:51], a[252:255], v[180:183]
    s_add_u32 s29, s29, s75
    s_and_b32 s69, s29, s63
    s_add_u32 m0, s32, s69
    v_accvgpr_write_b32 a122, v148
    v_accvgpr_write_b32 a123, v149
    v_accvgpr_write_b32 a124, v152
    v_accvgpr_write_b32 a125, v153
    v_accvgpr_write_b32 a126, v156
    v_mfma_f32_16x16x32_bf16 v[184:187], a[200:203], a[224:227], v[184:187]
    buffer_load_dwordx4 v14, s[12:15], s29 offen nt lds
    v_accvgpr_write_b32 a127, v157
    v_mul_f32 v160, s62, v160
    v_mul_f32 v161, s62, v161
    v_mfma_f32_16x16x32_bf16 v[184:187], a[52:55], a[252:255], v[184:187]
    v_mul_f32 v162, s62, v162
    v_mul_f32 v163, s62, v163
    v_mul_f32 v164, s62, v164
    v_mul_f32 v165, s62, v165
    v_mul_f32 v166, s62, v166
    v_mfma_f32_16x16x32_bf16 v[188:191], a[204:207], a[224:227], v[188:191]
    v_mul_f32 v167, s62, v167
    v_mul_f32 v168, s62, v168
    v_mul_f32 v169, s62, v169
    v_mul_f32 v170, s62, v170
    v_mul_f32 v171, s62, v171
    v_mfma_f32_16x16x32_bf16 v[188:191], a[56:59], a[252:255], v[188:191]
    v_mul_f32 v172, s62, v172
    v_mul_f32 v173, s62, v173
    v_mul_f32 v174, s62, v174
    v_mul_f32 v175, s62, v175
    v_cvt_pk_bf16_f32 v160, v160, v161
    v_mfma_f32_16x16x32_bf16 v[192:195], a[176:179], a[228:231], v[192:195]
    s_add_u32 s29, s29, s75
    s_and_b32 s69, s29, s63
    s_add_u32 m0, s32, s69
    v_cvt_pk_bf16_f32 v161, v162, v163
    v_cvt_pk_bf16_f32 v164, v164, v165
    v_cvt_pk_bf16_f32 v165, v166, v167
    v_mul_f32 v176, s62, v176
    v_mul_f32 v177, s62, v177
    v_mfma_f32_16x16x32_bf16 v[192:195], a[28:31], a[60:63], v[192:195]
    buffer_load_dwordx4 v13, s[12:15], s29 offen nt lds
    v_mul_f32 v178, s62, v178
    v_mul_f32 v179, s62, v179
    v_mul_f32 v180, s62, v180
    v_mfma_f32_16x16x32_bf16 v[196:199], a[180:183], a[228:231], v[196:199]
    v_mul_f32 v181, s62, v181
    v_mul_f32 v182, s62, v182
    v_mul_f32 v183, s62, v183
    v_cvt_pk_bf16_f32 v168, v168, v169
    v_cvt_pk_bf16_f32 v169, v170, v171
    v_mfma_f32_16x16x32_bf16 v[196:199], a[32:35], a[60:63], v[196:199]
    v_cvt_pk_bf16_f32 v172, v172, v173
    v_cvt_pk_bf16_f32 v173, v174, v175
    v_permlane16_swap_b32 v160, v164
    v_permlane16_swap_b32 v161, v165
    v_mul_f32 v184, s62, v184
    v_mfma_f32_16x16x32_bf16 v[200:203], a[184:187], a[228:231], v[200:203]
    v_mul_f32 v185, s62, v185
    v_mul_f32 v186, s62, v186
    v_mul_f32 v187, s62, v187
    v_mul_f32 v188, s62, v188
    v_mul_f32 v189, s62, v189
    v_mfma_f32_16x16x32_bf16 v[200:203], a[36:39], a[60:63], v[200:203]
    s_add_u32 s29, s29, s75
    s_and_b32 s69, s29, s63
    s_add_u32 m0, s32, s69
    v_mul_f32 v190, s62, v190
    v_mul_f32 v191, s62, v191
    v_cvt_pk_bf16_f32 v176, v176, v177
    v_cvt_pk_bf16_f32 v177, v178, v179
    v_cvt_pk_bf16_f32 v180, v180, v181
    v_mfma_f32_16x16x32_bf16 v[204:207], a[188:191], a[228:231], v[204:207]
    buffer_load_dwordx4 v14, s[12:15], s29 offen nt lds
    v_cvt_pk_bf16_f32 v181, v182, v183
    v_permlane16_swap_b32 v168, v172
    v_permlane16_swap_b32 v169, v173
    v_mfma_f32_16x16x32_bf16 v[204:207], a[40:43], a[60:63], v[204:207]
    s_add_u32 s29, s29, s75
    v_accvgpr_write_b32 a128, v160
    v_accvgpr_write_b32 a129, v161
    v_accvgpr_write_b32 a130, v164
    v_accvgpr_write_b32 a131, v165
    v_cvt_pk_bf16_f32 v184, v184, v185
    v_mfma_f32_16x16x32_bf16 v[208:211], a[192:195], a[228:231], v[208:211]
    v_cvt_pk_bf16_f32 v185, v186, v187
    v_cvt_pk_bf16_f32 v188, v188, v189
    v_cvt_pk_bf16_f32 v189, v190, v191
    v_permlane16_swap_b32 v176, v180
    v_permlane16_swap_b32 v177, v181
    v_mfma_f32_16x16x32_bf16 v[208:211], a[44:47], a[60:63], v[208:211]
    v_accvgpr_write_b32 a132, v168
    v_accvgpr_write_b32 a133, v169
    v_accvgpr_write_b32 a134, v172
    v_accvgpr_write_b32 a135, v173
    v_permlane16_swap_b32 v184, v188
    v_mfma_f32_16x16x32_bf16 v[212:215], a[196:199], a[228:231], v[212:215]
    v_permlane16_swap_b32 v185, v189
    v_accvgpr_write_b32 a136, v176
    v_accvgpr_write_b32 a137, v177
    v_accvgpr_write_b32 a138, v180
    v_accvgpr_write_b32 a139, v181
    v_mfma_f32_16x16x32_bf16 v[212:215], a[48:51], a[60:63], v[212:215]
    v_accvgpr_write_b32 a140, v184
    v_accvgpr_write_b32 a141, v185
    v_accvgpr_write_b32 a142, v188
    v_accvgpr_write_b32 a143, v189
    v_mul_f32 v192, s62, v192
    v_mfma_f32_16x16x32_bf16 v[216:219], a[200:203], a[228:231], v[216:219]
    v_mul_f32 v193, s62, v193
    v_mul_f32 v194, s62, v194
    v_mul_f32 v195, s62, v195
    v_mul_f32 v196, s62, v196
    v_mul_f32 v197, s62, v197
    v_mfma_f32_16x16x32_bf16 v[216:219], a[52:55], a[60:63], v[216:219]
    v_mul_f32 v198, s62, v198
    v_mul_f32 v199, s62, v199
    v_mul_f32 v200, s62, v200
    v_mul_f32 v201, s62, v201
    v_mul_f32 v202, s62, v202
    v_mfma_f32_16x16x32_bf16 v[220:223], a[204:207], a[228:231], v[220:223]
    v_mul_f32 v203, s62, v203
    v_mul_f32 v204, s62, v204
    v_mul_f32 v205, s62, v205
    v_mul_f32 v206, s62, v206
    v_mul_f32 v207, s62, v207
    v_mfma_f32_16x16x32_bf16 v[220:223], a[56:59], a[60:63], v[220:223]
    v_cvt_pk_bf16_f32 v192, v192, v193
    v_cvt_pk_bf16_f32 v193, v194, v195
    v_cvt_pk_bf16_f32 v196, v196, v197
    v_cvt_pk_bf16_f32 v197, v198, v199
    v_mul_f32 v208, s62, v208
    v_mfma_f32_16x16x32_bf16 v[224:227], a[176:179], a[232:235], v[224:227]
    v_mul_f32 v209, s62, v209
    v_mul_f32 v210, s62, v210
    v_mul_f32 v211, s62, v211
    v_mul_f32 v212, s62, v212
    v_mul_f32 v213, s62, v213
    v_mfma_f32_16x16x32_bf16 v[224:227], a[28:31], a[160:163], v[224:227]
    ds_read_b128 a[176:179], v1
    v_mul_f32 v214, s62, v214
    v_mul_f32 v215, s62, v215
    v_cvt_pk_bf16_f32 v200, v200, v201
    v_cvt_pk_bf16_f32 v201, v202, v203
    v_mfma_f32_16x16x32_bf16 v[228:231], a[180:183], a[232:235], v[228:231]
    v_cvt_pk_bf16_f32 v204, v204, v205
    v_cvt_pk_bf16_f32 v205, v206, v207
    v_permlane16_swap_b32 v192, v196
    v_permlane16_swap_b32 v193, v197
    v_mul_f32 v216, s62, v216
    v_mfma_f32_16x16x32_bf16 v[228:231], a[32:35], a[160:163], v[228:231]
    ds_read_b128 a[180:183], v2
    v_mul_f32 v217, s62, v217
    v_mul_f32 v218, s62, v218
    v_mul_f32 v219, s62, v219
    v_mul_f32 v220, s62, v220
    v_mfma_f32_16x16x32_bf16 v[232:235], a[184:187], a[232:235], v[232:235]
    v_mul_f32 v221, s62, v221
    v_mul_f32 v222, s62, v222
    v_mul_f32 v223, s62, v223
    v_cvt_pk_bf16_f32 v208, v208, v209
    v_cvt_pk_bf16_f32 v209, v210, v211
    v_mfma_f32_16x16x32_bf16 v[232:235], a[36:39], a[160:163], v[232:235]
    ds_read_b128 a[184:187], v3
    v_cvt_pk_bf16_f32 v212, v212, v213
    v_cvt_pk_bf16_f32 v213, v214, v215
    v_permlane16_swap_b32 v200, v204
    v_permlane16_swap_b32 v201, v205
    v_mfma_f32_16x16x32_bf16 v[236:239], a[188:191], a[232:235], v[236:239]
    v_accvgpr_write_b32 a144, v192
    v_accvgpr_write_b32 a145, v193
    v_accvgpr_write_b32 a146, v196
    v_accvgpr_write_b32 a147, v197
    v_cvt_pk_bf16_f32 v216, v216, v217
    v_mfma_f32_16x16x32_bf16 v[236:239], a[40:43], a[160:163], v[236:239]
    ds_read_b128 a[188:191], v4
    v_cvt_pk_bf16_f32 v217, v218, v219
    v_cvt_pk_bf16_f32 v220, v220, v221
    v_cvt_pk_bf16_f32 v221, v222, v223
    v_permlane16_swap_b32 v208, v212
    v_mfma_f32_16x16x32_bf16 v[240:243], a[192:195], a[232:235], v[240:243]
    v_permlane16_swap_b32 v209, v213
    v_accvgpr_write_b32 a148, v200
    v_accvgpr_write_b32 a149, v201
    v_accvgpr_write_b32 a150, v204
    v_accvgpr_write_b32 a151, v205
    v_mfma_f32_16x16x32_bf16 v[240:243], a[44:47], a[160:163], v[240:243]
    ds_read_b128 a[192:195], v1 offset:4096
    v_permlane16_swap_b32 v216, v220
    v_permlane16_swap_b32 v217, v221
    v_accvgpr_write_b32 a152, v208
    v_accvgpr_write_b32 a153, v209
    v_mfma_f32_16x16x32_bf16 v[244:247], a[196:199], a[232:235], v[244:247]
    v_accvgpr_write_b32 a154, v212
    v_accvgpr_write_b32 a155, v213
    v_accvgpr_write_b32 a156, v216
    v_accvgpr_write_b32 a157, v217
    v_accvgpr_write_b32 a158, v220
    v_mfma_f32_16x16x32_bf16 v[244:247], a[48:51], a[160:163], v[244:247]
    ds_read_b128 a[196:199], v2 offset:4096
    v_accvgpr_write_b32 a159, v221
    v_mul_f32 v224, s62, v224
    v_mul_f32 v225, s62, v225
    v_mul_f32 v226, s62, v226
    v_mfma_f32_16x16x32_bf16 v[248:251], a[200:203], a[232:235], v[248:251]
    v_mul_f32 v227, s62, v227
    v_mul_f32 v228, s62, v228
    v_mul_f32 v229, s62, v229
    v_mul_f32 v230, s62, v230
    v_mul_f32 v231, s62, v231
    v_mfma_f32_16x16x32_bf16 v[248:251], a[52:55], a[160:163], v[248:251]
    ds_read_b128 a[200:203], v3 offset:4096
    v_mul_f32 v232, s62, v232
    v_mul_f32 v233, s62, v233
    v_mul_f32 v234, s62, v234
    v_mul_f32 v235, s62, v235
    v_mfma_f32_16x16x32_bf16 v[252:255], a[204:207], a[232:235], v[252:255]
    v_mul_f32 v236, s62, v236
    v_mul_f32 v237, s62, v237
    v_mul_f32 v238, s62, v238
    v_mul_f32 v239, s62, v239
    v_cvt_pk_bf16_f32 v224, v224, v225
    v_mfma_f32_16x16x32_bf16 v[252:255], a[56:59], a[160:163], v[252:255]
    s_waitcnt lgkmcnt(6)
    ds_read_b128 a[204:207], v4 offset:4096
    v_cvt_pk_bf16_f32 v225, v226, v227
    v_cvt_pk_bf16_f32 v228, v228, v229
    v_cvt_pk_bf16_f32 v229, v230, v231
    v_mul_f32 v240, s62, v240
    s_mov_b32 s34, 7
    v_mfma_f32_16x16x32_bf16 v[32:35], a[176:179], a[64:67], v[48:51]
    s_waitcnt lgkmcnt(6)
    v_mul_f32 v241, s62, v241
    v_mul_f32 v242, s62, v242
    v_mul_f32 v243, s62, v243
    v_mul_f32 v244, s62, v244
    v_mul_f32 v245, s62, v245
    v_mul_f32 v246, s62, v246
    v_mul_f32 v247, s62, v247
    v_mfma_f32_16x16x32_bf16 v[32:35], a[180:183], a[68:71], v[32:35]
    s_waitcnt lgkmcnt(5)
    v_cvt_pk_bf16_f32 v232, v232, v233
    v_cvt_pk_bf16_f32 v233, v234, v235
    v_cvt_pk_bf16_f32 v236, v236, v237
    v_cvt_pk_bf16_f32 v237, v238, v239
    v_permlane16_swap_b32 v224, v228
    v_permlane16_swap_b32 v225, v229
    v_mul_f32 v248, s62, v248
    v_mfma_f32_16x16x32_bf16 v[32:35], a[184:187], a[72:75], v[32:35]
    s_waitcnt lgkmcnt(4)
    v_mul_f32 v249, s62, v249
    v_mul_f32 v250, s62, v250
    v_mul_f32 v251, s62, v251
    v_mul_f32 v252, s62, v252
    v_mul_f32 v253, s62, v253
    v_mul_f32 v254, s62, v254
    v_mul_f32 v255, s62, v255
    v_mfma_f32_16x16x32_bf16 v[32:35], a[188:191], a[76:79], v[32:35]
    s_waitcnt lgkmcnt(3)
    v_cvt_pk_bf16_f32 v240, v240, v241
    v_cvt_pk_bf16_f32 v241, v242, v243
    v_cvt_pk_bf16_f32 v244, v244, v245
    v_cvt_pk_bf16_f32 v245, v246, v247
    v_permlane16_swap_b32 v232, v236
    v_permlane16_swap_b32 v233, v237
    v_accvgpr_write_b32 a160, v224
    v_mfma_f32_16x16x32_bf16 v[36:39], a[192:195], a[64:67], v[48:51]
    s_waitcnt lgkmcnt(2)
    v_accvgpr_write_b32 a161, v225
    v_accvgpr_write_b32 a162, v228
    v_accvgpr_write_b32 a163, v229
    v_cvt_pk_bf16_f32 v248, v248, v249
    v_cvt_pk_bf16_f32 v249, v250, v251
    v_cvt_pk_bf16_f32 v252, v252, v253
    v_cvt_pk_bf16_f32 v253, v254, v255
    v_mfma_f32_16x16x32_bf16 v[36:39], a[196:199], a[68:71], v[36:39]
    s_waitcnt lgkmcnt(1)
    v_permlane16_swap_b32 v240, v244
    v_permlane16_swap_b32 v241, v245
    v_accvgpr_write_b32 a164, v232
    v_accvgpr_write_b32 a165, v233
    v_accvgpr_write_b32 a166, v236
    v_accvgpr_write_b32 a167, v237
    v_permlane16_swap_b32 v248, v252
    v_mfma_f32_16x16x32_bf16 v[36:39], a[200:203], a[72:75], v[36:39]
    s_waitcnt lgkmcnt(0)
    v_permlane16_swap_b32 v249, v253
    v_accvgpr_write_b32 a168, v240
    v_accvgpr_write_b32 a169, v241
    v_accvgpr_write_b32 a170, v244
    v_accvgpr_write_b32 a171, v245
    v_accvgpr_write_b32 a172, v248
    v_accvgpr_write_b32 a173, v249
    v_mfma_f32_16x16x32_bf16 v[36:39], a[204:207], a[76:79], v[36:39]
    v_accvgpr_write_b32 a174, v252
    v_accvgpr_write_b32 a175, v253
L_at:
    ds_read_b64_tr_b16 a[208:209], v5
    ds_read_b64_tr_b16 a[210:211], v5 offset:4096
    v_exp_f32 v32, v32
    ds_read_b64_tr_b16 a[212:213], v6
    ds_read_b64_tr_b16 a[214:215], v6 offset:4096
    v_exp_f32 v33, v33
    v_exp_f32 v34, v34
    ds_read_b64_tr_b16 a[216:217], v7
    ds_read_b64_tr_b16 a[218:219], v7 offset:4096
    v_exp_f32 v35, v35
    v_exp_f32 v36, v36
    v_mfma_f32_16x16x32_bf16 v[40:43], a[176:179], a[80:83], v[52:55]
    ds_read_b64_tr_b16 a[220:221], v8
    ds_read_b64_tr_b16 a[222:223], v8 offset:4096
    v_mfma_f32_16x16x32_bf16 v[40:43], a[180:183], a[84:87], v[40:43]
    v_exp_f32 v37, v37
    v_mfma_f32_16x16x32_bf16 v[40:43], a[184:187], a[88:91], v[40:43]
    ds_read_b64_tr_b16 a[224:225], v9
    v_cvt_pk_bf16_f32 v24, v32, v33
    v_mfma_f32_16x16x32_bf16 v[40:43], a[188:191], a[92:95], v[40:43]
    v_exp_f32 v38, v38
    v_mfma_f32_16x16x32_bf16 v[44:47], a[192:195], a[80:83], v[52:55]
    ds_read_b64_tr_b16 a[226:227], v9 offset:4096
    v_cvt_pk_bf16_f32 v25, v34, v35
    v_mfma_f32_16x16x32_bf16 v[44:47], a[196:199], a[84:87], v[44:47]
    v_exp_f32 v39, v39
    v_mfma_f32_16x16x32_bf16 v[44:47], a[200:203], a[88:91], v[44:47]
    v_cvt_pk_bf16_f32 v26, v36, v37
    v_cvt_pk_bf16_f32 v27, v38, v39
    v_mfma_f32_16x16x32_bf16 v[44:47], a[204:207], a[92:95], v[44:47]
    s_waitcnt lgkmcnt(8)
    ds_read_b64_tr_b16 a[228:229], v10
    ds_read_b64_tr_b16 a[230:231], v10 offset:4096
    v_mfma_f32_16x16x32_bf16 v[96:99], a[208:211], v[24:27], 0
    s_waitcnt lgkmcnt(8)
    ds_read_b64_tr_b16 a[232:233], v11
    ds_read_b64_tr_b16 a[234:235], v11 offset:4096
    v_mfma_f32_16x16x32_bf16 v[100:103], a[212:215], v[24:27], 0
    s_waitcnt lgkmcnt(8)
    ds_read_b64_tr_b16 a[236:237], v12
    ds_read_b64_tr_b16 a[238:239], v12 offset:4096
    v_mfma_f32_16x16x32_bf16 v[104:107], a[216:219], v[24:27], 0
    s_waitcnt lgkmcnt(8)
    v_exp_f32 v40, v40
    v_mfma_f32_16x16x32_bf16 v[108:111], a[220:223], v[24:27], 0
    s_waitcnt lgkmcnt(6)
    v_exp_f32 v41, v41
    v_mfma_f32_16x16x32_bf16 v[112:115], a[224:227], v[24:27], 0
    s_waitcnt lgkmcnt(4)
    v_add_f32 v17, v17, v32
    v_add_f32 v17, v17, v33
    v_mfma_f32_16x16x32_bf16 v[116:119], a[228:231], v[24:27], 0
    s_waitcnt lgkmcnt(2)
    v_add_f32 v17, v17, v34
    v_add_f32 v17, v17, v35
    v_mfma_f32_16x16x32_bf16 v[120:123], a[232:235], v[24:27], 0
    s_waitcnt lgkmcnt(0)
    v_exp_f32 v42, v42
    v_mfma_f32_16x16x32_bf16 v[124:127], a[236:239], v[24:27], 0
    v_exp_f32 v43, v43
    v_mfma_f32_16x16x32_bf16 v[32:35], a[176:179], a[96:99], v[56:59]
    v_exp_f32 v44, v44
    v_mfma_f32_16x16x32_bf16 v[32:35], a[180:183], a[100:103], v[32:35]
    v_add_f32 v17, v17, v36
    v_add_f32 v17, v17, v37
    v_mfma_f32_16x16x32_bf16 v[32:35], a[184:187], a[104:107], v[32:35]
    v_exp_f32 v45, v45
    v_mfma_f32_16x16x32_bf16 v[32:35], a[188:191], a[108:111], v[32:35]
    v_add_f32 v17, v17, v38
    v_add_f32 v17, v17, v39
    v_mfma_f32_16x16x32_bf16 v[36:39], a[192:195], a[96:99], v[56:59]
    v_exp_f32 v46, v46
    v_mfma_f32_16x16x32_bf16 v[36:39], a[196:199], a[100:103], v[36:39]
    v_exp_f32 v47, v47
    v_cvt_pk_bf16_f32 v28, v40, v41
    v_mfma_f32_16x16x32_bf16 v[36:39], a[200:203], a[104:107], v[36:39]
    v_cvt_pk_bf16_f32 v29, v42, v43
    v_cvt_pk_bf16_f32 v30, v44, v45
    v_cvt_pk_bf16_f32 v31, v46, v47
    v_mfma_f32_16x16x32_bf16 v[36:39], a[204:207], a[108:111], v[36:39]
    v_add_f32 v18, v18, v40
    v_add_f32 v18, v18, v41
    v_mfma_f32_16x16x32_bf16 v[128:131], a[208:211], v[28:31], 0
    v_exp_f32 v32, v32
    v_mfma_f32_16x16x32_bf16 v[132:135], a[212:215], v[28:31], 0
    v_exp_f32 v33, v33
    v_mfma_f32_16x16x32_bf16 v[136:139], a[216:219], v[28:31], 0
    v_add_f32 v18, v18, v42
    v_add_f32 v18, v18, v43
    v_mfma_f32_16x16x32_bf16 v[140:143], a[220:223], v[28:31], 0
    v_exp_f32 v34, v34
    v_mfma_f32_16x16x32_bf16 v[144:147], a[224:227], v[28:31], 0
    v_exp_f32 v35, v35
    v_mfma_f32_16x16x32_bf16 v[148:151], a[228:231], v[28:31], 0
    v_add_f32 v18, v18, v44
    v_add_f32 v18, v18, v45
    v_mfma_f32_16x16x32_bf16 v[152:155], a[232:235], v[28:31], 0
    v_exp_f32 v36, v36
    v_mfma_f32_16x16x32_bf16 v[156:159], a[236:239], v[28:31], 0
    v_exp_f32 v37, v37
    v_mfma_f32_16x16x32_bf16 v[40:43], a[176:179], a[112:115], v[60:63]
    v_add_f32 v18, v18, v46
    v_add_f32 v18, v18, v47
    v_mfma_f32_16x16x32_bf16 v[40:43], a[180:183], a[116:119], v[40:43]
    v_cvt_pk_bf16_f32 v24, v32, v33
    v_cvt_pk_bf16_f32 v25, v34, v35
    v_mfma_f32_16x16x32_bf16 v[40:43], a[184:187], a[120:123], v[40:43]
    v_exp_f32 v38, v38
    v_mfma_f32_16x16x32_bf16 v[40:43], a[188:191], a[124:127], v[40:43]
    v_exp_f32 v39, v39
    v_mfma_f32_16x16x32_bf16 v[44:47], a[192:195], a[112:115], v[60:63]
    v_add_f32 v19, v19, v32
    v_add_f32 v19, v19, v33
    v_mfma_f32_16x16x32_bf16 v[44:47], a[196:199], a[116:119], v[44:47]
    v_cvt_pk_bf16_f32 v26, v36, v37
    v_cvt_pk_bf16_f32 v27, v38, v39
    v_mfma_f32_16x16x32_bf16 v[44:47], a[200:203], a[120:123], v[44:47]
    v_add_f32 v19, v19, v34
    v_add_f32 v19, v19, v35
    v_mfma_f32_16x16x32_bf16 v[44:47], a[204:207], a[124:127], v[44:47]
    v_add_f32 v19, v19, v36
    v_add_f32 v19, v19, v37
    v_mfma_f32_16x16x32_bf16 v[160:163], a[208:211], v[24:27], 0
    v_exp_f32 v40, v40
    v_mfma_f32_16x16x32_bf16 v[164:167], a[212:215], v[24:27], 0
    v_exp_f32 v41, v41
    v_mfma_f32_16x16x32_bf16 v[168:171], a[216:219], v[24:27], 0
    v_exp_f32 v42, v42
    v_mfma_f32_16x16x32_bf16 v[172:175], a[220:223], v[24:27], 0
    v_exp_f32 v43, v43
    v_mfma_f32_16x16x32_bf16 v[176:179], a[224:227], v[24:27], 0
    v_mfma_f32_16x16x32_bf16 v[180:183], a[228:231], v[24:27], 0
    v_exp_f32 v44, v44
    v_mfma_f32_16x16x32_bf16 v[184:187], a[232:235], v[24:27], 0
    v_exp_f32 v45, v45
    v_mfma_f32_16x16x32_bf16 v[188:191], a[236:239], v[24:27], 0
    v_add_f32 v19, v19, v38
    v_add_f32 v19, v19, v39
    v_mfma_f32_16x16x32_bf16 v[32:35], a[176:179], a[128:131], v[64:67]
    v_cvt_pk_bf16_f32 v28, v40, v41
    v_cvt_pk_bf16_f32 v29, v42, v43
    v_mfma_f32_16x16x32_bf16 v[32:35], a[180:183], a[132:135], v[32:35]
    v_exp_f32 v46, v46
    v_mfma_f32_16x16x32_bf16 v[32:35], a[184:187], a[136:139], v[32:35]
    v_exp_f32 v47, v47
    v_mfma_f32_16x16x32_bf16 v[32:35], a[188:191], a[140:143], v[32:35]
    v_add_f32 v20, v20, v40
    v_add_f32 v20, v20, v41
    v_mfma_f32_16x16x32_bf16 v[36:39], a[192:195], a[128:131], v[64:67]
    v_cvt_pk_bf16_f32 v30, v44, v45
    v_cvt_pk_bf16_f32 v31, v46, v47
    v_mfma_f32_16x16x32_bf16 v[36:39], a[196:199], a[132:135], v[36:39]
    v_add_f32 v20, v20, v42
    v_add_f32 v20, v20, v43
    v_mfma_f32_16x16x32_bf16 v[36:39], a[200:203], a[136:139], v[36:39]
    v_add_f32 v20, v20, v44
    v_add_f32 v20, v20, v45
    v_mfma_f32_16x16x32_bf16 v[36:39], a[204:207], a[140:143], v[36:39]
    v_add_f32 v20, v20, v46
    v_add_f32 v20, v20, v47
    v_mfma_f32_16x16x32_bf16 v[192:195], a[208:211], v[28:31], 0
    v_exp_f32 v32, v32
    v_mfma_f32_16x16x32_bf16 v[196:199], a[212:215], v[28:31], 0
    v_exp_f32 v33, v33
    v_mfma_f32_16x16x32_bf16 v[200:203], a[216:219], v[28:31], 0
    v_exp_f32 v34, v34
    v_mfma_f32_16x16x32_bf16 v[204:207], a[220:223], v[28:31], 0
    v_exp_f32 v35, v35
    v_mfma_f32_16x16x32_bf16 v[208:211], a[224:227], v[28:31], 0
    v_mfma_f32_16x16x32_bf16 v[212:215], a[228:231], v[28:31], 0
    v_exp_f32 v36, v36
    v_mfma_f32_16x16x32_bf16 v[216:219], a[232:235], v[28:31], 0
    v_exp_f32 v37, v37
    v_mfma_f32_16x16x32_bf16 v[220:223], a[236:239], v[28:31], 0
    v_cvt_pk_bf16_f32 v24, v32, v33
    v_cvt_pk_bf16_f32 v25, v34, v35
    v_mfma_f32_16x16x32_bf16 v[40:43], a[176:179], a[144:147], v[68:71]
    v_exp_f32 v38, v38
    v_mfma_f32_16x16x32_bf16 v[40:43], a[180:183], a[148:151], v[40:43]
    v_exp_f32 v39, v39
    v_mfma_f32_16x16x32_bf16 v[40:43], a[184:187], a[152:155], v[40:43]
    v_add_f32 v21, v21, v32
    v_add_f32 v21, v21, v33
    v_mfma_f32_16x16x32_bf16 v[40:43], a[188:191], a[156:159], v[40:43]
    v_cvt_pk_bf16_f32 v26, v36, v37
    v_cvt_pk_bf16_f32 v27, v38, v39
    v_mfma_f32_16x16x32_bf16 v[44:47], a[192:195], a[144:147], v[68:71]
    v_add_f32 v21, v21, v34
    v_add_f32 v21, v21, v35
    v_mfma_f32_16x16x32_bf16 v[44:47], a[196:199], a[148:151], v[44:47]
    v_add_f32 v21, v21, v36
    v_add_f32 v21, v21, v37
    v_mfma_f32_16x16x32_bf16 v[44:47], a[200:203], a[152:155], v[44:47]
    v_add_f32 v21, v21, v38
    v_add_f32 v21, v21, v39
    v_mfma_f32_16x16x32_bf16 v[44:47], a[204:207], a[156:159], v[44:47]
    s_waitcnt vmcnt(16)
    v_mfma_f32_16x16x32_bf16 v[224:227], a[208:211], v[24:27], 0
    s_barrier
    v_exp_f32 v40, v40
    v_mfma_f32_16x16x32_bf16 v[228:231], a[212:215], v[24:27], 0
    v_exp_f32 v41, v41
    v_mfma_f32_16x16x32_bf16 v[232:235], a[216:219], v[24:27], 0
    v_exp_f32 v42, v42
    v_mfma_f32_16x16x32_bf16 v[236:239], a[220:223], v[24:27], 0
    v_exp_f32 v43, v43
    v_mfma_f32_16x16x32_bf16 v[240:243], a[224:227], v[24:27], 0
    v_exp_f32 v44, v44
    v_mfma_f32_16x16x32_bf16 v[244:247], a[228:231], v[24:27], 0
    v_exp_f32 v45, v45
    v_mfma_f32_16x16x32_bf16 v[248:251], a[232:235], v[24:27], 0
    v_cvt_pk_bf16_f32 v28, v40, v41
    v_cvt_pk_bf16_f32 v29, v42, v43
    v_mfma_f32_16x16x32_bf16 v[252:255], a[236:239], v[24:27], 0
    v_exp_f32 v46, v46
    v_mfma_f32_16x16x32_bf16 v[32:35], a[176:179], a[160:163], v[72:75]
    s_and_b32 s69, s29, s63
    v_exp_f32 v47, v47
    v_mfma_f32_16x16x32_bf16 v[32:35], a[180:183], a[164:167], v[32:35]
    s_add_u32 m0, s32, s69
    ds_read_b128 a[176:179], v1 offset:8192
    ds_read_b128 a[180:183], v2 offset:8192
    v_mfma_f32_16x16x32_bf16 v[32:35], a[184:187], a[168:171], v[32:35]
    s_waitcnt vmcnt(3)
    buffer_load_dwordx4 v13, s[12:15], s29 offen nt lds
    v_cvt_pk_bf16_f32 v30, v44, v45
    v_cvt_pk_bf16_f32 v31, v46, v47
    v_mfma_f32_16x16x32_bf16 v[32:35], a[188:191], a[172:175], v[32:35]
    s_add_u32 s29, s29, s75
    ds_read_b128 a[184:187], v3 offset:8192
    ds_read_b128 a[188:191], v4 offset:8192
    v_mfma_f32_16x16x32_bf16 v[36:39], a[192:195], a[160:163], v[72:75]
    ds_read_b128 a[192:195], v1 offset:12288
    v_add_f32 v22, v22, v40
    v_mfma_f32_16x16x32_bf16 v[36:39], a[196:199], a[164:167], v[36:39]
    ds_read_b128 a[196:199], v2 offset:12288
    v_add_f32 v22, v22, v41
    v_mfma_f32_16x16x32_bf16 v[36:39], a[200:203], a[168:171], v[36:39]
    ds_read_b128 a[200:203], v3 offset:12288
    v_add_f32 v22, v22, v42
    v_mfma_f32_16x16x32_bf16 v[36:39], a[204:207], a[172:175], v[36:39]
    ds_read_b128 a[204:207], v4 offset:12288
    v_add_f32 v22, v22, v43
    v_mfma_f32_16x16x32_bf16 a[0:3], a[208:211], v[28:31], 0
    v_exp_f32 v32, v32
    v_mfma_f32_16x16x32_bf16 a[4:7], a[212:215], v[28:31], 0
    v_exp_f32 v33, v33
    v_mfma_f32_16x16x32_bf16 a[8:11], a[216:219], v[28:31], 0
    v_exp_f32 v34, v34
    v_mfma_f32_16x16x32_bf16 a[12:15], a[220:223], v[28:31], 0
    v_exp_f32 v35, v35
    v_mfma_f32_16x16x32_bf16 a[16:19], a[224:227], v[28:31], 0
    v_add_f32 v22, v22, v44
    v_add_f32 v22, v22, v45
    v_mfma_f32_16x16x32_bf16 a[20:23], a[228:231], v[28:31], 0
    s_and_b32 s69, s29, s63
    v_exp_f32 v36, v36
    v_mfma_f32_16x16x32_bf16 a[24:27], a[232:235], v[28:31], 0
    s_add_u32 m0, s32, s69
    v_exp_f32 v37, v37
    v_mfma_f32_16x16x32_bf16 a[28:31], a[236:239], v[28:31], 0
    s_waitcnt lgkmcnt(7)
    s_waitcnt vmcnt(3)
    buffer_load_dwordx4 v14, s[12:15], s29 offen nt lds
    v_add_f32 v22, v22, v46
    v_add_f32 v22, v22, v47
    v_mfma_f32_16x16x32_bf16 v[40:43], a[176:179], a[64:67], v[48:51]
    s_waitcnt lgkmcnt(6)
    s_add_u32 s29, s29, s75
    v_cvt_pk_bf16_f32 v24, v32, v33
    v_cvt_pk_bf16_f32 v25, v34, v35
    v_mfma_f32_16x16x32_bf16 v[40:43], a[180:183], a[68:71], v[40:43]
    s_waitcnt lgkmcnt(5)
    v_exp_f32 v38, v38
    v_mfma_f32_16x16x32_bf16 v[40:43], a[184:187], a[72:75], v[40:43]
    s_waitcnt lgkmcnt(4)
    v_exp_f32 v39, v39
    v_mfma_f32_16x16x32_bf16 v[40:43], a[188:191], a[76:79], v[40:43]
    s_waitcnt lgkmcnt(3)
    v_add_f32 v23, v23, v32
    v_add_f32 v23, v23, v33
    v_mfma_f32_16x16x32_bf16 v[44:47], a[192:195], a[64:67], v[48:51]
    s_waitcnt lgkmcnt(2)
    v_cvt_pk_bf16_f32 v26, v36, v37
    v_cvt_pk_bf16_f32 v27, v38, v39
    v_mfma_f32_16x16x32_bf16 v[44:47], a[196:199], a[68:71], v[44:47]
    s_waitcnt lgkmcnt(1)
    v_add_f32 v23, v23, v34
    v_add_f32 v23, v23, v35
    v_mfma_f32_16x16x32_bf16 v[44:47], a[200:203], a[72:75], v[44:47]
    s_waitcnt lgkmcnt(0)
    v_add_f32 v23, v23, v36
    v_add_f32 v23, v23, v37
    v_mfma_f32_16x16x32_bf16 v[44:47], a[204:207], a[76:79], v[44:47]
    v_add_f32 v23, v23, v38
    v_add_f32 v23, v23, v39
    v_mfma_f32_16x16x32_bf16 a[32:35], a[208:211], v[24:27], 0
    ds_read_b64_tr_b16 a[208:209], v5 offset:8192
    ds_read_b64_tr_b16 a[210:211], v5 offset:12288
    v_mfma_f32_16x16x32_bf16 a[36:39], a[212:215], v[24:27], 0
    v_exp_f32 v40, v40
    v_mfma_f32_16x16x32_bf16 a[40:43], a[216:219], v[24:27], 0
    ds_read_b64_tr_b16 a[212:213], v6 offset:8192
    ds_read_b64_tr_b16 a[214:215], v6 offset:12288
    v_mfma_f32_16x16x32_bf16 a[44:47], a[220:223], v[24:27], 0
    v_exp_f32 v41, v41
    v_mfma_f32_16x16x32_bf16 a[48:51], a[224:227], v[24:27], 0
    v_exp_f32 v42, v42
    v_mfma_f32_16x16x32_bf16 a[52:55], a[228:231], v[24:27], 0
    ds_read_b64_tr_b16 a[216:217], v7 offset:8192
    ds_read_b64_tr_b16 a[218:219], v7 offset:12288
    v_mfma_f32_16x16x32_bf16 a[56:59], a[232:235], v[24:27], 0
    v_exp_f32 v43, v43
    v_mfma_f32_16x16x32_bf16 a[60:63], a[236:239], v[24:27], 0
    v_exp_f32 v44, v44
L_atl:
    v_mfma_f32_16x16x32_bf16 v[32:35], a[176:179], a[80:83], v[52:55]
    ds_read_b64_tr_b16 a[220:221], v8 offset:8192
    ds_read_b64_tr_b16 a[222:223], v8 offset:12288
    v_mfma_f32_16x16x32_bf16 v[32:35], a[180:183], a[84:87], v[32:35]
    v_exp_f32 v45, v45
    v_mfma_f32_16x16x32_bf16 v[32:35], a[184:187], a[88:91], v[32:35]
    ds_read_b64_tr_b16 a[224:225], v9 offset:8192
    v_cvt_pk_bf16_f32 v28, v40, v41
    v_mfma_f32_16x16x32_bf16 v[32:35], a[188:191], a[92:95], v[32:35]
    v_exp_f32 v46, v46
    v_mfma_f32_16x16x32_bf16 v[36:39], a[192:195], a[80:83], v[52:55]
    s_and_b32 s69, s29, s63
    ds_read_b64_tr_b16 a[226:227], v9 offset:12288
    v_cvt_pk_bf16_f32 v29, v42, v43
    v_mfma_f32_16x16x32_bf16 v[36:39], a[196:199], a[84:87], v[36:39]
    s_add_u32 m0, s32, s69
    v_exp_f32 v47, v47
    v_mfma_f32_16x16x32_bf16 v[36:39], a[200:203], a[88:91], v[36:39]
    s_waitcnt vmcnt(3)
    buffer_load_dwordx4 v13, s[12:15], s29 offen nt lds
    v_cvt_pk_bf16_f32 v30, v44, v45
    v_cvt_pk_bf16_f32 v31, v46, v47
    v_mfma_f32_16x16x32_bf16 v[36:39], a[204:207], a[92:95], v[36:39]
    s_waitcnt lgkmcnt(8)
    s_add_u32 s29, s29, s75
    ds_read_b64_tr_b16 a[228:229], v10 offset:8192
    ds_read_b64_tr_b16 a[230:231], v10 offset:12288
    v_mfma_f32_16x16x32_bf16 v[96:99], a[208:211], v[28:31], v[96:99]
    s_waitcnt lgkmcnt(8)
    ds_read_b64_tr_b16 a[232:233], v11 offset:8192
    ds_read_b64_tr_b16 a[234:235], v11 offset:12288
    v_mfma_f32_16x16x32_bf16 v[100:103], a[212:215], v[28:31], v[100:103]
    s_waitcnt lgkmcnt(8)
    ds_read_b64_tr_b16 a[236:237], v12 offset:8192
    ds_read_b64_tr_b16 a[238:239], v12 offset:12288
    v_mfma_f32_16x16x32_bf16 v[104:107], a[216:219], v[28:31], v[104:107]
    s_waitcnt lgkmcnt(8)
    v_exp_f32 v32, v32
    v_mfma_f32_16x16x32_bf16 v[108:111], a[220:223], v[28:31], v[108:111]
    s_waitcnt lgkmcnt(6)
    v_exp_f32 v33, v33
    v_mfma_f32_16x16x32_bf16 v[112:115], a[224:227], v[28:31], v[112:115]
    s_waitcnt lgkmcnt(4)
    v_add_f32 v17, v17, v40
    v_add_f32 v17, v17, v41
    v_mfma_f32_16x16x32_bf16 v[116:119], a[228:231], v[28:31], v[116:119]
    s_waitcnt lgkmcnt(2)
    v_add_f32 v17, v17, v42
    v_add_f32 v17, v17, v43
    v_mfma_f32_16x16x32_bf16 v[120:123], a[232:235], v[28:31], v[120:123]
    s_waitcnt lgkmcnt(0)
    v_exp_f32 v34, v34
    v_mfma_f32_16x16x32_bf16 v[124:127], a[236:239], v[28:31], v[124:127]
    v_exp_f32 v35, v35
    v_mfma_f32_16x16x32_bf16 v[40:43], a[176:179], a[96:99], v[56:59]
    v_exp_f32 v36, v36
    v_mfma_f32_16x16x32_bf16 v[40:43], a[180:183], a[100:103], v[40:43]
    s_and_b32 s69, s29, s63
    v_add_f32 v17, v17, v44
    v_add_f32 v17, v17, v45
    v_mfma_f32_16x16x32_bf16 v[40:43], a[184:187], a[104:107], v[40:43]
    s_add_u32 m0, s32, s69
    v_exp_f32 v37, v37
    v_mfma_f32_16x16x32_bf16 v[40:43], a[188:191], a[108:111], v[40:43]
    s_waitcnt vmcnt(3)
    buffer_load_dwordx4 v14, s[12:15], s29 offen nt lds
    v_add_f32 v17, v17, v46
    v_add_f32 v17, v17, v47
    v_mfma_f32_16x16x32_bf16 v[44:47], a[192:195], a[96:99], v[56:59]
    s_add_u32 s29, s29, s75
    v_exp_f32 v38, v38
    v_mfma_f32_16x16x32_bf16 v[44:47], a[196:199], a[100:103], v[44:47]
    v_exp_f32 v39, v39
    v_cvt_pk_bf16_f32 v24, v32, v33
    v_mfma_f32_16x16x32_bf16 v[44:47], a[200:203], a[104:107], v[44:47]
    v_cvt_pk_bf16_f32 v25, v34, v35
    v_cvt_pk_bf16_f32 v26, v36, v37
    v_cvt_pk_bf16_f32 v27, v38, v39
    v_mfma_f32_16x16x32_bf16 v[44:47], a[204:207], a[108:111], v[44:47]
    v_add_f32 v18, v18, v32
    v_add_f32 v18, v18, v33
    v_mfma_f32_16x16x32_bf16 v[128:131], a[208:211], v[24:27], v[128:131]
    v_exp_f32 v40, v40
    v_mfma_f32_16x16x32_bf16 v[132:135], a[212:215], v[24:27], v[132:135]
    v_exp_f32 v41, v41
    v_mfma_f32_16x16x32_bf16 v[136:139], a[216:219], v[24:27], v[136:139]
    v_add_f32 v18, v18, v34
    v_add_f32 v18, v18, v35
    v_mfma_f32_16x16x32_bf16 v[140:143], a[220:223], v[24:27], v[140:143]
    v_exp_f32 v42, v42
    v_mfma_f32_16x16x32_bf16 v[144:147], a[224:227], v[24:27], v[144:147]
    v_exp_f32 v43, v43
    v_mfma_f32_16x16x32_bf16 v[148:151], a[228:231], v[24:27], v[148:151]
    v_add_f32 v18, v18, v36
    v_add_f32 v18, v18, v37
    v_mfma_f32_16x16x32_bf16 v[152:155], a[232:235], v[24:27], v[152:155]
    s_and_b32 s69, s29, s63
    v_exp_f32 v44, v44
    v_mfma_f32_16x16x32_bf16 v[156:159], a[236:239], v[24:27], v[156:159]
    s_add_u32 m0, s32, s69
    v_exp_f32 v45, v45
    v_mfma_f32_16x16x32_bf16 v[32:35], a[176:179], a[112:115], v[60:63]
    s_waitcnt vmcnt(3)
    buffer_load_dwordx4 v13, s[12:15], s29 offen nt lds
    v_add_f32 v18, v18, v38
    v_add_f32 v18, v18, v39
    v_mfma_f32_16x16x32_bf16 v[32:35], a[180:183], a[116:119], v[32:35]
    s_add_u32 s29, s29, s75
    v_cvt_pk_bf16_f32 v28, v40, v41
    v_cvt_pk_bf16_f32 v29, v42, v43
    v_mfma_f32_16x16x32_bf16 v[32:35], a[184:187], a[120:123], v[32:35]
    v_exp_f32 v46, v46
    v_mfma_f32_16x16x32_bf16 v[32:35], a[188:191], a[124:127], v[32:35]
    v_exp_f32 v47, v47
    v_mfma_f32_16x16x32_bf16 v[36:39], a[192:195], a[112:115], v[60:63]
    v_add_f32 v19, v19, v40
    v_add_f32 v19, v19, v41
    v_mfma_f32_16x16x32_bf16 v[36:39], a[196:199], a[116:119], v[36:39]
    v_cvt_pk_bf16_f32 v30, v44, v45
    v_cvt_pk_bf16_f32 v31, v46, v47
    v_mfma_f32_16x16x32_bf16 v[36:39], a[200:203], a[120:123], v[36:39]
    v_add_f32 v19, v19, v42
    v_add_f32 v19, v19, v43
    v_mfma_f32_16x16x32_bf16 v[36:39], a[204:207], a[124:127], v[36:39]
    v_add_f32 v19, v19, v44
    v_add_f32 v19, v19, v45
    v_mfma_f32_16x16x32_bf16 v[160:163], a[208:211], v[28:31], v[160:163]
    v_exp_f32 v32, v32
    v_mfma_f32_16x16x32_bf16 v[164:167], a[212:215], v[28:31], v[164:167]
    v_exp_f32 v33, v33
    v_mfma_f32_16x16x32_bf16 v[168:171], a[216:219], v[28:31], v[168:171]
    s_and_b32 s69, s29, s63
    v_exp_f32 v34, v34
    v_mfma_f32_16x16x32_bf16 v[172:175], a[220:223], v[28:31], v[172:175]
    s_add_u32 m0, s32, s69
    v_exp_f32 v35, v35
    v_mfma_f32_16x16x32_bf16 v[176:179], a[224:227], v[28:31], v[176:179]
    s_waitcnt vmcnt(3)
    buffer_load_dwordx4 v14, s[12:15], s29 offen nt lds
    v_mfma_f32_16x16x32_bf16 v[180:183], a[228:231], v[28:31], v[180:183]
    s_add_u32 s29, s29, s75
    v_exp_f32 v36, v36
    v_mfma_f32_16x16x32_bf16 v[184:187], a[232:235], v[28:31], v[184:187]
    v_exp_f32 v37, v37
    v_mfma_f32_16x16x32_bf16 v[188:191], a[236:239], v[28:31], v[188:191]
    v_add_f32 v19, v19, v46
    v_add_f32 v19, v19, v47
    v_mfma_f32_16x16x32_bf16 v[40:43], a[176:179], a[128:131], v[64:67]
    v_cvt_pk_bf16_f32 v24, v32, v33
    v_cvt_pk_bf16_f32 v25, v34, v35
    v_mfma_f32_16x16x32_bf16 v[40:43], a[180:183], a[132:135], v[40:43]
    v_exp_f32 v38, v38
    v_mfma_f32_16x16x32_bf16 v[40:43], a[184:187], a[136:139], v[40:43]
    v_exp_f32 v39, v39
    v_mfma_f32_16x16x32_bf16 v[40:43], a[188:191], a[140:143], v[40:43]
    v_add_f32 v20, v20, v32
    v_add_f32 v20, v20, v33
    v_mfma_f32_16x16x32_bf16 v[44:47], a[192:195], a[128:131], v[64:67]
    v_cvt_pk_bf16_f32 v26, v36, v37
    v_cvt_pk_bf16_f32 v27, v38, v39
    v_mfma_f32_16x16x32_bf16 v[44:47], a[196:199], a[132:135], v[44:47]
    v_add_f32 v20, v20, v34
    v_add_f32 v20, v20, v35
    v_mfma_f32_16x16x32_bf16 v[44:47], a[200:203], a[136:139], v[44:47]
    v_add_f32 v20, v20, v36
    v_add_f32 v20, v20, v37
    v_mfma_f32_16x16x32_bf16 v[44:47], a[204:207], a[140:143], v[44:47]
    v_add_f32 v20, v20, v38
    v_add_f32 v20, v20, v39
    v_mfma_f32_16x16x32_bf16 v[192:195], a[208:211], v[24:27], v[192:195]
    v_exp_f32 v40, v40
    v_mfma_f32_16x16x32_bf16 v[196:199], a[212:215], v[24:27], v[196:199]
    v_exp_f32 v41, v41
    v_mfma_f32_16x16x32_bf16 v[200:203], a[216:219], v[24:27], v[200:203]
    s_and_b32 s69, s29, s63
    v_exp_f32 v42, v42
    v_mfma_f32_16x16x32_bf16 v[204:207], a[220:223], v[24:27], v[204:207]
    s_add_u32 m0, s32, s69
    v_exp_f32 v43, v43
    v_mfma_f32_16x16x32_bf16 v[208:211], a[224:227], v[24:27], v[208:211]
    s_waitcnt vmcnt(3)
    buffer_load_dwordx4 v13, s[12:15], s29 offen nt lds
    v_mfma_f32_16x16x32_bf16 v[212:215], a[228:231], v[24:27], v[212:215]
    s_add_u32 s29, s29, s75
    v_exp_f32 v44, v44
    v_mfma_f32_16x16x32_bf16 v[216:219], a[232:235], v[24:27], v[216:219]
    v_exp_f32 v45, v45
    v_mfma_f32_16x16x32_bf16 v[220:223], a[236:239], v[24:27], v[220:223]
    v_cvt_pk_bf16_f32 v28, v40, v41
    v_cvt_pk_bf16_f32 v29, v42, v43
    v_mfma_f32_16x16x32_bf16 v[32:35], a[176:179], a[144:147], v[68:71]
    v_exp_f32 v46, v46
    v_mfma_f32_16x16x32_bf16 v[32:35], a[180:183], a[148:151], v[32:35]
    v_exp_f32 v47, v47
    v_mfma_f32_16x16x32_bf16 v[32:35], a[184:187], a[152:155], v[32:35]
    v_add_f32 v21, v21, v40
    v_add_f32 v21, v21, v41
    v_mfma_f32_16x16x32_bf16 v[32:35], a[188:191], a[156:159], v[32:35]
    v_cvt_pk_bf16_f32 v30, v44, v45
    v_cvt_pk_bf16_f32 v31, v46, v47
    v_mfma_f32_16x16x32_bf16 v[36:39], a[192:195], a[144:147], v[68:71]
    v_add_f32 v21, v21, v42
    v_add_f32 v21, v21, v43
    v_mfma_f32_16x16x32_bf16 v[36:39], a[196:199], a[148:151], v[36:39]
    s_and_b32 s69, s29, s63
    v_add_f32 v21, v21, v44
    v_add_f32 v21, v21, v45
    v_mfma_f32_16x16x32_bf16 v[36:39], a[200:203], a[152:155], v[36:39]
    s_add_u32 m0, s32, s69
    v_add_f32 v21, v21, v46
    v_add_f32 v21, v21, v47
    v_mfma_f32_16x16x32_bf16 v[36:39], a[204:207], a[156:159], v[36:39]
    s_waitcnt vmcnt(3)
    buffer_load_dwordx4 v14, s[12:15], s29 offen nt lds
    v_mfma_f32_16x16x32_bf16 v[224:227], a[208:211], v[28:31], v[224:227]
    s_barrier
    v_exp_f32 v32, v32
    v_mfma_f32_16x16x32_bf16 v[228:231], a[212:215], v[28:31], v[228:231]
    s_add_u32 s29, s29, s75
    v_exp_f32 v33, v33
    v_mfma_f32_16x16x32_bf16 v[232:235], a[216:219], v[28:31], v[232:235]
    v_exp_f32 v34, v34
    v_mfma_f32_16x16x32_bf16 v[236:239], a[220:223], v[28:31], v[236:239]
    v_exp_f32 v35, v35
    v_mfma_f32_16x16x32_bf16 v[240:243], a[224:227], v[28:31], v[240:243]
    v_exp_f32 v36, v36
    v_mfma_f32_16x16x32_bf16 v[244:247], a[228:231], v[28:31], v[244:247]
    v_exp_f32 v37, v37
    v_mfma_f32_16x16x32_bf16 v[248:251], a[232:235], v[28:31], v[248:251]
    v_cvt_pk_bf16_f32 v24, v32, v33
    v_cvt_pk_bf16_f32 v25, v34, v35
    v_mfma_f32_16x16x32_bf16 v[252:255], a[236:239], v[28:31], v[252:255]
    v_exp_f32 v38, v38
    v_mfma_f32_16x16x32_bf16 v[40:43], a[176:179], a[160:163], v[72:75]
    s_and_b32 s69, s29, s63
    v_exp_f32 v39, v39
    v_mfma_f32_16x16x32_bf16 v[40:43], a[180:183], a[164:167], v[40:43]
    s_add_u32 m0, s32, s69
    ds_read_b128 a[176:179], v1 offset:16384
    ds_read_b128 a[180:183], v2 offset:16384
    v_mfma_f32_16x16x32_bf16 v[40:43], a[184:187], a[168:171], v[40:43]
    s_waitcnt vmcnt(3)
    buffer_load_dwordx4 v13, s[12:15], s29 offen nt lds
    v_cvt_pk_bf16_f32 v26, v36, v37
    v_cvt_pk_bf16_f32 v27, v38, v39
    v_mfma_f32_16x16x32_bf16 v[40:43], a[188:191], a[172:175], v[40:43]
    s_add_u32 s29, s29, s75
    ds_read_b128 a[184:187], v3 offset:16384
    ds_read_b128 a[188:191], v4 offset:16384
    v_mfma_f32_16x16x32_bf16 v[44:47], a[192:195], a[160:163], v[72:75]
    ds_read_b128 a[192:195], v1 offset:20480
    v_add_f32 v22, v22, v32
    v_mfma_f32_16x16x32_bf16 v[44:47], a[196:199], a[164:167], v[44:47]
    ds_read_b128 a[196:199], v2 offset:20480
    v_add_f32 v22, v22, v33
    v_mfma_f32_16x16x32_bf16 v[44:47], a[200:203], a[168:171], v[44:47]
    ds_read_b128 a[200:203], v3 offset:20480
    v_add_f32 v22, v22, v34
    v_mfma_f32_16x16x32_bf16 v[44:47], a[204:207], a[172:175], v[44:47]
    ds_read_b128 a[204:207], v4 offset:20480
    v_add_f32 v22, v22, v35
    v_mfma_f32_16x16x32_bf16 a[0:3], a[208:211], v[24:27], a[0:3]
    v_exp_f32 v40, v40
    v_mfma_f32_16x16x32_bf16 a[4:7], a[212:215], v[24:27], a[4:7]
    v_exp_f32 v41, v41
    v_mfma_f32_16x16x32_bf16 a[8:11], a[216:219], v[24:27], a[8:11]
    v_exp_f32 v42, v42
    v_mfma_f32_16x16x32_bf16 a[12:15], a[220:223], v[24:27], a[12:15]
    v_exp_f32 v43, v43
    v_mfma_f32_16x16x32_bf16 a[16:19], a[224:227], v[24:27], a[16:19]
    v_add_f32 v22, v22, v36
    v_add_f32 v22, v22, v37
    v_mfma_f32_16x16x32_bf16 a[20:23], a[228:231], v[24:27], a[20:23]
    s_and_b32 s69, s29, s63
    v_exp_f32 v44, v44
    v_mfma_f32_16x16x32_bf16 a[24:27], a[232:235], v[24:27], a[24:27]
    s_add_u32 m0, s32, s69
    v_exp_f32 v45, v45
    v_mfma_f32_16x16x32_bf16 a[28:31], a[236:239], v[24:27], a[28:31]
    s_waitcnt lgkmcnt(7)
    s_waitcnt vmcnt(3)
    buffer_load_dwordx4 v14, s[12:15], s29 offen nt lds
    v_add_f32 v22, v22, v38
    v_add_f32 v22, v22, v39
    v_mfma_f32_16x16x32_bf16 v[32:35], a[176:179], a[64:67], v[48:51]
    s_waitcnt lgkmcnt(6)
    s_add_u32 s29, s29, s75
    v_cvt_pk_bf16_f32 v28, v40, v41
    v_cvt_pk_bf16_f32 v29, v42, v43
    v_mfma_f32_16x16x32_bf16 v[32:35], a[180:183], a[68:71], v[32:35]
    s_waitcnt lgkmcnt(5)
    v_exp_f32 v46, v46
    v_mfma_f32_16x16x32_bf16 v[32:35], a[184:187], a[72:75], v[32:35]
    s_waitcnt lgkmcnt(4)
    v_exp_f32 v47, v47
    v_mfma_f32_16x16x32_bf16 v[32:35], a[188:191], a[76:79], v[32:35]
    s_waitcnt lgkmcnt(3)
    v_add_f32 v23, v23, v40
    v_add_f32 v23, v23, v41
    v_mfma_f32_16x16x32_bf16 v[36:39], a[192:195], a[64:67], v[48:51]
    s_waitcnt lgkmcnt(2)
    v_cvt_pk_bf16_f32 v30, v44, v45
    v_cvt_pk_bf16_f32 v31, v46, v47
    v_mfma_f32_16x16x32_bf16 v[36:39], a[196:199], a[68:71], v[36:39]
    s_waitcnt lgkmcnt(1)
    v_add_f32 v23, v23, v42
    v_add_f32 v23, v23, v43
    v_mfma_f32_16x16x32_bf16 v[36:39], a[200:203], a[72:75], v[36:39]
    s_waitcnt lgkmcnt(0)
    v_add_f32 v23, v23, v44
    v_add_f32 v23, v23, v45
    v_mfma_f32_16x16x32_bf16 v[36:39], a[204:207], a[76:79], v[36:39]
    v_add_f32 v23, v23, v46
    v_add_f32 v23, v23, v47
    v_mfma_f32_16x16x32_bf16 a[32:35], a[208:211], v[28:31], a[32:35]
    ds_read_b64_tr_b16 a[208:209], v5 offset:16384
    ds_read_b64_tr_b16 a[210:211], v5 offset:20480
    v_mfma_f32_16x16x32_bf16 a[36:39], a[212:215], v[28:31], a[36:39]
    v_exp_f32 v32, v32
    v_mfma_f32_16x16x32_bf16 a[40:43], a[216:219], v[28:31], a[40:43]
    ds_read_b64_tr_b16 a[212:213], v6 offset:16384
    ds_read_b64_tr_b16 a[214:215], v6 offset:20480
    v_mfma_f32_16x16x32_bf16 a[44:47], a[220:223], v[28:31], a[44:47]
    v_exp_f32 v33, v33
    v_mfma_f32_16x16x32_bf16 a[48:51], a[224:227], v[28:31], a[48:51]
    v_exp_f32 v34, v34
    v_mfma_f32_16x16x32_bf16 a[52:55], a[228:231], v[28:31], a[52:55]
    ds_read_b64_tr_b16 a[216:217], v7 offset:16384
    ds_read_b64_tr_b16 a[218:219], v7 offset:20480
    v_mfma_f32_16x16x32_bf16 a[56:59], a[232:235], v[28:31], a[56:59]
    v_exp_f32 v35, v35
    v_mfma_f32_16x16x32_bf16 a[60:63], a[236:239], v[28:31], a[60:63]
    v_exp_f32 v36, v36
    v_mfma_f32_16x16x32_bf16 v[40:43], a[176:179], a[80:83], v[52:55]
    ds_read_b64_tr_b16 a[220:221], v8 offset:16384
    ds_read_b64_tr_b16 a[222:223], v8 offset:20480
    v_mfma_f32_16x16x32_bf16 v[40:43], a[180:183], a[84:87], v[40:43]
    v_exp_f32 v37, v37
    v_mfma_f32_16x16x32_bf16 v[40:43], a[184:187], a[88:91], v[40:43]
    ds_read_b64_tr_b16 a[224:225], v9 offset:16384
    v_cvt_pk_bf16_f32 v24, v32, v33
    v_mfma_f32_16x16x32_bf16 v[40:43], a[188:191], a[92:95], v[40:43]
    v_exp_f32 v38, v38
    v_mfma_f32_16x16x32_bf16 v[44:47], a[192:195], a[80:83], v[52:55]
    s_and_b32 s69, s29, s63
    ds_read_b64_tr_b16 a[226:227], v9 offset:20480
    v_cvt_pk_bf16_f32 v25, v34, v35
    v_mfma_f32_16x16x32_bf16 v[44:47], a[196:199], a[84:87], v[44:47]
    s_add_u32 m0, s32, s69
    v_exp_f32 v39, v39
    v_mfma_f32_16x16x32_bf16 v[44:47], a[200:203], a[88:91], v[44:47]
    s_waitcnt vmcnt(3)
    buffer_load_dwordx4 v13, s[12:15], s29 offen nt lds
    v_cvt_pk_bf16_f32 v26, v36, v37
    v_cvt_pk_bf16_f32 v27, v38, v39
    v_mfma_f32_16x16x32_bf16 v[44:47], a[204:207], a[92:95], v[44:47]
    s_waitcnt lgkmcnt(8)
    s_add_u32 s29, s29, s75
    ds_read_b64_tr_b16 a[228:229], v10 offset:16384
    ds_read_b64_tr_b16 a[230:231], v10 offset:20480
    v_mfma_f32_16x16x32_bf16 v[96:99], a[208:211], v[24:27], v[96:99]
    s_waitcnt lgkmcnt(8)
    ds_read_b64_tr_b16 a[232:233], v11 offset:16384
    ds_read_b64_tr_b16 a[234:235], v11 offset:20480
    v_mfma_f32_16x16x32_bf16 v[100:103], a[212:215], v[24:27], v[100:103]
    s_waitcnt lgkmcnt(8)
    ds_read_b64_tr_b16 a[236:237], v12 offset:16384
    ds_read_b64_tr_b16 a[238:239], v12 offset:20480
    v_mfma_f32_16x16x32_bf16 v[104:107], a[216:219], v[24:27], v[104:107]
    s_waitcnt lgkmcnt(8)
    v_exp_f32 v40, v40
    v_mfma_f32_16x16x32_bf16 v[108:111], a[220:223], v[24:27], v[108:111]
    s_waitcnt lgkmcnt(6)
    v_exp_f32 v41, v41
    v_mfma_f32_16x16x32_bf16 v[112:115], a[224:227], v[24:27], v[112:115]
    s_waitcnt lgkmcnt(4)
    v_add_f32 v17, v17, v32
    v_add_f32 v17, v17, v33
    v_mfma_f32_16x16x32_bf16 v[116:119], a[228:231], v[24:27], v[116:119]
    s_waitcnt lgkmcnt(2)
    v_add_f32 v17, v17, v34
    v_add_f32 v17, v17, v35
    v_mfma_f32_16x16x32_bf16 v[120:123], a[232:235], v[24:27], v[120:123]
    s_waitcnt lgkmcnt(0)
    v_exp_f32 v42, v42
    v_mfma_f32_16x16x32_bf16 v[124:127], a[236:239], v[24:27], v[124:127]
    v_exp_f32 v43, v43
    v_mfma_f32_16x16x32_bf16 v[32:35], a[176:179], a[96:99], v[56:59]
    v_exp_f32 v44, v44
    v_mfma_f32_16x16x32_bf16 v[32:35], a[180:183], a[100:103], v[32:35]
    s_and_b32 s69, s29, s63
    v_add_f32 v17, v17, v36
    v_add_f32 v17, v17, v37
    v_mfma_f32_16x16x32_bf16 v[32:35], a[184:187], a[104:107], v[32:35]
    s_add_u32 m0, s32, s69
    v_exp_f32 v45, v45
    v_mfma_f32_16x16x32_bf16 v[32:35], a[188:191], a[108:111], v[32:35]
    s_waitcnt vmcnt(3)
    buffer_load_dwordx4 v14, s[12:15], s29 offen nt lds
    v_add_f32 v17, v17, v38
    v_add_f32 v17, v17, v39
    v_mfma_f32_16x16x32_bf16 v[36:39], a[192:195], a[96:99], v[56:59]
    s_add_u32 s29, s29, s75
    v_exp_f32 v46, v46
    v_mfma_f32_16x16x32_bf16 v[36:39], a[196:199], a[100:103], v[36:39]
    v_exp_f32 v47, v47
    v_cvt_pk_bf16_f32 v28, v40, v41
    v_mfma_f32_16x16x32_bf16 v[36:39], a[200:203], a[104:107], v[36:39]
    v_cvt_pk_bf16_f32 v29, v42, v43
    v_cvt_pk_bf16_f32 v30, v44, v45
    v_cvt_pk_bf16_f32 v31, v46, v47
    v_mfma_f32_16x16x32_bf16 v[36:39], a[204:207], a[108:111], v[36:39]
    v_add_f32 v18, v18, v40
    v_add_f32 v18, v18, v41
    v_mfma_f32_16x16x32_bf16 v[128:131], a[208:211], v[28:31], v[128:131]
    v_exp_f32 v32, v32
    v_mfma_f32_16x16x32_bf16 v[132:135], a[212:215], v[28:31], v[132:135]
    v_exp_f32 v33, v33
    v_mfma_f32_16x16x32_bf16 v[136:139], a[216:219], v[28:31], v[136:139]
    v_add_f32 v18, v18, v42
    v_add_f32 v18, v18, v43
    v_mfma_f32_16x16x32_bf16 v[140:143], a[220:223], v[28:31], v[140:143]
    v_exp_f32 v34, v34
    v_mfma_f32_16x16x32_bf16 v[144:147], a[224:227], v[28:31], v[144:147]
    v_exp_f32 v35, v35
    v_mfma_f32_16x16x32_bf16 v[148:151], a[228:231], v[28:31], v[148:151]
    v_add_f32 v18, v18, v44
    v_add_f32 v18, v18, v45
    v_mfma_f32_16x16x32_bf16 v[152:155], a[232:235], v[28:31], v[152:155]
    s_and_b32 s69, s29, s63
    v_exp_f32 v36, v36
    v_mfma_f32_16x16x32_bf16 v[156:159], a[236:239], v[28:31], v[156:159]
    s_add_u32 m0, s32, s69
    v_exp_f32 v37, v37
    v_mfma_f32_16x16x32_bf16 v[40:43], a[176:179], a[112:115], v[60:63]
    s_waitcnt vmcnt(3)
    buffer_load_dwordx4 v13, s[12:15], s29 offen nt lds
    v_add_f32 v18, v18, v46
    v_add_f32 v18, v18, v47
    v_mfma_f32_16x16x32_bf16 v[40:43], a[180:183], a[116:119], v[40:43]
    s_add_u32 s29, s29, s75
    v_cvt_pk_bf16_f32 v24, v32, v33
    v_cvt_pk_bf16_f32 v25, v34, v35
    v_mfma_f32_16x16x32_bf16 v[40:43], a[184:187], a[120:123], v[40:43]
    v_exp_f32 v38, v38
    v_mfma_f32_16x16x32_bf16 v[40:43], a[188:191], a[124:127], v[40:43]
    v_exp_f32 v39, v39
    v_mfma_f32_16x16x32_bf16 v[44:47], a[192:195], a[112:115], v[60:63]
    v_add_f32 v19, v19, v32
    v_add_f32 v19, v19, v33
    v_mfma_f32_16x16x32_bf16 v[44:47], a[196:199], a[116:119], v[44:47]
    v_cvt_pk_bf16_f32 v26, v36, v37
    v_cvt_pk_bf16_f32 v27, v38, v39
    v_mfma_f32_16x16x32_bf16 v[44:47], a[200:203], a[120:123], v[44:47]
    v_add_f32 v19, v19, v34
    v_add_f32 v19, v19, v35
    v_mfma_f32_16x16x32_bf16 v[44:47], a[204:207], a[124:127], v[44:47]
    v_add_f32 v19, v19, v36
    v_add_f32 v19, v19, v37
    v_mfma_f32_16x16x32_bf16 v[160:163], a[208:211], v[24:27], v[160:163]
    v_exp_f32 v40, v40
    v_mfma_f32_16x16x32_bf16 v[164:167], a[212:215], v[24:27], v[164:167]
    v_exp_f32 v41, v41
    v_mfma_f32_16x16x32_bf16 v[168:171], a[216:219], v[24:27], v[168:171]
    s_and_b32 s69, s29, s63
    v_exp_f32 v42, v42
    v_mfma_f32_16x16x32_bf16 v[172:175], a[220:223], v[24:27], v[172:175]
    s_add_u32 m0, s32, s69
    v_exp_f32 v43, v43
    v_mfma_f32_16x16x32_bf16 v[176:179], a[224:227], v[24:27], v[176:179]
    s_waitcnt vmcnt(3)
    buffer_load_dwordx4 v14, s[12:15], s29 offen nt lds
    v_mfma_f32_16x16x32_bf16 v[180:183], a[228:231], v[24:27], v[180:183]
    s_add_u32 s29, s29, s75
    v_exp_f32 v44, v44
    v_mfma_f32_16x16x32_bf16 v[184:187], a[232:235], v[24:27], v[184:187]
    v_exp_f32 v45, v45
    v_mfma_f32_16x16x32_bf16 v[188:191], a[236:239], v[24:27], v[188:191]
    v_add_f32 v19, v19, v38
    v_add_f32 v19, v19, v39
    v_mfma_f32_16x16x32_bf16 v[32:35], a[176:179], a[128:131], v[64:67]
    v_cvt_pk_bf16_f32 v28, v40, v41
    v_cvt_pk_bf16_f32 v29, v42, v43
    v_mfma_f32_16x16x32_bf16 v[32:35], a[180:183], a[132:135], v[32:35]
    v_exp_f32 v46, v46
    v_mfma_f32_16x16x32_bf16 v[32:35], a[184:187], a[136:139], v[32:35]
    v_exp_f32 v47, v47
    v_mfma_f32_16x16x32_bf16 v[32:35], a[188:191], a[140:143], v[32:35]
    v_add_f32 v20, v20, v40
    v_add_f32 v20, v20, v41
    v_mfma_f32_16x16x32_bf16 v[36:39], a[192:195], a[128:131], v[64:67]
    v_cvt_pk_bf16_f32 v30, v44, v45
    v_cvt_pk_bf16_f32 v31, v46, v47
    v_mfma_f32_16x16x32_bf16 v[36:39], a[196:199], a[132:135], v[36:39]
    v_add_f32 v20, v20, v42
    v_add_f32 v20, v20, v43
    v_mfma_f32_16x16x32_bf16 v[36:39], a[200:203], a[136:139], v[36:39]
    v_add_f32 v20, v20, v44
    v_add_f32 v20, v20, v45
    v_mfma_f32_16x16x32_bf16 v[36:39], a[204:207], a[140:143], v[36:39]
    v_add_f32 v20, v20, v46
    v_add_f32 v20, v20, v47
    v_mfma_f32_16x16x32_bf16 v[192:195], a[208:211], v[28:31], v[192:195]
    v_exp_f32 v32, v32
    v_mfma_f32_16x16x32_bf16 v[196:199], a[212:215], v[28:31], v[196:199]
    v_exp_f32 v33, v33
    v_mfma_f32_16x16x32_bf16 v[200:203], a[216:219], v[28:31], v[200:203]
    s_and_b32 s69, s29, s63
    v_exp_f32 v34, v34
    v_mfma_f32_16x16x32_bf16 v[204:207], a[220:223], v[28:31], v[204:207]
    s_add_u32 m0, s32, s69
    v_exp_f32 v35, v35
    v_mfma_f32_16x16x32_bf16 v[208:211], a[224:227], v[28:31], v[208:211]
    s_waitcnt vmcnt(3)
    buffer_load_dwordx4 v13, s[12:15], s29 offen nt lds
    v_mfma_f32_16x16x32_bf16 v[212:215], a[228:231], v[28:31], v[212:215]
    s_add_u32 s29, s29, s75
    v_exp_f32 v36, v36
    v_mfma_f32_16x16x32_bf16 v[216:219], a[232:235], v[28:31], v[216:219]
    v_exp_f32 v37, v37
    v_mfma_f32_16x16x32_bf16 v[220:223], a[236:239], v[28:31], v[220:223]
    v_cvt_pk_bf16_f32 v24, v32, v33
    v_cvt_pk_bf16_f32 v25, v34, v35
    v_mfma_f32_16x16x32_bf16 v[40:43], a[176:179], a[144:147], v[68:71]
    v_exp_f32 v38, v38
    v_mfma_f32_16x16x32_bf16 v[40:43], a[180:183], a[148:151], v[40:43]
    v_exp_f32 v39, v39
    v_mfma_f32_16x16x32_bf16 v[40:43], a[184:187], a[152:155], v[40:43]
    v_add_f32 v21, v21, v32
    v_add_f32 v21, v21, v33
    v_mfma_f32_16x16x32_bf16 v[40:43], a[188:191], a[156:159], v[40:43]
    v_cvt_pk_bf16_f32 v26, v36, v37
    v_cvt_pk_bf16_f32 v27, v38, v39
    v_mfma_f32_16x16x32_bf16 v[44:47], a[192:195], a[144:147], v[68:71]
    v_add_f32 v21, v21, v34
    v_add_f32 v21, v21, v35
    v_mfma_f32_16x16x32_bf16 v[44:47], a[196:199], a[148:151], v[44:47]
    s_and_b32 s69, s29, s63
    v_add_f32 v21, v21, v36
    v_add_f32 v21, v21, v37
    v_mfma_f32_16x16x32_bf16 v[44:47], a[200:203], a[152:155], v[44:47]
    s_add_u32 m0, s32, s69
    v_add_f32 v21, v21, v38
    v_add_f32 v21, v21, v39
    v_mfma_f32_16x16x32_bf16 v[44:47], a[204:207], a[156:159], v[44:47]
    s_waitcnt vmcnt(3)
    buffer_load_dwordx4 v14, s[12:15], s29 offen nt lds
    v_mfma_f32_16x16x32_bf16 v[224:227], a[208:211], v[24:27], v[224:227]
    s_barrier
    v_exp_f32 v40, v40
    v_mfma_f32_16x16x32_bf16 v[228:231], a[212:215], v[24:27], v[228:231]
    s_add_u32 s29, s29, s75
    v_exp_f32 v41, v41
    v_mfma_f32_16x16x32_bf16 v[232:235], a[216:219], v[24:27], v[232:235]
    v_exp_f32 v42, v42
    v_mfma_f32_16x16x32_bf16 v[236:239], a[220:223], v[24:27], v[236:239]
    v_exp_f32 v43, v43
    v_mfma_f32_16x16x32_bf16 v[240:243], a[224:227], v[24:27], v[240:243]
    v_exp_f32 v44, v44
    v_mfma_f32_16x16x32_bf16 v[244:247], a[228:231], v[24:27], v[244:247]
    v_exp_f32 v45, v45
    v_mfma_f32_16x16x32_bf16 v[248:251], a[232:235], v[24:27], v[248:251]
    v_cvt_pk_bf16_f32 v28, v40, v41
    v_cvt_pk_bf16_f32 v29, v42, v43
    v_mfma_f32_16x16x32_bf16 v[252:255], a[236:239], v[24:27], v[252:255]
    v_exp_f32 v46, v46
    v_mfma_f32_16x16x32_bf16 v[32:35], a[176:179], a[160:163], v[72:75]
    s_and_b32 s69, s29, s63
    v_exp_f32 v47, v47
    v_mfma_f32_16x16x32_bf16 v[32:35], a[180:183], a[164:167], v[32:35]
    s_add_u32 m0, s32, s69
    ds_read_b128 a[176:179], v1 offset:24576
    ds_read_b128 a[180:183], v2 offset:24576
    v_mfma_f32_16x16x32_bf16 v[32:35], a[184:187], a[168:171], v[32:35]
    s_waitcnt vmcnt(3)
    buffer_load_dwordx4 v13, s[12:15], s29 offen nt lds
    v_cvt_pk_bf16_f32 v30, v44, v45
    v_cvt_pk_bf16_f32 v31, v46, v47
    v_mfma_f32_16x16x32_bf16 v[32:35], a[188:191], a[172:175], v[32:35]
    s_add_u32 s29, s29, s75
    ds_read_b128 a[184:187], v3 offset:24576
    ds_read_b128 a[188:191], v4 offset:24576
    v_mfma_f32_16x16x32_bf16 v[36:39], a[192:195], a[160:163], v[72:75]
    ds_read_b128 a[192:195], v1 offset:28672
    v_add_f32 v22, v22, v40
    v_mfma_f32_16x16x32_bf16 v[36:39], a[196:199], a[164:167], v[36:39]
    ds_read_b128 a[196:199], v2 offset:28672
    v_add_f32 v22, v22, v41
    v_mfma_f32_16x16x32_bf16 v[36:39], a[200:203], a[168:171], v[36:39]
    ds_read_b128 a[200:203], v3 offset:28672
    v_add_f32 v22, v22, v42
    v_mfma_f32_16x16x32_bf16 v[36:39], a[204:207], a[172:175], v[36:39]
    ds_read_b128 a[204:207], v4 offset:28672
    v_add_f32 v22, v22, v43
    v_mfma_f32_16x16x32_bf16 a[0:3], a[208:211], v[28:31], a[0:3]
    v_exp_f32 v32, v32
    v_mfma_f32_16x16x32_bf16 a[4:7], a[212:215], v[28:31], a[4:7]
    v_exp_f32 v33, v33
    v_mfma_f32_16x16x32_bf16 a[8:11], a[216:219], v[28:31], a[8:11]
    v_exp_f32 v34, v34
    v_mfma_f32_16x16x32_bf16 a[12:15], a[220:223], v[28:31], a[12:15]
    v_exp_f32 v35, v35
    v_mfma_f32_16x16x32_bf16 a[16:19], a[224:227], v[28:31], a[16:19]
    v_add_f32 v22, v22, v44
    v_add_f32 v22, v22, v45
    v_mfma_f32_16x16x32_bf16 a[20:23], a[228:231], v[28:31], a[20:23]
    s_and_b32 s69, s29, s63
    v_exp_f32 v36, v36
    v_mfma_f32_16x16x32_bf16 a[24:27], a[232:235], v[28:31], a[24:27]
    s_add_u32 m0, s32, s69
    v_exp_f32 v37, v37
    v_mfma_f32_16x16x32_bf16 a[28:31], a[236:239], v[28:31], a[28:31]
    s_waitcnt lgkmcnt(7)
    s_waitcnt vmcnt(3)
    buffer_load_dwordx4 v14, s[12:15], s29 offen nt lds
    v_add_f32 v22, v22, v46
    v_add_f32 v22, v22, v47
    v_mfma_f32_16x16x32_bf16 v[40:43], a[176:179], a[64:67], v[48:51]
    s_waitcnt lgkmcnt(6)
    s_add_u32 s29, s29, s75
    v_cvt_pk_bf16_f32 v24, v32, v33
    v_cvt_pk_bf16_f32 v25, v34, v35
    v_mfma_f32_16x16x32_bf16 v[40:43], a[180:183], a[68:71], v[40:43]
    s_waitcnt lgkmcnt(5)
    v_exp_f32 v38, v38
    v_mfma_f32_16x16x32_bf16 v[40:43], a[184:187], a[72:75], v[40:43]
    s_waitcnt lgkmcnt(4)
    v_exp_f32 v39, v39
    v_mfma_f32_16x16x32_bf16 v[40:43], a[188:191], a[76:79], v[40:43]
    s_waitcnt lgkmcnt(3)
    v_add_f32 v23, v23, v32
    v_add_f32 v23, v23, v33
    v_mfma_f32_16x16x32_bf16 v[44:47], a[192:195], a[64:67], v[48:51]
    s_waitcnt lgkmcnt(2)
    v_cvt_pk_bf16_f32 v26, v36, v37
    v_cvt_pk_bf16_f32 v27, v38, v39
    v_mfma_f32_16x16x32_bf16 v[44:47], a[196:199], a[68:71], v[44:47]
    s_waitcnt lgkmcnt(1)
    v_add_f32 v23, v23, v34
    v_add_f32 v23, v23, v35
    v_mfma_f32_16x16x32_bf16 v[44:47], a[200:203], a[72:75], v[44:47]
    s_waitcnt lgkmcnt(0)
    v_add_f32 v23, v23, v36
    v_add_f32 v23, v23, v37
    v_mfma_f32_16x16x32_bf16 v[44:47], a[204:207], a[76:79], v[44:47]
    v_add_f32 v23, v23, v38
    v_add_f32 v23, v23, v39
    v_mfma_f32_16x16x32_bf16 a[32:35], a[208:211], v[24:27], a[32:35]
    ds_read_b64_tr_b16 a[208:209], v5 offset:24576
    ds_read_b64_tr_b16 a[210:211], v5 offset:28672
    v_mfma_f32_16x16x32_bf16 a[36:39], a[212:215], v[24:27], a[36:39]
    v_exp_f32 v40, v40
    v_mfma_f32_16x16x32_bf16 a[40:43], a[216:219], v[24:27], a[40:43]
    ds_read_b64_tr_b16 a[212:213], v6 offset:24576
    ds_read_b64_tr_b16 a[214:215], v6 offset:28672
    v_mfma_f32_16x16x32_bf16 a[44:47], a[220:223], v[24:27], a[44:47]
    v_exp_f32 v41, v41
    v_mfma_f32_16x16x32_bf16 a[48:51], a[224:227], v[24:27], a[48:51]
    v_exp_f32 v42, v42
    v_mfma_f32_16x16x32_bf16 a[52:55], a[228:231], v[24:27], a[52:55]
    ds_read_b64_tr_b16 a[216:217], v7 offset:24576
    ds_read_b64_tr_b16 a[218:219], v7 offset:28672
    v_mfma_f32_16x16x32_bf16 a[56:59], a[232:235], v[24:27], a[56:59]
    v_exp_f32 v43, v43
    v_mfma_f32_16x16x32_bf16 a[60:63], a[236:239], v[24:27], a[60:63]
    v_exp_f32 v44, v44
    v_mfma_f32_16x16x32_bf16 v[32:35], a[176:179], a[80:83], v[52:55]
    ds_read_b64_tr_b16 a[220:221], v8 offset:24576
    ds_read_b64_tr_b16 a[222:223], v8 offset:28672
    v_mfma_f32_16x16x32_bf16 v[32:35], a[180:183], a[84:87], v[32:35]
    v_exp_f32 v45, v45
    v_mfma_f32_16x16x32_bf16 v[32:35], a[184:187], a[88:91], v[32:35]
    ds_read_b64_tr_b16 a[224:225], v9 offset:24576
    v_cvt_pk_bf16_f32 v28, v40, v41
    v_mfma_f32_16x16x32_bf16 v[32:35], a[188:191], a[92:95], v[32:35]
    v_exp_f32 v46, v46
    v_mfma_f32_16x16x32_bf16 v[36:39], a[192:195], a[80:83], v[52:55]
    s_and_b32 s69, s29, s63
    ds_read_b64_tr_b16 a[226:227], v9 offset:28672
    v_cvt_pk_bf16_f32 v29, v42, v43
    v_mfma_f32_16x16x32_bf16 v[36:39], a[196:199], a[84:87], v[36:39]
    s_add_u32 m0, s32, s69
    v_exp_f32 v47, v47
    v_mfma_f32_16x16x32_bf16 v[36:39], a[200:203], a[88:91], v[36:39]
    s_waitcnt vmcnt(3)
    buffer_load_dwordx4 v13, s[12:15], s29 offen nt lds
    v_cvt_pk_bf16_f32 v30, v44, v45
    v_cvt_pk_bf16_f32 v31, v46, v47
    v_mfma_f32_16x16x32_bf16 v[36:39], a[204:207], a[92:95], v[36:39]
    s_waitcnt lgkmcnt(8)
    s_add_u32 s29, s29, s75
    ds_read_b64_tr_b16 a[228:229], v10 offset:24576
    ds_read_b64_tr_b16 a[230:231], v10 offset:28672
    v_mfma_f32_16x16x32_bf16 v[96:99], a[208:211], v[28:31], v[96:99]
    s_waitcnt lgkmcnt(8)
    ds_read_b64_tr_b16 a[232:233], v11 offset:24576
    ds_read_b64_tr_b16 a[234:235], v11 offset:28672
    v_mfma_f32_16x16x32_bf16 v[100:103], a[212:215], v[28:31], v[100:103]
    s_waitcnt lgkmcnt(8)
    ds_read_b64_tr_b16 a[236:237], v12 offset:24576
    ds_read_b64_tr_b16 a[238:239], v12 offset:28672
    v_mfma_f32_16x16x32_bf16 v[104:107], a[216:219], v[28:31], v[104:107]
    s_waitcnt lgkmcnt(8)
    v_exp_f32 v32, v32
    v_mfma_f32_16x16x32_bf16 v[108:111], a[220:223], v[28:31], v[108:111]
    s_waitcnt lgkmcnt(6)
    v_exp_f32 v33, v33
    v_mfma_f32_16x16x32_bf16 v[112:115], a[224:227], v[28:31], v[112:115]
    s_waitcnt lgkmcnt(4)
    v_add_f32 v17, v17, v40
    v_add_f32 v17, v17, v41
    v_mfma_f32_16x16x32_bf16 v[116:119], a[228:231], v[28:31], v[116:119]
    s_waitcnt lgkmcnt(2)
    v_add_f32 v17, v17, v42
    v_add_f32 v17, v17, v43
    v_mfma_f32_16x16x32_bf16 v[120:123], a[232:235], v[28:31], v[120:123]
    s_waitcnt lgkmcnt(0)
    v_exp_f32 v34, v34
    v_mfma_f32_16x16x32_bf16 v[124:127], a[236:239], v[28:31], v[124:127]
    v_exp_f32 v35, v35
    v_mfma_f32_16x16x32_bf16 v[40:43], a[176:179], a[96:99], v[56:59]
    v_exp_f32 v36, v36
    v_mfma_f32_16x16x32_bf16 v[40:43], a[180:183], a[100:103], v[40:43]
    s_and_b32 s69, s29, s63
    v_add_f32 v17, v17, v44
    v_add_f32 v17, v17, v45
    v_mfma_f32_16x16x32_bf16 v[40:43], a[184:187], a[104:107], v[40:43]
    s_add_u32 m0, s32, s69
    v_exp_f32 v37, v37
    v_mfma_f32_16x16x32_bf16 v[40:43], a[188:191], a[108:111], v[40:43]
    s_waitcnt vmcnt(3)
    buffer_load_dwordx4 v14, s[12:15], s29 offen nt lds
    v_add_f32 v17, v17, v46
    v_add_f32 v17, v17, v47
    v_mfma_f32_16x16x32_bf16 v[44:47], a[192:195], a[96:99], v[56:59]
    s_add_u32 s29, s29, s75
    v_exp_f32 v38, v38
    v_mfma_f32_16x16x32_bf16 v[44:47], a[196:199], a[100:103], v[44:47]
    v_exp_f32 v39, v39
    v_cvt_pk_bf16_f32 v24, v32, v33
    v_mfma_f32_16x16x32_bf16 v[44:47], a[200:203], a[104:107], v[44:47]
    v_cvt_pk_bf16_f32 v25, v34, v35
    v_cvt_pk_bf16_f32 v26, v36, v37
    v_cvt_pk_bf16_f32 v27, v38, v39
    v_mfma_f32_16x16x32_bf16 v[44:47], a[204:207], a[108:111], v[44:47]
    v_add_f32 v18, v18, v32
    v_add_f32 v18, v18, v33
    v_mfma_f32_16x16x32_bf16 v[128:131], a[208:211], v[24:27], v[128:131]
    v_exp_f32 v40, v40
    v_mfma_f32_16x16x32_bf16 v[132:135], a[212:215], v[24:27], v[132:135]
    v_exp_f32 v41, v41
    v_mfma_f32_16x16x32_bf16 v[136:139], a[216:219], v[24:27], v[136:139]
    v_add_f32 v18, v18, v34
    v_add_f32 v18, v18, v35
    v_mfma_f32_16x16x32_bf16 v[140:143], a[220:223], v[24:27], v[140:143]
    v_exp_f32 v42, v42
    v_mfma_f32_16x16x32_bf16 v[144:147], a[224:227], v[24:27], v[144:147]
    v_exp_f32 v43, v43
    v_mfma_f32_16x16x32_bf16 v[148:151], a[228:231], v[24:27], v[148:151]
    v_add_f32 v18, v18, v36
    v_add_f32 v18, v18, v37
    v_mfma_f32_16x16x32_bf16 v[152:155], a[232:235], v[24:27], v[152:155]
    s_and_b32 s69, s29, s63
    v_exp_f32 v44, v44
    v_mfma_f32_16x16x32_bf16 v[156:159], a[236:239], v[24:27], v[156:159]
    s_add_u32 m0, s32, s69
    v_exp_f32 v45, v45
    v_mfma_f32_16x16x32_bf16 v[32:35], a[176:179], a[112:115], v[60:63]
    s_waitcnt vmcnt(3)
    buffer_load_dwordx4 v13, s[12:15], s29 offen nt lds
    v_add_f32 v18, v18, v38
    v_add_f32 v18, v18, v39
    v_mfma_f32_16x16x32_bf16 v[32:35], a[180:183], a[116:119], v[32:35]
    s_add_u32 s29, s29, s75
    v_cvt_pk_bf16_f32 v28, v40, v41
    v_cvt_pk_bf16_f32 v29, v42, v43
    v_mfma_f32_16x16x32_bf16 v[32:35], a[184:187], a[120:123], v[32:35]
    v_exp_f32 v46, v46
    v_mfma_f32_16x16x32_bf16 v[32:35], a[188:191], a[124:127], v[32:35]
    v_exp_f32 v47, v47
    v_mfma_f32_16x16x32_bf16 v[36:39], a[192:195], a[112:115], v[60:63]
    v_add_f32 v19, v19, v40
    v_add_f32 v19, v19, v41
    v_mfma_f32_16x16x32_bf16 v[36:39], a[196:199], a[116:119], v[36:39]
    v_cvt_pk_bf16_f32 v30, v44, v45
    v_cvt_pk_bf16_f32 v31, v46, v47
    v_mfma_f32_16x16x32_bf16 v[36:39], a[200:203], a[120:123], v[36:39]
    v_add_f32 v19, v19, v42
    v_add_f32 v19, v19, v43
    v_mfma_f32_16x16x32_bf16 v[36:39], a[204:207], a[124:127], v[36:39]
    v_add_f32 v19, v19, v44
    v_add_f32 v19, v19, v45
    v_mfma_f32_16x16x32_bf16 v[160:163], a[208:211], v[28:31], v[160:163]
    v_exp_f32 v32, v32
    v_mfma_f32_16x16x32_bf16 v[164:167], a[212:215], v[28:31], v[164:167]
    v_exp_f32 v33, v33
    v_mfma_f32_16x16x32_bf16 v[168:171], a[216:219], v[28:31], v[168:171]
    s_and_b32 s69, s29, s63
    v_exp_f32 v34, v34
    v_mfma_f32_16x16x32_bf16 v[172:175], a[220:223], v[28:31], v[172:175]
    s_add_u32 m0, s32, s69
    v_exp_f32 v35, v35
    v_mfma_f32_16x16x32_bf16 v[176:179], a[224:227], v[28:31], v[176:179]
    s_waitcnt vmcnt(3)
    buffer_load_dwordx4 v14, s[12:15], s29 offen nt lds
    v_mfma_f32_16x16x32_bf16 v[180:183], a[228:231], v[28:31], v[180:183]
    s_add_u32 s29, s29, s75
    v_exp_f32 v36, v36
    v_mfma_f32_16x16x32_bf16 v[184:187], a[232:235], v[28:31], v[184:187]
    v_exp_f32 v37, v37
    v_mfma_f32_16x16x32_bf16 v[188:191], a[236:239], v[28:31], v[188:191]
    v_add_f32 v19, v19, v46
    v_add_f32 v19, v19, v47
    v_mfma_f32_16x16x32_bf16 v[40:43], a[176:179], a[128:131], v[64:67]
    v_cvt_pk_bf16_f32 v24, v32, v33
    v_cvt_pk_bf16_f32 v25, v34, v35
    v_mfma_f32_16x16x32_bf16 v[40:43], a[180:183], a[132:135], v[40:43]
    v_exp_f32 v38, v38
    v_mfma_f32_16x16x32_bf16 v[40:43], a[184:187], a[136:139], v[40:43]
    v_exp_f32 v39, v39
    v_mfma_f32_16x16x32_bf16 v[40:43], a[188:191], a[140:143], v[40:43]
    v_add_f32 v20, v20, v32
    v_add_f32 v20, v20, v33
    v_mfma_f32_16x16x32_bf16 v[44:47], a[192:195], a[128:131], v[64:67]
    v_cvt_pk_bf16_f32 v26, v36, v37
    v_cvt_pk_bf16_f32 v27, v38, v39
    v_mfma_f32_16x16x32_bf16 v[44:47], a[196:199], a[132:135], v[44:47]
    v_add_f32 v20, v20, v34
    v_add_f32 v20, v20, v35
    v_mfma_f32_16x16x32_bf16 v[44:47], a[200:203], a[136:139], v[44:47]
    v_add_f32 v20, v20, v36
    v_add_f32 v20, v20, v37
    v_mfma_f32_16x16x32_bf16 v[44:47], a[204:207], a[140:143], v[44:47]
    v_add_f32 v20, v20, v38
    v_add_f32 v20, v20, v39
    v_mfma_f32_16x16x32_bf16 v[192:195], a[208:211], v[24:27], v[192:195]
    v_exp_f32 v40, v40
    v_mfma_f32_16x16x32_bf16 v[196:199], a[212:215], v[24:27], v[196:199]
    v_exp_f32 v41, v41
    v_mfma_f32_16x16x32_bf16 v[200:203], a[216:219], v[24:27], v[200:203]
    s_and_b32 s69, s29, s63
    v_exp_f32 v42, v42
    v_mfma_f32_16x16x32_bf16 v[204:207], a[220:223], v[24:27], v[204:207]
    s_add_u32 m0, s32, s69
    v_exp_f32 v43, v43
    v_mfma_f32_16x16x32_bf16 v[208:211], a[224:227], v[24:27], v[208:211]
    s_waitcnt vmcnt(3)
    buffer_load_dwordx4 v13, s[12:15], s29 offen nt lds
    v_mfma_f32_16x16x32_bf16 v[212:215], a[228:231], v[24:27], v[212:215]
    s_add_u32 s29, s29, s75
    v_exp_f32 v44, v44
    v_mfma_f32_16x16x32_bf16 v[216:219], a[232:235], v[24:27], v[216:219]
    v_exp_f32 v45, v45
    v_mfma_f32_16x16x32_bf16 v[220:223], a[236:239], v[24:27], v[220:223]
    v_cvt_pk_bf16_f32 v28, v40, v41
    v_cvt_pk_bf16_f32 v29, v42, v43
    v_mfma_f32_16x16x32_bf16 v[32:35], a[176:179], a[144:147], v[68:71]
    v_exp_f32 v46, v46
    v_mfma_f32_16x16x32_bf16 v[32:35], a[180:183], a[148:151], v[32:35]
    v_exp_f32 v47, v47
    v_mfma_f32_16x16x32_bf16 v[32:35], a[184:187], a[152:155], v[32:35]
    v_add_f32 v21, v21, v40
    v_add_f32 v21, v21, v41
    v_mfma_f32_16x16x32_bf16 v[32:35], a[188:191], a[156:159], v[32:35]
    v_cvt_pk_bf16_f32 v30, v44, v45
    v_cvt_pk_bf16_f32 v31, v46, v47
    v_mfma_f32_16x16x32_bf16 v[36:39], a[192:195], a[144:147], v[68:71]
    v_add_f32 v21, v21, v42
    v_add_f32 v21, v21, v43
    v_mfma_f32_16x16x32_bf16 v[36:39], a[196:199], a[148:151], v[36:39]
    s_and_b32 s69, s29, s63
    v_add_f32 v21, v21, v44
    v_add_f32 v21, v21, v45
    v_mfma_f32_16x16x32_bf16 v[36:39], a[200:203], a[152:155], v[36:39]
    s_add_u32 m0, s32, s69
    v_add_f32 v21, v21, v46
    v_add_f32 v21, v21, v47
    v_mfma_f32_16x16x32_bf16 v[36:39], a[204:207], a[156:159], v[36:39]
    s_waitcnt vmcnt(3)
    buffer_load_dwordx4 v14, s[12:15], s29 offen nt lds
    v_mfma_f32_16x16x32_bf16 v[224:227], a[208:211], v[28:31], v[224:227]
    s_barrier
    v_exp_f32 v32, v32
    v_mfma_f32_16x16x32_bf16 v[228:231], a[212:215], v[28:31], v[228:231]
    s_add_u32 s29, s29, s75
    v_exp_f32 v33, v33
    v_mfma_f32_16x16x32_bf16 v[232:235], a[216:219], v[28:31], v[232:235]
    v_exp_f32 v34, v34
    v_mfma_f32_16x16x32_bf16 v[236:239], a[220:223], v[28:31], v[236:239]
    v_exp_f32 v35, v35
    v_mfma_f32_16x16x32_bf16 v[240:243], a[224:227], v[28:31], v[240:243]
    v_exp_f32 v36, v36
    v_mfma_f32_16x16x32_bf16 v[244:247], a[228:231], v[28:31], v[244:247]
    v_exp_f32 v37, v37
    v_mfma_f32_16x16x32_bf16 v[248:251], a[232:235], v[28:31], v[248:251]
    v_cvt_pk_bf16_f32 v24, v32, v33
    v_cvt_pk_bf16_f32 v25, v34, v35
    v_mfma_f32_16x16x32_bf16 v[252:255], a[236:239], v[28:31], v[252:255]
    v_exp_f32 v38, v38
    v_mfma_f32_16x16x32_bf16 v[40:43], a[176:179], a[160:163], v[72:75]
    s_and_b32 s69, s29, s63
    v_exp_f32 v39, v39
    v_mfma_f32_16x16x32_bf16 v[40:43], a[180:183], a[164:167], v[40:43]
    s_add_u32 m0, s32, s69
    ds_read_b128 a[176:179], v1
    ds_read_b128 a[180:183], v2
    v_mfma_f32_16x16x32_bf16 v[40:43], a[184:187], a[168:171], v[40:43]
    s_waitcnt vmcnt(3)
    buffer_load_dwordx4 v13, s[12:15], s29 offen nt lds
    v_cvt_pk_bf16_f32 v26, v36, v37
    v_cvt_pk_bf16_f32 v27, v38, v39
    v_mfma_f32_16x16x32_bf16 v[40:43], a[188:191], a[172:175], v[40:43]
    s_add_u32 s29, s29, s75
    ds_read_b128 a[184:187], v3
    ds_read_b128 a[188:191], v4
    v_mfma_f32_16x16x32_bf16 v[44:47], a[192:195], a[160:163], v[72:75]
    ds_read_b128 a[192:195], v1 offset:4096
    v_add_f32 v22, v22, v32
    v_mfma_f32_16x16x32_bf16 v[44:47], a[196:199], a[164:167], v[44:47]
    ds_read_b128 a[196:199], v2 offset:4096
    v_add_f32 v22, v22, v33
    v_mfma_f32_16x16x32_bf16 v[44:47], a[200:203], a[168:171], v[44:47]
    ds_read_b128 a[200:203], v3 offset:4096
    v_add_f32 v22, v22, v34
    v_mfma_f32_16x16x32_bf16 v[44:47], a[204:207], a[172:175], v[44:47]
    ds_read_b128 a[204:207], v4 offset:4096
    v_add_f32 v22, v22, v35
    v_mfma_f32_16x16x32_bf16 a[0:3], a[208:211], v[24:27], a[0:3]
    v_exp_f32 v40, v40
    v_mfma_f32_16x16x32_bf16 a[4:7], a[212:215], v[24:27], a[4:7]
    v_exp_f32 v41, v41
    v_mfma_f32_16x16x32_bf16 a[8:11], a[216:219], v[24:27], a[8:11]
    v_exp_f32 v42, v42
    v_mfma_f32_16x16x32_bf16 a[12:15], a[220:223], v[24:27], a[12:15]
    v_exp_f32 v43, v43
    v_mfma_f32_16x16x32_bf16 a[16:19], a[224:227], v[24:27], a[16:19]
    v_add_f32 v22, v22, v36
    v_add_f32 v22, v22, v37
    v_mfma_f32_16x16x32_bf16 a[20:23], a[228:231], v[24:27], a[20:23]
    s_and_b32 s69, s29, s63
    v_exp_f32 v44, v44
    v_mfma_f32_16x16x32_bf16 a[24:27], a[232:235], v[24:27], a[24:27]
    s_add_u32 m0, s32, s69
    v_exp_f32 v45, v45
    v_mfma_f32_16x16x32_bf16 a[28:31], a[236:239], v[24:27], a[28:31]
    s_waitcnt lgkmcnt(7)
    s_waitcnt vmcnt(3)
    buffer_load_dwordx4 v14, s[12:15], s29 offen nt lds
    v_add_f32 v22, v22, v38
    v_add_f32 v22, v22, v39
    v_mfma_f32_16x16x32_bf16 v[32:35], a[176:179], a[64:67], v[48:51]
    s_waitcnt lgkmcnt(6)
    s_add_u32 s29, s29, s75
    v_cvt_pk_bf16_f32 v28, v40, v41
    v_cvt_pk_bf16_f32 v29, v42, v43
    v_mfma_f32_16x16x32_bf16 v[32:35], a[180:183], a[68:71], v[32:35]
    s_waitcnt lgkmcnt(5)
    v_exp_f32 v46, v46
    v_mfma_f32_16x16x32_bf16 v[32:35], a[184:187], a[72:75], v[32:35]
    s_waitcnt lgkmcnt(4)
    v_exp_f32 v47, v47
    v_mfma_f32_16x16x32_bf16 v[32:35], a[188:191], a[76:79], v[32:35]
    s_waitcnt lgkmcnt(3)
    v_add_f32 v23, v23, v40
    v_add_f32 v23, v23, v41
    v_mfma_f32_16x16x32_bf16 v[36:39], a[192:195], a[64:67], v[48:51]
    s_waitcnt lgkmcnt(2)
    v_cvt_pk_bf16_f32 v30, v44, v45
    v_cvt_pk_bf16_f32 v31, v46, v47
    v_mfma_f32_16x16x32_bf16 v[36:39], a[196:199], a[68:71], v[36:39]
    s_waitcnt lgkmcnt(1)
    v_add_f32 v23, v23, v42
    v_add_f32 v23, v23, v43
    v_mfma_f32_16x16x32_bf16 v[36:39], a[200:203], a[72:75], v[36:39]
    s_waitcnt lgkmcnt(0)
    v_add_f32 v23, v23, v44
    v_add_f32 v23, v23, v45
    v_mfma_f32_16x16x32_bf16 v[36:39], a[204:207], a[76:79], v[36:39]
    v_add_f32 v23, v23, v46
    v_add_f32 v23, v23, v47
    v_mfma_f32_16x16x32_bf16 a[32:35], a[208:211], v[28:31], a[32:35]
    ds_read_b64_tr_b16 a[208:209], v5
    ds_read_b64_tr_b16 a[210:211], v5 offset:4096
    v_mfma_f32_16x16x32_bf16 a[36:39], a[212:215], v[28:31], a[36:39]
    v_exp_f32 v32, v32
    v_mfma_f32_16x16x32_bf16 a[40:43], a[216:219], v[28:31], a[40:43]
    ds_read_b64_tr_b16 a[212:213], v6
    ds_read_b64_tr_b16 a[214:215], v6 offset:4096
    v_mfma_f32_16x16x32_bf16 a[44:47], a[220:223], v[28:31], a[44:47]
    v_exp_f32 v33, v33
    v_mfma_f32_16x16x32_bf16 a[48:51], a[224:227], v[28:31], a[48:51]
    v_exp_f32 v34, v34
    v_mfma_f32_16x16x32_bf16 a[52:55], a[228:231], v[28:31], a[52:55]
    ds_read_b64_tr_b16 a[216:217], v7
    ds_read_b64_tr_b16 a[218:219], v7 offset:4096
    v_mfma_f32_16x16x32_bf16 a[56:59], a[232:235], v[28:31], a[56:59]
    v_exp_f32 v35, v35
    v_mfma_f32_16x16x32_bf16 a[60:63], a[236:239], v[28:31], a[60:63]
    v_exp_f32 v36, v36
    v_mfma_f32_16x16x32_bf16 v[40:43], a[176:179], a[80:83], v[52:55]
    ds_read_b64_tr_b16 a[220:221], v8
    ds_read_b64_tr_b16 a[222:223], v8 offset:4096
    v_mfma_f32_16x16x32_bf16 v[40:43], a[180:183], a[84:87], v[40:43]
    v_exp_f32 v37, v37
    v_mfma_f32_16x16x32_bf16 v[40:43], a[184:187], a[88:91], v[40:43]
    ds_read_b64_tr_b16 a[224:225], v9
    v_cvt_pk_bf16_f32 v24, v32, v33
    v_mfma_f32_16x16x32_bf16 v[40:43], a[188:191], a[92:95], v[40:43]
    v_exp_f32 v38, v38
    v_mfma_f32_16x16x32_bf16 v[44:47], a[192:195], a[80:83], v[52:55]
    s_and_b32 s69, s29, s63
    ds_read_b64_tr_b16 a[226:227], v9 offset:4096
    v_cvt_pk_bf16_f32 v25, v34, v35
    v_mfma_f32_16x16x32_bf16 v[44:47], a[196:199], a[84:87], v[44:47]
    s_add_u32 m0, s32, s69
    v_exp_f32 v39, v39
    v_mfma_f32_16x16x32_bf16 v[44:47], a[200:203], a[88:91], v[44:47]
    s_waitcnt vmcnt(3)
    buffer_load_dwordx4 v13, s[12:15], s29 offen nt lds
    v_cvt_pk_bf16_f32 v26, v36, v37
    v_cvt_pk_bf16_f32 v27, v38, v39
    v_mfma_f32_16x16x32_bf16 v[44:47], a[204:207], a[92:95], v[44:47]
    s_waitcnt lgkmcnt(8)
    s_add_u32 s29, s29, s75
    ds_read_b64_tr_b16 a[228:229], v10
    ds_read_b64_tr_b16 a[230:231], v10 offset:4096
    v_mfma_f32_16x16x32_bf16 v[96:99], a[208:211], v[24:27], v[96:99]
    s_waitcnt lgkmcnt(8)
    ds_read_b64_tr_b16 a[232:233], v11
    ds_read_b64_tr_b16 a[234:235], v11 offset:4096
    v_mfma_f32_16x16x32_bf16 v[100:103], a[212:215], v[24:27], v[100:103]
    s_waitcnt lgkmcnt(8)
    ds_read_b64_tr_b16 a[236:237], v12
    ds_read_b64_tr_b16 a[238:239], v12 offset:4096
    v_mfma_f32_16x16x32_bf16 v[104:107], a[216:219], v[24:27], v[104:107]
    s_waitcnt lgkmcnt(8)
    v_exp_f32 v40, v40
    v_mfma_f32_16x16x32_bf16 v[108:111], a[220:223], v[24:27], v[108:111]
    s_waitcnt lgkmcnt(6)
    v_exp_f32 v41, v41
    v_mfma_f32_16x16x32_bf16 v[112:115], a[224:227], v[24:27], v[112:115]
    s_waitcnt lgkmcnt(4)
    v_add_f32 v17, v17, v32
    v_add_f32 v17, v17, v33
    v_mfma_f32_16x16x32_bf16 v[116:119], a[228:231], v[24:27], v[116:119]
    s_waitcnt lgkmcnt(2)
    v_add_f32 v17, v17, v34
    v_add_f32 v17, v17, v35
    v_mfma_f32_16x16x32_bf16 v[120:123], a[232:235], v[24:27], v[120:123]
    s_waitcnt lgkmcnt(0)
    v_exp_f32 v42, v42
    v_mfma_f32_16x16x32_bf16 v[124:127], a[236:239], v[24:27], v[124:127]
    v_exp_f32 v43, v43
    v_mfma_f32_16x16x32_bf16 v[32:35], a[176:179], a[96:99], v[56:59]
    v_exp_f32 v44, v44
    v_mfma_f32_16x16x32_bf16 v[32:35], a[180:183], a[100:103], v[32:35]
    s_and_b32 s69, s29, s63
    v_add_f32 v17, v17, v36
    v_add_f32 v17, v17, v37
    v_mfma_f32_16x16x32_bf16 v[32:35], a[184:187], a[104:107], v[32:35]
    s_add_u32 m0, s32, s69
    v_exp_f32 v45, v45
    v_mfma_f32_16x16x32_bf16 v[32:35], a[188:191], a[108:111], v[32:35]
    s_waitcnt vmcnt(3)
    buffer_load_dwordx4 v14, s[12:15], s29 offen nt lds
    v_add_f32 v17, v17, v38
    v_add_f32 v17, v17, v39
    v_mfma_f32_16x16x32_bf16 v[36:39], a[192:195], a[96:99], v[56:59]
    s_add_u32 s29, s29, s75
    v_exp_f32 v46, v46
    v_mfma_f32_16x16x32_bf16 v[36:39], a[196:199], a[100:103], v[36:39]
    v_exp_f32 v47, v47
    v_cvt_pk_bf16_f32 v28, v40, v41
    v_mfma_f32_16x16x32_bf16 v[36:39], a[200:203], a[104:107], v[36:39]
    v_cvt_pk_bf16_f32 v29, v42, v43
    v_cvt_pk_bf16_f32 v30, v44, v45
    v_cvt_pk_bf16_f32 v31, v46, v47
    v_mfma_f32_16x16x32_bf16 v[36:39], a[204:207], a[108:111], v[36:39]
    v_add_f32 v18, v18, v40
    v_add_f32 v18, v18, v41
    v_mfma_f32_16x16x32_bf16 v[128:131], a[208:211], v[28:31], v[128:131]
    v_exp_f32 v32, v32
    v_mfma_f32_16x16x32_bf16 v[132:135], a[212:215], v[28:31], v[132:135]
    v_exp_f32 v33, v33
    v_mfma_f32_16x16x32_bf16 v[136:139], a[216:219], v[28:31], v[136:139]
    v_add_f32 v18, v18, v42
    v_add_f32 v18, v18, v43
    v_mfma_f32_16x16x32_bf16 v[140:143], a[220:223], v[28:31], v[140:143]
    v_exp_f32 v34, v34
    v_mfma_f32_16x16x32_bf16 v[144:147], a[224:227], v[28:31], v[144:147]
    v_exp_f32 v35, v35
    v_mfma_f32_16x16x32_bf16 v[148:151], a[228:231], v[28:31], v[148:151]
    v_add_f32 v18, v18, v44
    v_add_f32 v18, v18, v45
    v_mfma_f32_16x16x32_bf16 v[152:155], a[232:235], v[28:31], v[152:155]
    s_and_b32 s69, s29, s63
    v_exp_f32 v36, v36
    v_mfma_f32_16x16x32_bf16 v[156:159], a[236:239], v[28:31], v[156:159]
    s_add_u32 m0, s32, s69
    v_exp_f32 v37, v37
    v_mfma_f32_16x16x32_bf16 v[40:43], a[176:179], a[112:115], v[60:63]
    s_waitcnt vmcnt(3)
    buffer_load_dwordx4 v13, s[12:15], s29 offen nt lds
    v_add_f32 v18, v18, v46
    v_add_f32 v18, v18, v47
    v_mfma_f32_16x16x32_bf16 v[40:43], a[180:183], a[116:119], v[40:43]
    s_add_u32 s29, s29, s75
    v_cvt_pk_bf16_f32 v24, v32, v33
    v_cvt_pk_bf16_f32 v25, v34, v35
    v_mfma_f32_16x16x32_bf16 v[40:43], a[184:187], a[120:123], v[40:43]
    v_exp_f32 v38, v38
    v_mfma_f32_16x16x32_bf16 v[40:43], a[188:191], a[124:127], v[40:43]
    v_exp_f32 v39, v39
    v_mfma_f32_16x16x32_bf16 v[44:47], a[192:195], a[112:115], v[60:63]
    v_add_f32 v19, v19, v32
    v_add_f32 v19, v19, v33
    v_mfma_f32_16x16x32_bf16 v[44:47], a[196:199], a[116:119], v[44:47]
    v_cvt_pk_bf16_f32 v26, v36, v37
    v_cvt_pk_bf16_f32 v27, v38, v39
    v_mfma_f32_16x16x32_bf16 v[44:47], a[200:203], a[120:123], v[44:47]
    v_add_f32 v19, v19, v34
    v_add_f32 v19, v19, v35
    v_mfma_f32_16x16x32_bf16 v[44:47], a[204:207], a[124:127], v[44:47]
    v_add_f32 v19, v19, v36
    v_add_f32 v19, v19, v37
    v_mfma_f32_16x16x32_bf16 v[160:163], a[208:211], v[24:27], v[160:163]
    v_exp_f32 v40, v40
    v_mfma_f32_16x16x32_bf16 v[164:167], a[212:215], v[24:27], v[164:167]
    v_exp_f32 v41, v41
    v_mfma_f32_16x16x32_bf16 v[168:171], a[216:219], v[24:27], v[168:171]
    s_and_b32 s69, s29, s63
    v_exp_f32 v42, v42
    v_mfma_f32_16x16x32_bf16 v[172:175], a[220:223], v[24:27], v[172:175]
    s_add_u32 m0, s32, s69
    v_exp_f32 v43, v43
    v_mfma_f32_16x16x32_bf16 v[176:179], a[224:227], v[24:27], v[176:179]
    s_waitcnt vmcnt(3)
    buffer_load_dwordx4 v14, s[12:15], s29 offen nt lds
    v_mfma_f32_16x16x32_bf16 v[180:183], a[228:231], v[24:27], v[180:183]
    s_add_u32 s29, s29, s75
    v_exp_f32 v44, v44
    v_mfma_f32_16x16x32_bf16 v[184:187], a[232:235], v[24:27], v[184:187]
    v_exp_f32 v45, v45
    v_mfma_f32_16x16x32_bf16 v[188:191], a[236:239], v[24:27], v[188:191]
    v_add_f32 v19, v19, v38
    v_add_f32 v19, v19, v39
    v_mfma_f32_16x16x32_bf16 v[32:35], a[176:179], a[128:131], v[64:67]
    v_cvt_pk_bf16_f32 v28, v40, v41
    v_cvt_pk_bf16_f32 v29, v42, v43
    v_mfma_f32_16x16x32_bf16 v[32:35], a[180:183], a[132:135], v[32:35]
    v_exp_f32 v46, v46
    v_mfma_f32_16x16x32_bf16 v[32:35], a[184:187], a[136:139], v[32:35]
    v_exp_f32 v47, v47
    v_mfma_f32_16x16x32_bf16 v[32:35], a[188:191], a[140:143], v[32:35]
    v_add_f32 v20, v20, v40
    v_add_f32 v20, v20, v41
    v_mfma_f32_16x16x32_bf16 v[36:39], a[192:195], a[128:131], v[64:67]
    v_cvt_pk_bf16_f32 v30, v44, v45
    v_cvt_pk_bf16_f32 v31, v46, v47
    v_mfma_f32_16x16x32_bf16 v[36:39], a[196:199], a[132:135], v[36:39]
    v_add_f32 v20, v20, v42
    v_add_f32 v20, v20, v43
    v_mfma_f32_16x16x32_bf16 v[36:39], a[200:203], a[136:139], v[36:39]
    v_add_f32 v20, v20, v44
    v_add_f32 v20, v20, v45
    v_mfma_f32_16x16x32_bf16 v[36:39], a[204:207], a[140:143], v[36:39]
    v_add_f32 v20, v20, v46
    v_add_f32 v20, v20, v47
    v_mfma_f32_16x16x32_bf16 v[192:195], a[208:211], v[28:31], v[192:195]
    v_exp_f32 v32, v32
    v_mfma_f32_16x16x32_bf16 v[196:199], a[212:215], v[28:31], v[196:199]
    v_exp_f32 v33, v33
    v_mfma_f32_16x16x32_bf16 v[200:203], a[216:219], v[28:31], v[200:203]
    s_and_b32 s69, s29, s63
    v_exp_f32 v34, v34
    v_mfma_f32_16x16x32_bf16 v[204:207], a[220:223], v[28:31], v[204:207]
    s_add_u32 m0, s32, s69
    v_exp_f32 v35, v35
    v_mfma_f32_16x16x32_bf16 v[208:211], a[224:227], v[28:31], v[208:211]
    s_waitcnt vmcnt(3)
    buffer_load_dwordx4 v13, s[12:15], s29 offen nt lds
    v_mfma_f32_16x16x32_bf16 v[212:215], a[228:231], v[28:31], v[212:215]
    s_add_u32 s29, s29, s75
    v_exp_f32 v36, v36
    v_mfma_f32_16x16x32_bf16 v[216:219], a[232:235], v[28:31], v[216:219]
    v_exp_f32 v37, v37
    v_mfma_f32_16x16x32_bf16 v[220:223], a[236:239], v[28:31], v[220:223]
    v_cvt_pk_bf16_f32 v24, v32, v33
    v_cvt_pk_bf16_f32 v25, v34, v35
    v_mfma_f32_16x16x32_bf16 v[40:43], a[176:179], a[144:147], v[68:71]
    v_exp_f32 v38, v38
    v_mfma_f32_16x16x32_bf16 v[40:43], a[180:183], a[148:151], v[40:43]
    v_exp_f32 v39, v39
    v_mfma_f32_16x16x32_bf16 v[40:43], a[184:187], a[152:155], v[40:43]
    v_add_f32 v21, v21, v32
    v_add_f32 v21, v21, v33
    v_mfma_f32_16x16x32_bf16 v[40:43], a[188:191], a[156:159], v[40:43]
    v_cvt_pk_bf16_f32 v26, v36, v37
    v_cvt_pk_bf16_f32 v27, v38, v39
    v_mfma_f32_16x16x32_bf16 v[44:47], a[192:195], a[144:147], v[68:71]
    v_add_f32 v21, v21, v34
    v_add_f32 v21, v21, v35
    v_mfma_f32_16x16x32_bf16 v[44:47], a[196:199], a[148:151], v[44:47]
    s_and_b32 s69, s29, s63
    v_add_f32 v21, v21, v36
    v_add_f32 v21, v21, v37
    v_mfma_f32_16x16x32_bf16 v[44:47], a[200:203], a[152:155], v[44:47]
    s_add_u32 m0, s32, s69
    v_add_f32 v21, v21, v38
    v_add_f32 v21, v21, v39
    v_mfma_f32_16x16x32_bf16 v[44:47], a[204:207], a[156:159], v[44:47]
    s_waitcnt vmcnt(3)
    buffer_load_dwordx4 v14, s[12:15], s29 offen nt lds
    v_mfma_f32_16x16x32_bf16 v[224:227], a[208:211], v[24:27], v[224:227]
    s_barrier
    v_exp_f32 v40, v40
    v_mfma_f32_16x16x32_bf16 v[228:231], a[212:215], v[24:27], v[228:231]
    s_add_u32 s29, s29, s75
    v_exp_f32 v41, v41
    v_mfma_f32_16x16x32_bf16 v[232:235], a[216:219], v[24:27], v[232:235]
    v_exp_f32 v42, v42
    v_mfma_f32_16x16x32_bf16 v[236:239], a[220:223], v[24:27], v[236:239]
    v_exp_f32 v43, v43
    v_mfma_f32_16x16x32_bf16 v[240:243], a[224:227], v[24:27], v[240:243]
    v_exp_f32 v44, v44
    v_mfma_f32_16x16x32_bf16 v[244:247], a[228:231], v[24:27], v[244:247]
    v_exp_f32 v45, v45
    v_mfma_f32_16x16x32_bf16 v[248:251], a[232:235], v[24:27], v[248:251]
    v_cvt_pk_bf16_f32 v28, v40, v41
    v_cvt_pk_bf16_f32 v29, v42, v43
    v_mfma_f32_16x16x32_bf16 v[252:255], a[236:239], v[24:27], v[252:255]
    v_exp_f32 v46, v46
    v_mfma_f32_16x16x32_bf16 v[32:35], a[176:179], a[160:163], v[72:75]
    s_and_b32 s69, s29, s63
    v_exp_f32 v47, v47
    v_mfma_f32_16x16x32_bf16 v[32:35], a[180:183], a[164:167], v[32:35]
    s_add_u32 m0, s32, s69
    ds_read_b128 a[176:179], v1 offset:8192
    ds_read_b128 a[180:183], v2 offset:8192
    v_mfma_f32_16x16x32_bf16 v[32:35], a[184:187], a[168:171], v[32:35]
    s_waitcnt vmcnt(3)
    buffer_load_dwordx4 v13, s[12:15], s29 offen nt lds
    v_cvt_pk_bf16_f32 v30, v44, v45
    v_cvt_pk_bf16_f32 v31, v46, v47
    v_mfma_f32_16x16x32_bf16 v[32:35], a[188:191], a[172:175], v[32:35]
    s_add_u32 s29, s29, s75
    ds_read_b128 a[184:187], v3 offset:8192
    ds_read_b128 a[188:191], v4 offset:8192
    v_mfma_f32_16x16x32_bf16 v[36:39], a[192:195], a[160:163], v[72:75]
    ds_read_b128 a[192:195], v1 offset:12288
    v_add_f32 v22, v22, v40
    v_mfma_f32_16x16x32_bf16 v[36:39], a[196:199], a[164:167], v[36:39]
    ds_read_b128 a[196:199], v2 offset:12288
    v_add_f32 v22, v22, v41
    v_mfma_f32_16x16x32_bf16 v[36:39], a[200:203], a[168:171], v[36:39]
    ds_read_b128 a[200:203], v3 offset:12288
    v_add_f32 v22, v22, v42
    v_mfma_f32_16x16x32_bf16 v[36:39], a[204:207], a[172:175], v[36:39]
    ds_read_b128 a[204:207], v4 offset:12288
    v_add_f32 v22, v22, v43
    v_mfma_f32_16x16x32_bf16 a[0:3], a[208:211], v[28:31], a[0:3]
    v_exp_f32 v32, v32
    v_mfma_f32_16x16x32_bf16 a[4:7], a[212:215], v[28:31], a[4:7]
    v_exp_f32 v33, v33
    v_mfma_f32_16x16x32_bf16 a[8:11], a[216:219], v[28:31], a[8:11]
    v_exp_f32 v34, v34
    v_mfma_f32_16x16x32_bf16 a[12:15], a[220:223], v[28:31], a[12:15]
    v_exp_f32 v35, v35
    v_mfma_f32_16x16x32_bf16 a[16:19], a[224:227], v[28:31], a[16:19]
    v_add_f32 v22, v22, v44
    v_add_f32 v22, v22, v45
    v_mfma_f32_16x16x32_bf16 a[20:23], a[228:231], v[28:31], a[20:23]
    s_and_b32 s69, s29, s63
    v_exp_f32 v36, v36
    v_mfma_f32_16x16x32_bf16 a[24:27], a[232:235], v[28:31], a[24:27]
    s_add_u32 m0, s32, s69
    v_exp_f32 v37, v37
    v_mfma_f32_16x16x32_bf16 a[28:31], a[236:239], v[28:31], a[28:31]
    s_waitcnt lgkmcnt(7)
    s_waitcnt vmcnt(3)
    buffer_load_dwordx4 v14, s[12:15], s29 offen nt lds
    v_add_f32 v22, v22, v46
    v_add_f32 v22, v22, v47
    v_mfma_f32_16x16x32_bf16 v[40:43], a[176:179], a[64:67], v[48:51]
    s_waitcnt lgkmcnt(6)
    s_add_u32 s29, s29, s75
    v_cvt_pk_bf16_f32 v24, v32, v33
    v_cvt_pk_bf16_f32 v25, v34, v35
    v_mfma_f32_16x16x32_bf16 v[40:43], a[180:183], a[68:71], v[40:43]
    s_waitcnt lgkmcnt(5)
    v_exp_f32 v38, v38
    v_mfma_f32_16x16x32_bf16 v[40:43], a[184:187], a[72:75], v[40:43]
    s_waitcnt lgkmcnt(4)
    v_exp_f32 v39, v39
    v_mfma_f32_16x16x32_bf16 v[40:43], a[188:191], a[76:79], v[40:43]
    s_waitcnt lgkmcnt(3)
    v_add_f32 v23, v23, v32
    v_add_f32 v23, v23, v33
    v_mfma_f32_16x16x32_bf16 v[44:47], a[192:195], a[64:67], v[48:51]
    s_waitcnt lgkmcnt(2)
    v_cvt_pk_bf16_f32 v26, v36, v37
    v_cvt_pk_bf16_f32 v27, v38, v39
    v_mfma_f32_16x16x32_bf16 v[44:47], a[196:199], a[68:71], v[44:47]
    s_waitcnt lgkmcnt(1)
    v_add_f32 v23, v23, v34
    v_add_f32 v23, v23, v35
    v_mfma_f32_16x16x32_bf16 v[44:47], a[200:203], a[72:75], v[44:47]
    s_waitcnt lgkmcnt(0)
    v_add_f32 v23, v23, v36
    v_add_f32 v23, v23, v37
    v_mfma_f32_16x16x32_bf16 v[44:47], a[204:207], a[76:79], v[44:47]
    v_add_f32 v23, v23, v38
    v_add_f32 v23, v23, v39
    v_mfma_f32_16x16x32_bf16 a[32:35], a[208:211], v[24:27], a[32:35]
    ds_read_b64_tr_b16 a[208:209], v5 offset:8192
    ds_read_b64_tr_b16 a[210:211], v5 offset:12288
    v_mfma_f32_16x16x32_bf16 a[36:39], a[212:215], v[24:27], a[36:39]
    v_exp_f32 v40, v40
    v_mfma_f32_16x16x32_bf16 a[40:43], a[216:219], v[24:27], a[40:43]
    ds_read_b64_tr_b16 a[212:213], v6 offset:8192
    ds_read_b64_tr_b16 a[214:215], v6 offset:12288
    v_mfma_f32_16x16x32_bf16 a[44:47], a[220:223], v[24:27], a[44:47]
    v_exp_f32 v41, v41
    v_mfma_f32_16x16x32_bf16 a[48:51], a[224:227], v[24:27], a[48:51]
    v_exp_f32 v42, v42
    v_mfma_f32_16x16x32_bf16 a[52:55], a[228:231], v[24:27], a[52:55]
    ds_read_b64_tr_b16 a[216:217], v7 offset:8192
    ds_read_b64_tr_b16 a[218:219], v7 offset:12288
    v_mfma_f32_16x16x32_bf16 a[56:59], a[232:235], v[24:27], a[56:59]
    v_exp_f32 v43, v43
    v_mfma_f32_16x16x32_bf16 a[60:63], a[236:239], v[24:27], a[60:63]
    v_exp_f32 v44, v44
    s_sub_u32 s34, s34, 1
    s_cmp_lg_u32 s34, 0
    s_cbranch_scc1 L_atl
    v_mfma_f32_16x16x32_bf16 v[32:35], a[176:179], a[80:83], v[52:55]
    ds_read_b64_tr_b16 a[220:221], v8 offset:8192
    ds_read_b64_tr_b16 a[222:223], v8 offset:12288
    v_mfma_f32_16x16x32_bf16 v[32:35], a[180:183], a[84:87], v[32:35]
    v_exp_f32 v45, v45
    v_mfma_f32_16x16x32_bf16 v[32:35], a[184:187], a[88:91], v[32:35]
    ds_read_b64_tr_b16 a[224:225], v9 offset:8192
    v_cvt_pk_bf16_f32 v28, v40, v41
    v_mfma_f32_16x16x32_bf16 v[32:35], a[188:191], a[92:95], v[32:35]
    v_exp_f32 v46, v46
    v_mfma_f32_16x16x32_bf16 v[36:39], a[192:195], a[80:83], v[52:55]
    ds_read_b64_tr_b16 a[226:227], v9 offset:12288
    v_cvt_pk_bf16_f32 v29, v42, v43
    v_mfma_f32_16x16x32_bf16 v[36:39], a[196:199], a[84:87], v[36:39]
    v_exp_f32 v47, v47
    v_mfma_f32_16x16x32_bf16 v[36:39], a[200:203], a[88:91], v[36:39]
    v_cvt_pk_bf16_f32 v30, v44, v45
    v_cvt_pk_bf16_f32 v31, v46, v47
    v_mfma_f32_16x16x32_bf16 v[36:39], a[204:207], a[92:95], v[36:39]
    s_waitcnt lgkmcnt(8)
    ds_read_b64_tr_b16 a[228:229], v10 offset:8192
    ds_read_b64_tr_b16 a[230:231], v10 offset:12288
    v_mfma_f32_16x16x32_bf16 v[96:99], a[208:211], v[28:31], v[96:99]
    s_waitcnt lgkmcnt(8)
    ds_read_b64_tr_b16 a[232:233], v11 offset:8192
    ds_read_b64_tr_b16 a[234:235], v11 offset:12288
    v_mfma_f32_16x16x32_bf16 v[100:103], a[212:215], v[28:31], v[100:103]
    s_waitcnt lgkmcnt(8)
    ds_read_b64_tr_b16 a[236:237], v12 offset:8192
    ds_read_b64_tr_b16 a[238:239], v12 offset:12288
    v_mfma_f32_16x16x32_bf16 v[104:107], a[216:219], v[28:31], v[104:107]
    s_waitcnt lgkmcnt(8)
    v_exp_f32 v32, v32
    v_mfma_f32_16x16x32_bf16 v[108:111], a[220:223], v[28:31], v[108:111]
    s_waitcnt lgkmcnt(6)
    v_exp_f32 v33, v33
    v_mfma_f32_16x16x32_bf16 v[112:115], a[224:227], v[28:31], v[112:115]
    s_waitcnt lgkmcnt(4)
    v_add_f32 v17, v17, v40
    v_add_f32 v17, v17, v41
    v_mfma_f32_16x16x32_bf16 v[116:119], a[228:231], v[28:31], v[116:119]
    s_waitcnt lgkmcnt(2)
    v_add_f32 v17, v17, v42
    v_add_f32 v17, v17, v43
    v_mfma_f32_16x16x32_bf16 v[120:123], a[232:235], v[28:31], v[120:123]
    s_waitcnt lgkmcnt(0)
    v_exp_f32 v34, v34
    v_mfma_f32_16x16x32_bf16 v[124:127], a[236:239], v[28:31], v[124:127]
    v_exp_f32 v35, v35
    v_mfma_f32_16x16x32_bf16 v[40:43], a[176:179], a[96:99], v[56:59]
    v_exp_f32 v36, v36
    v_mfma_f32_16x16x32_bf16 v[40:43], a[180:183], a[100:103], v[40:43]
    v_add_f32 v17, v17, v44
    v_add_f32 v17, v17, v45
    v_mfma_f32_16x16x32_bf16 v[40:43], a[184:187], a[104:107], v[40:43]
    v_exp_f32 v37, v37
    v_mfma_f32_16x16x32_bf16 v[40:43], a[188:191], a[108:111], v[40:43]
    v_add_f32 v17, v17, v46
    v_add_f32 v17, v17, v47
    v_mfma_f32_16x16x32_bf16 v[44:47], a[192:195], a[96:99], v[56:59]
    v_exp_f32 v38, v38
    v_mfma_f32_16x16x32_bf16 v[44:47], a[196:199], a[100:103], v[44:47]
    v_exp_f32 v39, v39
    v_cvt_pk_bf16_f32 v24, v32, v33
    v_mfma_f32_16x16x32_bf16 v[44:47], a[200:203], a[104:107], v[44:47]
    v_cvt_pk_bf16_f32 v25, v34, v35
    v_cvt_pk_bf16_f32 v26, v36, v37
    v_cvt_pk_bf16_f32 v27, v38, v39
    v_mfma_f32_16x16x32_bf16 v[44:47], a[204:207], a[108:111], v[44:47]
    v_add_f32 v18, v18, v32
    v_add_f32 v18, v18, v33
    v_mfma_f32_16x16x32_bf16 v[128:131], a[208:211], v[24:27], v[128:131]
    v_exp_f32 v40, v40
    v_mfma_f32_16x16x32_bf16 v[132:135], a[212:215], v[24:27], v[132:135]
    v_exp_f32 v41, v41
    v_mfma_f32_16x16x32_bf16 v[136:139], a[216:219], v[24:27], v[136:139]
    v_add_f32 v18, v18, v34
    v_add_f32 v18, v18, v35
    v_mfma_f32_16x16x32_bf16 v[140:143], a[220:223], v[24:27], v[140:143]
    v_exp_f32 v42, v42
    v_mfma_f32_16x16x32_bf16 v[144:147], a[224:227], v[24:27], v[144:147]
    v_exp_f32 v43, v43
    v_mfma_f32_16x16x32_bf16 v[148:151], a[228:231], v[24:27], v[148:151]
    v_add_f32 v18, v18, v36
    v_add_f32 v18, v18, v37
    v_mfma_f32_16x16x32_bf16 v[152:155], a[232:235], v[24:27], v[152:155]
    v_exp_f32 v44, v44
    v_mfma_f32_16x16x32_bf16 v[156:159], a[236:239], v[24:27], v[156:159]
    v_exp_f32 v45, v45
    v_mfma_f32_16x16x32_bf16 v[32:35], a[176:179], a[112:115], v[60:63]
    v_add_f32 v18, v18, v38
    v_add_f32 v18, v18, v39
    v_mfma_f32_16x16x32_bf16 v[32:35], a[180:183], a[116:119], v[32:35]
    v_cvt_pk_bf16_f32 v28, v40, v41
    v_cvt_pk_bf16_f32 v29, v42, v43
    v_mfma_f32_16x16x32_bf16 v[32:35], a[184:187], a[120:123], v[32:35]
    v_exp_f32 v46, v46
    v_mfma_f32_16x16x32_bf16 v[32:35], a[188:191], a[124:127], v[32:35]
    v_exp_f32 v47, v47
    v_mfma_f32_16x16x32_bf16 v[36:39], a[192:195], a[112:115], v[60:63]
    v_add_f32 v19, v19, v40
    v_add_f32 v19, v19, v41
    v_mfma_f32_16x16x32_bf16 v[36:39], a[196:199], a[116:119], v[36:39]
    v_cvt_pk_bf16_f32 v30, v44, v45
    v_cvt_pk_bf16_f32 v31, v46, v47
    v_mfma_f32_16x16x32_bf16 v[36:39], a[200:203], a[120:123], v[36:39]
    v_add_f32 v19, v19, v42
    v_add_f32 v19, v19, v43
    v_mfma_f32_16x16x32_bf16 v[36:39], a[204:207], a[124:127], v[36:39]
    v_add_f32 v19, v19, v44
    v_add_f32 v19, v19, v45
    v_mfma_f32_16x16x32_bf16 v[160:163], a[208:211], v[28:31], v[160:163]
    v_exp_f32 v32, v32
    v_mfma_f32_16x16x32_bf16 v[164:167], a[212:215], v[28:31], v[164:167]
    v_exp_f32 v33, v33
    v_mfma_f32_16x16x32_bf16 v[168:171], a[216:219], v[28:31], v[168:171]
    v_exp_f32 v34, v34
    v_mfma_f32_16x16x32_bf16 v[172:175], a[220:223], v[28:31], v[172:175]
    v_exp_f32 v35, v35
    v_mfma_f32_16x16x32_bf16 v[176:179], a[224:227], v[28:31], v[176:179]
    buffer_load_dword v89, v88, s[4:7], s77 offen
    s_add_u32 s77, s77, 8192
    v_mfma_f32_16x16x32_bf16 v[180:183], a[228:231], v[28:31], v[180:183]
    v_exp_f32 v36, v36
    v_mfma_f32_16x16x32_bf16 v[184:187], a[232:235], v[28:31], v[184:187]
    v_exp_f32 v37, v37
    v_mfma_f32_16x16x32_bf16 v[188:191], a[236:239], v[28:31], v[188:191]
    v_add_f32 v19, v19, v46
    v_add_f32 v19, v19, v47
    v_mfma_f32_16x16x32_bf16 v[40:43], a[176:179], a[128:131], v[64:67]
    v_cvt_pk_bf16_f32 v24, v32, v33
    v_cvt_pk_bf16_f32 v25, v34, v35
    v_mfma_f32_16x16x32_bf16 v[40:43], a[180:183], a[132:135], v[40:43]
    v_exp_f32 v38, v38
    v_mfma_f32_16x16x32_bf16 v[40:43], a[184:187], a[136:139], v[40:43]
    v_exp_f32 v39, v39
    v_mfma_f32_16x16x32_bf16 v[40:43], a[188:191], a[140:143], v[40:43]
    v_add_f32 v20, v20, v32
    v_add_f32 v20, v20, v33
    v_mfma_f32_16x16x32_bf16 v[44:47], a[192:195], a[128:131], v[64:67]
    v_cvt_pk_bf16_f32 v26, v36, v37
    v_cvt_pk_bf16_f32 v27, v38, v39
    v_mfma_f32_16x16x32_bf16 v[44:47], a[196:199], a[132:135], v[44:47]
    v_add_f32 v20, v20, v34
    v_add_f32 v20, v20, v35
    v_mfma_f32_16x16x32_bf16 v[44:47], a[200:203], a[136:139], v[44:47]
    v_add_f32 v20, v20, v36
    v_add_f32 v20, v20, v37
    v_mfma_f32_16x16x32_bf16 v[44:47], a[204:207], a[140:143], v[44:47]
    v_add_f32 v20, v20, v38
    v_add_f32 v20, v20, v39
    v_mfma_f32_16x16x32_bf16 v[192:195], a[208:211], v[24:27], v[192:195]
    v_exp_f32 v40, v40
    v_mfma_f32_16x16x32_bf16 v[196:199], a[212:215], v[24:27], v[196:199]
    v_exp_f32 v41, v41
    v_mfma_f32_16x16x32_bf16 v[200:203], a[216:219], v[24:27], v[200:203]
    v_exp_f32 v42, v42
    v_mfma_f32_16x16x32_bf16 v[204:207], a[220:223], v[24:27], v[204:207]
    v_exp_f32 v43, v43
    v_mfma_f32_16x16x32_bf16 v[208:211], a[224:227], v[24:27], v[208:211]
    v_mfma_f32_16x16x32_bf16 v[212:215], a[228:231], v[24:27], v[212:215]
    v_exp_f32 v44, v44
    v_mfma_f32_16x16x32_bf16 v[216:219], a[232:235], v[24:27], v[216:219]
    v_exp_f32 v45, v45
    v_mfma_f32_16x16x32_bf16 v[220:223], a[236:239], v[24:27], v[220:223]
    v_cvt_pk_bf16_f32 v28, v40, v41
    v_cvt_pk_bf16_f32 v29, v42, v43
    v_mfma_f32_16x16x32_bf16 v[32:35], a[176:179], a[144:147], v[68:71]
    v_exp_f32 v46, v46
    v_mfma_f32_16x16x32_bf16 v[32:35], a[180:183], a[148:151], v[32:35]
    v_exp_f32 v47, v47
    v_mfma_f32_16x16x32_bf16 v[32:35], a[184:187], a[152:155], v[32:35]
    v_add_f32 v21, v21, v40
    v_add_f32 v21, v21, v41
    v_mfma_f32_16x16x32_bf16 v[32:35], a[188:191], a[156:159], v[32:35]
    v_cvt_pk_bf16_f32 v30, v44, v45
    v_cvt_pk_bf16_f32 v31, v46, v47
    v_mfma_f32_16x16x32_bf16 v[36:39], a[192:195], a[144:147], v[68:71]
    v_add_f32 v21, v21, v42
    v_add_f32 v21, v21, v43
    v_mfma_f32_16x16x32_bf16 v[36:39], a[196:199], a[148:151], v[36:39]
    v_add_f32 v21, v21, v44
    v_add_f32 v21, v21, v45
    v_mfma_f32_16x16x32_bf16 v[36:39], a[200:203], a[152:155], v[36:39]
    v_add_f32 v21, v21, v46
    v_add_f32 v21, v21, v47
    v_mfma_f32_16x16x32_bf16 v[36:39], a[204:207], a[156:159], v[36:39]
    v_mfma_f32_16x16x32_bf16 v[224:227], a[208:211], v[28:31], v[224:227]
    s_barrier
    v_exp_f32 v32, v32
    v_mfma_f32_16x16x32_bf16 v[228:231], a[212:215], v[28:31], v[228:231]
    v_exp_f32 v33, v33
    v_mfma_f32_16x16x32_bf16 v[232:235], a[216:219], v[28:31], v[232:235]
    v_exp_f32 v34, v34
    v_mfma_f32_16x16x32_bf16 v[236:239], a[220:223], v[28:31], v[236:239]
    v_exp_f32 v35, v35
    v_mfma_f32_16x16x32_bf16 v[240:243], a[224:227], v[28:31], v[240:243]
    v_exp_f32 v36, v36
    v_mfma_f32_16x16x32_bf16 v[244:247], a[228:231], v[28:31], v[244:247]
    v_exp_f32 v37, v37
    v_mfma_f32_16x16x32_bf16 v[248:251], a[232:235], v[28:31], v[248:251]
    v_cvt_pk_bf16_f32 v24, v32, v33
    v_cvt_pk_bf16_f32 v25, v34, v35
    v_mfma_f32_16x16x32_bf16 v[252:255], a[236:239], v[28:31], v[252:255]
    v_exp_f32 v38, v38
    v_mfma_f32_16x16x32_bf16 v[40:43], a[176:179], a[160:163], v[72:75]
    v_exp_f32 v39, v39
    v_mfma_f32_16x16x32_bf16 v[40:43], a[180:183], a[164:167], v[40:43]
    ds_read_b128 a[176:179], v1 offset:16384
    ds_read_b128 a[180:183], v2 offset:16384
    v_mfma_f32_16x16x32_bf16 v[40:43], a[184:187], a[168:171], v[40:43]
    v_cvt_pk_bf16_f32 v26, v36, v37
    v_cvt_pk_bf16_f32 v27, v38, v39
    v_mfma_f32_16x16x32_bf16 v[40:43], a[188:191], a[172:175], v[40:43]
    ds_read_b128 a[184:187], v3 offset:16384
    ds_read_b128 a[188:191], v4 offset:16384
    v_mfma_f32_16x16x32_bf16 v[44:47], a[192:195], a[160:163], v[72:75]
    ds_read_b128 a[192:195], v1 offset:20480
    v_add_f32 v22, v22, v32
    v_mfma_f32_16x16x32_bf16 v[44:47], a[196:199], a[164:167], v[44:47]
    ds_read_b128 a[196:199], v2 offset:20480
    v_add_f32 v22, v22, v33
    v_mfma_f32_16x16x32_bf16 v[44:47], a[200:203], a[168:171], v[44:47]
    ds_read_b128 a[200:203], v3 offset:20480
    v_add_f32 v22, v22, v34
    v_mfma_f32_16x16x32_bf16 v[44:47], a[204:207], a[172:175], v[44:47]
    ds_read_b128 a[204:207], v4 offset:20480
    v_add_f32 v22, v22, v35
    v_mfma_f32_16x16x32_bf16 a[0:3], a[208:211], v[24:27], a[0:3]
    v_exp_f32 v40, v40
    v_mfma_f32_16x16x32_bf16 a[4:7], a[212:215], v[24:27], a[4:7]
    v_exp_f32 v41, v41
    v_mfma_f32_16x16x32_bf16 a[8:11], a[216:219], v[24:27], a[8:11]
    v_exp_f32 v42, v42
    v_mfma_f32_16x16x32_bf16 a[12:15], a[220:223], v[24:27], a[12:15]
    v_exp_f32 v43, v43
    v_mfma_f32_16x16x32_bf16 a[16:19], a[224:227], v[24:27], a[16:19]
    v_add_f32 v22, v22, v36
    v_add_f32 v22, v22, v37
    v_mfma_f32_16x16x32_bf16 a[20:23], a[228:231], v[24:27], a[20:23]
    v_exp_f32 v44, v44
    v_mfma_f32_16x16x32_bf16 a[24:27], a[232:235], v[24:27], a[24:27]
    v_exp_f32 v45, v45
    v_mfma_f32_16x16x32_bf16 a[28:31], a[236:239], v[24:27], a[28:31]
    s_waitcnt lgkmcnt(7)
    v_add_f32 v22, v22, v38
    v_add_f32 v22, v22, v39
    v_mfma_f32_16x16x32_bf16 v[32:35], a[176:179], a[64:67], v[48:51]
    s_waitcnt lgkmcnt(6)
    v_cvt_pk_bf16_f32 v28, v40, v41
    v_cvt_pk_bf16_f32 v29, v42, v43
    v_mfma_f32_16x16x32_bf16 v[32:35], a[180:183], a[68:71], v[32:35]
    s_waitcnt lgkmcnt(5)
    v_exp_f32 v46, v46
    v_mfma_f32_16x16x32_bf16 v[32:35], a[184:187], a[72:75], v[32:35]
    s_waitcnt lgkmcnt(4)
    v_exp_f32 v47, v47
    v_mfma_f32_16x16x32_bf16 v[32:35], a[188:191], a[76:79], v[32:35]
    s_waitcnt lgkmcnt(3)
    v_add_f32 v23, v23, v40
    v_add_f32 v23, v23, v41
    v_mfma_f32_16x16x32_bf16 v[36:39], a[192:195], a[64:67], v[48:51]
    s_waitcnt lgkmcnt(2)
    v_cvt_pk_bf16_f32 v30, v44, v45
    v_cvt_pk_bf16_f32 v31, v46, v47
    v_mfma_f32_16x16x32_bf16 v[36:39], a[196:199], a[68:71], v[36:39]
    s_waitcnt lgkmcnt(1)
    v_add_f32 v23, v23, v42
    v_add_f32 v23, v23, v43
    v_mfma_f32_16x16x32_bf16 v[36:39], a[200:203], a[72:75], v[36:39]
    s_waitcnt lgkmcnt(0)
    v_add_f32 v23, v23, v44
    v_add_f32 v23, v23, v45
    v_mfma_f32_16x16x32_bf16 v[36:39], a[204:207], a[76:79], v[36:39]
    v_add_f32 v23, v23, v46
    v_add_f32 v23, v23, v47
    v_mfma_f32_16x16x32_bf16 a[32:35], a[208:211], v[28:31], a[32:35]
    ds_read_b64_tr_b16 a[208:209], v5 offset:16384
    ds_read_b64_tr_b16 a[210:211], v5 offset:20480
    v_mfma_f32_16x16x32_bf16 a[36:39], a[212:215], v[28:31], a[36:39]
    v_exp_f32 v32, v32
    v_mfma_f32_16x16x32_bf16 a[40:43], a[216:219], v[28:31], a[40:43]
    ds_read_b64_tr_b16 a[212:213], v6 offset:16384
    ds_read_b64_tr_b16 a[214:215], v6 offset:20480
    v_mfma_f32_16x16x32_bf16 a[44:47], a[220:223], v[28:31], a[44:47]
    v_exp_f32 v33, v33
    v_mfma_f32_16x16x32_bf16 a[48:51], a[224:227], v[28:31], a[48:51]
    v_exp_f32 v34, v34
    v_mfma_f32_16x16x32_bf16 a[52:55], a[228:231], v[28:31], a[52:55]
    ds_read_b64_tr_b16 a[216:217], v7 offset:16384
    ds_read_b64_tr_b16 a[218:219], v7 offset:20480
    v_mfma_f32_16x16x32_bf16 a[56:59], a[232:235], v[28:31], a[56:59]
    v_exp_f32 v35, v35
    v_mfma_f32_16x16x32_bf16 a[60:63], a[236:239], v[28:31], a[60:63]
    v_exp_f32 v36, v36
    v_mfma_f32_16x16x32_bf16 v[40:43], a[176:179], a[80:83], v[52:55]
    ds_read_b64_tr_b16 a[220:221], v8 offset:16384
    ds_read_b64_tr_b16 a[222:223], v8 offset:20480
    v_mfma_f32_16x16x32_bf16 v[40:43], a[180:183], a[84:87], v[40:43]
    v_exp_f32 v37, v37
    v_mfma_f32_16x16x32_bf16 v[40:43], a[184:187], a[88:91], v[40:43]
    ds_read_b64_tr_b16 a[224:225], v9 offset:16384
    v_cvt_pk_bf16_f32 v24, v32, v33
    v_mfma_f32_16x16x32_bf16 v[40:43], a[188:191], a[92:95], v[40:43]
    v_exp_f32 v38, v38
    v_mfma_f32_16x16x32_bf16 v[44:47], a[192:195], a[80:83], v[52:55]
    ds_read_b64_tr_b16 a[226:227], v9 offset:20480
    v_cvt_pk_bf16_f32 v25, v34, v35
    v_mfma_f32_16x16x32_bf16 v[44:47], a[196:199], a[84:87], v[44:47]
    v_exp_f32 v39, v39
    v_mfma_f32_16x16x32_bf16 v[44:47], a[200:203], a[88:91], v[44:47]
    buffer_load_dword v89, v88, s[4:7], s77 offen
    s_add_u32 s77, s77, 8192
    v_cvt_pk_bf16_f32 v26, v36, v37
    v_cvt_pk_bf16_f32 v27, v38, v39
    v_mfma_f32_16x16x32_bf16 v[44:47], a[204:207], a[92:95], v[44:47]
    s_waitcnt lgkmcnt(8)
    ds_read_b64_tr_b16 a[228:229], v10 offset:16384
    ds_read_b64_tr_b16 a[230:231], v10 offset:20480
    v_mfma_f32_16x16x32_bf16 v[96:99], a[208:211], v[24:27], v[96:99]
    s_waitcnt lgkmcnt(8)
    ds_read_b64_tr_b16 a[232:233], v11 offset:16384
    ds_read_b64_tr_b16 a[234:235], v11 offset:20480
    v_mfma_f32_16x16x32_bf16 v[100:103], a[212:215], v[24:27], v[100:103]
    s_waitcnt lgkmcnt(8)
    ds_read_b64_tr_b16 a[236:237], v12 offset:16384
    ds_read_b64_tr_b16 a[238:239], v12 offset:20480
    v_mfma_f32_16x16x32_bf16 v[104:107], a[216:219], v[24:27], v[104:107]
    s_waitcnt lgkmcnt(8)
    v_exp_f32 v40, v40
    v_mfma_f32_16x16x32_bf16 v[108:111], a[220:223], v[24:27], v[108:111]
    s_waitcnt lgkmcnt(6)
    v_exp_f32 v41, v41
    v_mfma_f32_16x16x32_bf16 v[112:115], a[224:227], v[24:27], v[112:115]
    s_waitcnt lgkmcnt(4)
    v_add_f32 v17, v17, v32
    v_add_f32 v17, v17, v33
    v_mfma_f32_16x16x32_bf16 v[116:119], a[228:231], v[24:27], v[116:119]
    s_waitcnt lgkmcnt(2)
    v_add_f32 v17, v17, v34
    v_add_f32 v17, v17, v35
    v_mfma_f32_16x16x32_bf16 v[120:123], a[232:235], v[24:27], v[120:123]
    s_waitcnt lgkmcnt(0)
    v_exp_f32 v42, v42
    v_mfma_f32_16x16x32_bf16 v[124:127], a[236:239], v[24:27], v[124:127]
    v_exp_f32 v43, v43
    v_mfma_f32_16x16x32_bf16 v[32:35], a[176:179], a[96:99], v[56:59]
    v_exp_f32 v44, v44
    v_mfma_f32_16x16x32_bf16 v[32:35], a[180:183], a[100:103], v[32:35]
    v_add_f32 v17, v17, v36
    v_add_f32 v17, v17, v37
    v_mfma_f32_16x16x32_bf16 v[32:35], a[184:187], a[104:107], v[32:35]
    v_exp_f32 v45, v45
    v_mfma_f32_16x16x32_bf16 v[32:35], a[188:191], a[108:111], v[32:35]
    v_add_f32 v17, v17, v38
    v_add_f32 v17, v17, v39
    v_mfma_f32_16x16x32_bf16 v[36:39], a[192:195], a[96:99], v[56:59]
    v_exp_f32 v46, v46
    v_mfma_f32_16x16x32_bf16 v[36:39], a[196:199], a[100:103], v[36:39]
    v_exp_f32 v47, v47
    v_cvt_pk_bf16_f32 v28, v40, v41
    v_mfma_f32_16x16x32_bf16 v[36:39], a[200:203], a[104:107], v[36:39]
    v_cvt_pk_bf16_f32 v29, v42, v43
    v_cvt_pk_bf16_f32 v30, v44, v45
    v_cvt_pk_bf16_f32 v31, v46, v47
    v_mfma_f32_16x16x32_bf16 v[36:39], a[204:207], a[108:111], v[36:39]
    v_add_f32 v18, v18, v40
    v_add_f32 v18, v18, v41
    v_mfma_f32_16x16x32_bf16 v[128:131], a[208:211], v[28:31], v[128:131]
    v_exp_f32 v32, v32
    v_mfma_f32_16x16x32_bf16 v[132:135], a[212:215], v[28:31], v[132:135]
    v_exp_f32 v33, v33
    v_mfma_f32_16x16x32_bf16 v[136:139], a[216:219], v[28:31], v[136:139]
    v_add_f32 v18, v18, v42
    v_add_f32 v18, v18, v43
    v_mfma_f32_16x16x32_bf16 v[140:143], a[220:223], v[28:31], v[140:143]
    v_exp_f32 v34, v34
    v_mfma_f32_16x16x32_bf16 v[144:147], a[224:227], v[28:31], v[144:147]
    v_exp_f32 v35, v35
    v_mfma_f32_16x16x32_bf16 v[148:151], a[228:231], v[28:31], v[148:151]
    v_add_f32 v18, v18, v44
    v_add_f32 v18, v18, v45
    v_mfma_f32_16x16x32_bf16 v[152:155], a[232:235], v[28:31], v[152:155]
    v_exp_f32 v36, v36
    v_mfma_f32_16x16x32_bf16 v[156:159], a[236:239], v[28:31], v[156:159]
    v_exp_f32 v37, v37
    v_mfma_f32_16x16x32_bf16 v[40:43], a[176:179], a[112:115], v[60:63]
    v_add_f32 v18, v18, v46
    v_add_f32 v18, v18, v47
    v_mfma_f32_16x16x32_bf16 v[40:43], a[180:183], a[116:119], v[40:43]
    v_cvt_pk_bf16_f32 v24, v32, v33
    v_cvt_pk_bf16_f32 v25, v34, v35
    v_mfma_f32_16x16x32_bf16 v[40:43], a[184:187], a[120:123], v[40:43]
    v_exp_f32 v38, v38
    v_mfma_f32_16x16x32_bf16 v[40:43], a[188:191], a[124:127], v[40:43]
    v_exp_f32 v39, v39
    v_mfma_f32_16x16x32_bf16 v[44:47], a[192:195], a[112:115], v[60:63]
    v_add_f32 v19, v19, v32
    v_add_f32 v19, v19, v33
    v_mfma_f32_16x16x32_bf16 v[44:47], a[196:199], a[116:119], v[44:47]
    v_cvt_pk_bf16_f32 v26, v36, v37
    v_cvt_pk_bf16_f32 v27, v38, v39
    v_mfma_f32_16x16x32_bf16 v[44:47], a[200:203], a[120:123], v[44:47]
    v_add_f32 v19, v19, v34
    v_add_f32 v19, v19, v35
    v_mfma_f32_16x16x32_bf16 v[44:47], a[204:207], a[124:127], v[44:47]
    v_add_f32 v19, v19, v36
    v_add_f32 v19, v19, v37
    v_mfma_f32_16x16x32_bf16 v[160:163], a[208:211], v[24:27], v[160:163]
    v_exp_f32 v40, v40
    v_mfma_f32_16x16x32_bf16 v[164:167], a[212:215], v[24:27], v[164:167]
    v_exp_f32 v41, v41
    v_mfma_f32_16x16x32_bf16 v[168:171], a[216:219], v[24:27], v[168:171]
    v_exp_f32 v42, v42
    v_mfma_f32_16x16x32_bf16 v[172:175], a[220:223], v[24:27], v[172:175]
    v_exp_f32 v43, v43
    v_mfma_f32_16x16x32_bf16 v[176:179], a[224:227], v[24:27], v[176:179]
    v_mfma_f32_16x16x32_bf16 v[180:183], a[228:231], v[24:27], v[180:183]
    v_exp_f32 v44, v44
    v_mfma_f32_16x16x32_bf16 v[184:187], a[232:235], v[24:27], v[184:187]
    v_exp_f32 v45, v45
    v_mfma_f32_16x16x32_bf16 v[188:191], a[236:239], v[24:27], v[188:191]
    v_add_f32 v19, v19, v38
    v_add_f32 v19, v19, v39
    v_mfma_f32_16x16x32_bf16 v[32:35], a[176:179], a[128:131], v[64:67]
    v_cvt_pk_bf16_f32 v28, v40, v41
    v_cvt_pk_bf16_f32 v29, v42, v43
    v_mfma_f32_16x16x32_bf16 v[32:35], a[180:183], a[132:135], v[32:35]
    v_exp_f32 v46, v46
    v_mfma_f32_16x16x32_bf16 v[32:35], a[184:187], a[136:139], v[32:35]
    v_exp_f32 v47, v47
    v_mfma_f32_16x16x32_bf16 v[32:35], a[188:191], a[140:143], v[32:35]
    v_add_f32 v20, v20, v40
    v_add_f32 v20, v20, v41
    v_mfma_f32_16x16x32_bf16 v[36:39], a[192:195], a[128:131], v[64:67]
    v_cvt_pk_bf16_f32 v30, v44, v45
    v_cvt_pk_bf16_f32 v31, v46, v47
    v_mfma_f32_16x16x32_bf16 v[36:39], a[196:199], a[132:135], v[36:39]
    v_add_f32 v20, v20, v42
    v_add_f32 v20, v20, v43
    v_mfma_f32_16x16x32_bf16 v[36:39], a[200:203], a[136:139], v[36:39]
    v_add_f32 v20, v20, v44
    v_add_f32 v20, v20, v45
    v_mfma_f32_16x16x32_bf16 v[36:39], a[204:207], a[140:143], v[36:39]
    v_add_f32 v20, v20, v46
    v_add_f32 v20, v20, v47
    v_mfma_f32_16x16x32_bf16 v[192:195], a[208:211], v[28:31], v[192:195]
    v_exp_f32 v32, v32
    v_mfma_f32_16x16x32_bf16 v[196:199], a[212:215], v[28:31], v[196:199]
    v_exp_f32 v33, v33
    v_mfma_f32_16x16x32_bf16 v[200:203], a[216:219], v[28:31], v[200:203]
    v_exp_f32 v34, v34
    v_mfma_f32_16x16x32_bf16 v[204:207], a[220:223], v[28:31], v[204:207]
    v_exp_f32 v35, v35
    v_mfma_f32_16x16x32_bf16 v[208:211], a[224:227], v[28:31], v[208:211]
    v_mfma_f32_16x16x32_bf16 v[212:215], a[228:231], v[28:31], v[212:215]
    v_exp_f32 v36, v36
    v_mfma_f32_16x16x32_bf16 v[216:219], a[232:235], v[28:31], v[216:219]
    v_exp_f32 v37, v37
    v_mfma_f32_16x16x32_bf16 v[220:223], a[236:239], v[28:31], v[220:223]
    v_cvt_pk_bf16_f32 v24, v32, v33
    v_cvt_pk_bf16_f32 v25, v34, v35
    v_mfma_f32_16x16x32_bf16 v[40:43], a[176:179], a[144:147], v[68:71]
    v_exp_f32 v38, v38
    v_mfma_f32_16x16x32_bf16 v[40:43], a[180:183], a[148:151], v[40:43]
    v_exp_f32 v39, v39
    v_mfma_f32_16x16x32_bf16 v[40:43], a[184:187], a[152:155], v[40:43]
    v_add_f32 v21, v21, v32
    v_add_f32 v21, v21, v33
    v_mfma_f32_16x16x32_bf16 v[40:43], a[188:191], a[156:159], v[40:43]
    v_cvt_pk_bf16_f32 v26, v36, v37
    v_cvt_pk_bf16_f32 v27, v38, v39
    v_mfma_f32_16x16x32_bf16 v[44:47], a[192:195], a[144:147], v[68:71]
    v_add_f32 v21, v21, v34
    v_add_f32 v21, v21, v35
    v_mfma_f32_16x16x32_bf16 v[44:47], a[196:199], a[148:151], v[44:47]
    v_add_f32 v21, v21, v36
    v_add_f32 v21, v21, v37
    v_mfma_f32_16x16x32_bf16 v[44:47], a[200:203], a[152:155], v[44:47]
    v_add_f32 v21, v21, v38
    v_add_f32 v21, v21, v39
    v_mfma_f32_16x16x32_bf16 v[44:47], a[204:207], a[156:159], v[44:47]
    s_waitcnt vmcnt(4)
    v_mfma_f32_16x16x32_bf16 v[224:227], a[208:211], v[24:27], v[224:227]
    s_barrier
    v_exp_f32 v40, v40
    v_mfma_f32_16x16x32_bf16 v[228:231], a[212:215], v[24:27], v[228:231]
    v_exp_f32 v41, v41
    v_mfma_f32_16x16x32_bf16 v[232:235], a[216:219], v[24:27], v[232:235]
    v_exp_f32 v42, v42
    v_mfma_f32_16x16x32_bf16 v[236:239], a[220:223], v[24:27], v[236:239]
    v_exp_f32 v43, v43
    v_mfma_f32_16x16x32_bf16 v[240:243], a[224:227], v[24:27], v[240:243]
    v_exp_f32 v44, v44
    v_mfma_f32_16x16x32_bf16 v[244:247], a[228:231], v[24:27], v[244:247]
    v_exp_f32 v45, v45
    v_mfma_f32_16x16x32_bf16 v[248:251], a[232:235], v[24:27], v[248:251]
    v_cvt_pk_bf16_f32 v28, v40, v41
    v_cvt_pk_bf16_f32 v29, v42, v43
    v_mfma_f32_16x16x32_bf16 v[252:255], a[236:239], v[24:27], v[252:255]
    v_exp_f32 v46, v46
    v_mfma_f32_16x16x32_bf16 v[32:35], a[176:179], a[160:163], v[72:75]
    v_exp_f32 v47, v47
    v_mfma_f32_16x16x32_bf16 v[32:35], a[180:183], a[164:167], v[32:35]
    ds_read_b128 a[176:179], v1 offset:24576
    ds_read_b128 a[180:183], v2 offset:24576
    v_mfma_f32_16x16x32_bf16 v[32:35], a[184:187], a[168:171], v[32:35]
    v_cvt_pk_bf16_f32 v30, v44, v45
    v_cvt_pk_bf16_f32 v31, v46, v47
    v_mfma_f32_16x16x32_bf16 v[32:35], a[188:191], a[172:175], v[32:35]
    ds_read_b128 a[184:187], v3 offset:24576
    ds_read_b128 a[188:191], v4 offset:24576
    v_mfma_f32_16x16x32_bf16 v[36:39], a[192:195], a[160:163], v[72:75]
    ds_read_b128 a[192:195], v1 offset:28672
    v_add_f32 v22, v22, v40
    v_mfma_f32_16x16x32_bf16 v[36:39], a[196:199], a[164:167], v[36:39]
    ds_read_b128 a[196:199], v2 offset:28672
    v_add_f32 v22, v22, v41
    v_mfma_f32_16x16x32_bf16 v[36:39], a[200:203], a[168:171], v[36:39]
    ds_read_b128 a[200:203], v3 offset:28672
    v_add_f32 v22, v22, v42
    v_mfma_f32_16x16x32_bf16 v[36:39], a[204:207], a[172:175], v[36:39]
    ds_read_b128 a[204:207], v4 offset:28672
    v_add_f32 v22, v22, v43
    v_mfma_f32_16x16x32_bf16 a[0:3], a[208:211], v[28:31], a[0:3]
    v_exp_f32 v32, v32
    v_mfma_f32_16x16x32_bf16 a[4:7], a[212:215], v[28:31], a[4:7]
    v_exp_f32 v33, v33
    v_mfma_f32_16x16x32_bf16 a[8:11], a[216:219], v[28:31], a[8:11]
    v_exp_f32 v34, v34
    v_mfma_f32_16x16x32_bf16 a[12:15], a[220:223], v[28:31], a[12:15]
    v_exp_f32 v35, v35
    v_mfma_f32_16x16x32_bf16 a[16:19], a[224:227], v[28:31], a[16:19]
    v_add_f32 v22, v22, v44
    v_add_f32 v22, v22, v45
    v_mfma_f32_16x16x32_bf16 a[20:23], a[228:231], v[28:31], a[20:23]
    v_exp_f32 v36, v36
    v_mfma_f32_16x16x32_bf16 a[24:27], a[232:235], v[28:31], a[24:27]
    v_exp_f32 v37, v37
    v_mfma_f32_16x16x32_bf16 a[28:31], a[236:239], v[28:31], a[28:31]
    s_waitcnt lgkmcnt(7)
    v_add_f32 v22, v22, v46
    v_add_f32 v22, v22, v47
    v_mfma_f32_16x16x32_bf16 v[40:43], a[176:179], a[64:67], v[48:51]
    s_waitcnt lgkmcnt(6)
    v_cvt_pk_bf16_f32 v24, v32, v33
    v_cvt_pk_bf16_f32 v25, v34, v35
    v_mfma_f32_16x16x32_bf16 v[40:43], a[180:183], a[68:71], v[40:43]
    s_waitcnt lgkmcnt(5)
    v_exp_f32 v38, v38
    v_mfma_f32_16x16x32_bf16 v[40:43], a[184:187], a[72:75], v[40:43]
    s_waitcnt lgkmcnt(4)
    v_exp_f32 v39, v39
    v_mfma_f32_16x16x32_bf16 v[40:43], a[188:191], a[76:79], v[40:43]
    s_waitcnt lgkmcnt(3)
    v_add_f32 v23, v23, v32
    v_add_f32 v23, v23, v33
    v_mfma_f32_16x16x32_bf16 v[44:47], a[192:195], a[64:67], v[48:51]
    s_waitcnt lgkmcnt(2)
    v_cvt_pk_bf16_f32 v26, v36, v37
    v_cvt_pk_bf16_f32 v27, v38, v39
    v_mfma_f32_16x16x32_bf16 v[44:47], a[196:199], a[68:71], v[44:47]
    s_waitcnt lgkmcnt(1)
    v_add_f32 v23, v23, v34
    v_add_f32 v23, v23, v35
    v_mfma_f32_16x16x32_bf16 v[44:47], a[200:203], a[72:75], v[44:47]
    s_waitcnt lgkmcnt(0)
    v_add_f32 v23, v23, v36
    v_add_f32 v23, v23, v37
    v_mfma_f32_16x16x32_bf16 v[44:47], a[204:207], a[76:79], v[44:47]
    v_add_f32 v23, v23, v38
    v_add_f32 v23, v23, v39
    v_mfma_f32_16x16x32_bf16 a[32:35], a[208:211], v[24:27], a[32:35]
    ds_read_b64_tr_b16 a[208:209], v5 offset:24576
    ds_read_b64_tr_b16 a[210:211], v5 offset:28672
    v_mfma_f32_16x16x32_bf16 a[36:39], a[212:215], v[24:27], a[36:39]
    v_exp_f32 v40, v40
    v_mfma_f32_16x16x32_bf16 a[40:43], a[216:219], v[24:27], a[40:43]
    ds_read_b64_tr_b16 a[212:213], v6 offset:24576
    ds_read_b64_tr_b16 a[214:215], v6 offset:28672
    v_mfma_f32_16x16x32_bf16 a[44:47], a[220:223], v[24:27], a[44:47]
    v_exp_f32 v41, v41
    v_mfma_f32_16x16x32_bf16 a[48:51], a[224:227], v[24:27], a[48:51]
    v_exp_f32 v42, v42
    v_mfma_f32_16x16x32_bf16 a[52:55], a[228:231], v[24:27], a[52:55]
    ds_read_b64_tr_b16 a[216:217], v7 offset:24576
    ds_read_b64_tr_b16 a[218:219], v7 offset:28672
    v_mfma_f32_16x16x32_bf16 a[56:59], a[232:235], v[24:27], a[56:59]
    v_exp_f32 v43, v43
    v_mfma_f32_16x16x32_bf16 a[60:63], a[236:239], v[24:27], a[60:63]
    v_exp_f32 v44, v44
    v_mfma_f32_16x16x32_bf16 v[32:35], a[176:179], a[80:83], v[52:55]
    ds_read_b64_tr_b16 a[220:221], v8 offset:24576
    ds_read_b64_tr_b16 a[222:223], v8 offset:28672
    v_mfma_f32_16x16x32_bf16 v[32:35], a[180:183], a[84:87], v[32:35]
    v_exp_f32 v45, v45
    v_mfma_f32_16x16x32_bf16 v[32:35], a[184:187], a[88:91], v[32:35]
    ds_read_b64_tr_b16 a[224:225], v9 offset:24576
    v_cvt_pk_bf16_f32 v28, v40, v41
    v_mfma_f32_16x16x32_bf16 v[32:35], a[188:191], a[92:95], v[32:35]
    v_exp_f32 v46, v46
    v_mfma_f32_16x16x32_bf16 v[36:39], a[192:195], a[80:83], v[52:55]
    ds_read_b64_tr_b16 a[226:227], v9 offset:28672
    v_cvt_pk_bf16_f32 v29, v42, v43
    v_mfma_f32_16x16x32_bf16 v[36:39], a[196:199], a[84:87], v[36:39]
    v_exp_f32 v47, v47
    v_mfma_f32_16x16x32_bf16 v[36:39], a[200:203], a[88:91], v[36:39]
    v_cvt_pk_bf16_f32 v30, v44, v45
    v_cvt_pk_bf16_f32 v31, v46, v47
    v_mfma_f32_16x16x32_bf16 v[36:39], a[204:207], a[92:95], v[36:39]
    s_waitcnt lgkmcnt(8)
    ds_read_b64_tr_b16 a[228:229], v10 offset:24576
    ds_read_b64_tr_b16 a[230:231], v10 offset:28672
    v_mfma_f32_16x16x32_bf16 v[96:99], a[208:211], v[28:31], v[96:99]
    s_waitcnt lgkmcnt(8)
    ds_read_b64_tr_b16 a[232:233], v11 offset:24576
    ds_read_b64_tr_b16 a[234:235], v11 offset:28672
    v_mfma_f32_16x16x32_bf16 v[100:103], a[212:215], v[28:31], v[100:103]
    s_waitcnt lgkmcnt(8)
    ds_read_b64_tr_b16 a[236:237], v12 offset:24576
    ds_read_b64_tr_b16 a[238:239], v12 offset:28672
    v_mfma_f32_16x16x32_bf16 v[104:107], a[216:219], v[28:31], v[104:107]
    s_waitcnt lgkmcnt(8)
    v_exp_f32 v32, v32
    v_mfma_f32_16x16x32_bf16 v[108:111], a[220:223], v[28:31], v[108:111]
    s_waitcnt lgkmcnt(6)
    v_exp_f32 v33, v33
    v_mfma_f32_16x16x32_bf16 v[112:115], a[224:227], v[28:31], v[112:115]
    s_waitcnt lgkmcnt(4)
    v_add_f32 v17, v17, v40
    v_add_f32 v17, v17, v41
    v_mfma_f32_16x16x32_bf16 v[116:119], a[228:231], v[28:31], v[116:119]
    s_waitcnt lgkmcnt(2)
    v_add_f32 v17, v17, v42
    v_add_f32 v17, v17, v43
    v_mfma_f32_16x16x32_bf16 v[120:123], a[232:235], v[28:31], v[120:123]
    s_waitcnt lgkmcnt(0)
    v_exp_f32 v34, v34
    v_mfma_f32_16x16x32_bf16 v[124:127], a[236:239], v[28:31], v[124:127]
    v_exp_f32 v35, v35
    v_mfma_f32_16x16x32_bf16 v[40:43], a[176:179], a[96:99], v[56:59]
    v_exp_f32 v36, v36
    v_mfma_f32_16x16x32_bf16 v[40:43], a[180:183], a[100:103], v[40:43]
    v_add_f32 v17, v17, v44
    v_add_f32 v17, v17, v45
    v_mfma_f32_16x16x32_bf16 v[40:43], a[184:187], a[104:107], v[40:43]
    v_exp_f32 v37, v37
    v_mfma_f32_16x16x32_bf16 v[40:43], a[188:191], a[108:111], v[40:43]
    v_add_f32 v17, v17, v46
    v_add_f32 v17, v17, v47
    v_mfma_f32_16x16x32_bf16 v[44:47], a[192:195], a[96:99], v[56:59]
    v_exp_f32 v38, v38
    v_mfma_f32_16x16x32_bf16 v[44:47], a[196:199], a[100:103], v[44:47]
    v_exp_f32 v39, v39
    v_cvt_pk_bf16_f32 v24, v32, v33
    v_mfma_f32_16x16x32_bf16 v[44:47], a[200:203], a[104:107], v[44:47]
    v_cvt_pk_bf16_f32 v25, v34, v35
    v_cvt_pk_bf16_f32 v26, v36, v37
    v_cvt_pk_bf16_f32 v27, v38, v39
    v_mfma_f32_16x16x32_bf16 v[44:47], a[204:207], a[108:111], v[44:47]
    v_add_f32 v18, v18, v32
    v_add_f32 v18, v18, v33
    v_mfma_f32_16x16x32_bf16 v[128:131], a[208:211], v[24:27], v[128:131]
    v_exp_f32 v40, v40
    v_mfma_f32_16x16x32_bf16 v[132:135], a[212:215], v[24:27], v[132:135]
    v_exp_f32 v41, v41
    v_mfma_f32_16x16x32_bf16 v[136:139], a[216:219], v[24:27], v[136:139]
    v_add_f32 v18, v18, v34
    v_add_f32 v18, v18, v35
    v_mfma_f32_16x16x32_bf16 v[140:143], a[220:223], v[24:27], v[140:143]
    v_exp_f32 v42, v42
    v_mfma_f32_16x16x32_bf16 v[144:147], a[224:227], v[24:27], v[144:147]
    v_exp_f32 v43, v43
    v_mfma_f32_16x16x32_bf16 v[148:151], a[228:231], v[24:27], v[148:151]
    v_add_f32 v18, v18, v36
    v_add_f32 v18, v18, v37
    v_mfma_f32_16x16x32_bf16 v[152:155], a[232:235], v[24:27], v[152:155]
    v_exp_f32 v44, v44
    v_mfma_f32_16x16x32_bf16 v[156:159], a[236:239], v[24:27], v[156:159]
    v_exp_f32 v45, v45
    v_mfma_f32_16x16x32_bf16 v[32:35], a[176:179], a[112:115], v[60:63]
    v_add_f32 v18, v18, v38
    v_add_f32 v18, v18, v39
    v_mfma_f32_16x16x32_bf16 v[32:35], a[180:183], a[116:119], v[32:35]
    v_cvt_pk_bf16_f32 v28, v40, v41
    v_cvt_pk_bf16_f32 v29, v42, v43
    v_mfma_f32_16x16x32_bf16 v[32:35], a[184:187], a[120:123], v[32:35]
    v_exp_f32 v46, v46
    v_mfma_f32_16x16x32_bf16 v[32:35], a[188:191], a[124:127], v[32:35]
    v_exp_f32 v47, v47
    v_mfma_f32_16x16x32_bf16 v[36:39], a[192:195], a[112:115], v[60:63]
    v_add_f32 v19, v19, v40
    v_add_f32 v19, v19, v41
    v_mfma_f32_16x16x32_bf16 v[36:39], a[196:199], a[116:119], v[36:39]
    v_cvt_pk_bf16_f32 v30, v44, v45
    v_cvt_pk_bf16_f32 v31, v46, v47
    v_mfma_f32_16x16x32_bf16 v[36:39], a[200:203], a[120:123], v[36:39]
    v_add_f32 v19, v19, v42
    v_add_f32 v19, v19, v43
    v_mfma_f32_16x16x32_bf16 v[36:39], a[204:207], a[124:127], v[36:39]
    v_add_f32 v19, v19, v44
    v_add_f32 v19, v19, v45
    v_mfma_f32_16x16x32_bf16 v[160:163], a[208:211], v[28:31], v[160:163]
    v_exp_f32 v32, v32
    v_mfma_f32_16x16x32_bf16 v[164:167], a[212:215], v[28:31], v[164:167]
    v_exp_f32 v33, v33
    v_mfma_f32_16x16x32_bf16 v[168:171], a[216:219], v[28:31], v[168:171]
    v_exp_f32 v34, v34
    v_mfma_f32_16x16x32_bf16 v[172:175], a[220:223], v[28:31], v[172:175]
    v_exp_f32 v35, v35
    v_mfma_f32_16x16x32_bf16 v[176:179], a[224:227], v[28:31], v[176:179]
    v_mfma_f32_16x16x32_bf16 v[180:183], a[228:231], v[28:31], v[180:183]
    v_exp_f32 v36, v36
    v_mfma_f32_16x16x32_bf16 v[184:187], a[232:235], v[28:31], v[184:187]
    v_exp_f32 v37, v37
    v_mfma_f32_16x16x32_bf16 v[188:191], a[236:239], v[28:31], v[188:191]
    v_add_f32 v19, v19, v46
    v_add_f32 v19, v19, v47
    v_mfma_f32_16x16x32_bf16 v[40:43], a[176:179], a[128:131], v[64:67]
    v_cvt_pk_bf16_f32 v24, v32, v33
    v_cvt_pk_bf16_f32 v25, v34, v35
    v_mfma_f32_16x16x32_bf16 v[40:43], a[180:183], a[132:135], v[40:43]
    v_exp_f32 v38, v38
    v_mfma_f32_16x16x32_bf16 v[40:43], a[184:187], a[136:139], v[40:43]
    v_exp_f32 v39, v39
    v_mfma_f32_16x16x32_bf16 v[40:43], a[188:191], a[140:143], v[40:43]
    v_add_f32 v20, v20, v32
    v_add_f32 v20, v20, v33
    v_mfma_f32_16x16x32_bf16 v[44:47], a[192:195], a[128:131], v[64:67]
    v_cvt_pk_bf16_f32 v26, v36, v37
    v_cvt_pk_bf16_f32 v27, v38, v39
    v_mfma_f32_16x16x32_bf16 v[44:47], a[196:199], a[132:135], v[44:47]
    v_add_f32 v20, v20, v34
    v_add_f32 v20, v20, v35
    v_mfma_f32_16x16x32_bf16 v[44:47], a[200:203], a[136:139], v[44:47]
    v_add_f32 v20, v20, v36
    v_add_f32 v20, v20, v37
    v_mfma_f32_16x16x32_bf16 v[44:47], a[204:207], a[140:143], v[44:47]
    v_add_f32 v20, v20, v38
    v_add_f32 v20, v20, v39
    v_mfma_f32_16x16x32_bf16 v[192:195], a[208:211], v[24:27], v[192:195]
    v_exp_f32 v40, v40
    v_mfma_f32_16x16x32_bf16 v[196:199], a[212:215], v[24:27], v[196:199]
    v_exp_f32 v41, v41
    v_mfma_f32_16x16x32_bf16 v[200:203], a[216:219], v[24:27], v[200:203]
    v_exp_f32 v42, v42
    v_mfma_f32_16x16x32_bf16 v[204:207], a[220:223], v[24:27], v[204:207]
    v_exp_f32 v43, v43
    v_mfma_f32_16x16x32_bf16 v[208:211], a[224:227], v[24:27], v[208:211]
    v_mfma_f32_16x16x32_bf16 v[212:215], a[228:231], v[24:27], v[212:215]
    v_exp_f32 v44, v44
    v_mfma_f32_16x16x32_bf16 v[216:219], a[232:235], v[24:27], v[216:219]
    v_exp_f32 v45, v45
    v_mfma_f32_16x16x32_bf16 v[220:223], a[236:239], v[24:27], v[220:223]
    v_cvt_pk_bf16_f32 v28, v40, v41
    v_cvt_pk_bf16_f32 v29, v42, v43
    v_mfma_f32_16x16x32_bf16 v[32:35], a[176:179], a[144:147], v[68:71]
    v_exp_f32 v46, v46
    v_mfma_f32_16x16x32_bf16 v[32:35], a[180:183], a[148:151], v[32:35]
    v_exp_f32 v47, v47
    v_mfma_f32_16x16x32_bf16 v[32:35], a[184:187], a[152:155], v[32:35]
    v_add_f32 v21, v21, v40
    v_add_f32 v21, v21, v41
    v_mfma_f32_16x16x32_bf16 v[32:35], a[188:191], a[156:159], v[32:35]
    v_cvt_pk_bf16_f32 v30, v44, v45
    v_cvt_pk_bf16_f32 v31, v46, v47
    v_mfma_f32_16x16x32_bf16 v[36:39], a[192:195], a[144:147], v[68:71]
    v_add_f32 v21, v21, v42
    v_add_f32 v21, v21, v43
    v_mfma_f32_16x16x32_bf16 v[36:39], a[196:199], a[148:151], v[36:39]
    v_add_f32 v21, v21, v44
    v_add_f32 v21, v21, v45
    v_mfma_f32_16x16x32_bf16 v[36:39], a[200:203], a[152:155], v[36:39]
    v_add_f32 v21, v21, v46
    v_add_f32 v21, v21, v47
    v_mfma_f32_16x16x32_bf16 v[36:39], a[204:207], a[156:159], v[36:39]
    v_mfma_f32_16x16x32_bf16 v[224:227], a[208:211], v[28:31], v[224:227]
    v_exp_f32 v32, v32
    v_mfma_f32_16x16x32_bf16 v[228:231], a[212:215], v[28:31], v[228:231]
    v_exp_f32 v33, v33
    v_mfma_f32_16x16x32_bf16 v[232:235], a[216:219], v[28:31], v[232:235]
    v_exp_f32 v34, v34
    v_mfma_f32_16x16x32_bf16 v[236:239], a[220:223], v[28:31], v[236:239]
    v_exp_f32 v35, v35
    v_mfma_f32_16x16x32_bf16 v[240:243], a[224:227], v[28:31], v[240:243]
    v_exp_f32 v36, v36
    v_mfma_f32_16x16x32_bf16 v[244:247], a[228:231], v[28:31], v[244:247]
    v_exp_f32 v37, v37
    v_mfma_f32_16x16x32_bf16 v[248:251], a[232:235], v[28:31], v[248:251]
    v_cvt_pk_bf16_f32 v24, v32, v33
    v_cvt_pk_bf16_f32 v25, v34, v35
    v_mfma_f32_16x16x32_bf16 v[252:255], a[236:239], v[28:31], v[252:255]
    v_exp_f32 v38, v38
    v_mfma_f32_16x16x32_bf16 v[40:43], a[176:179], a[160:163], v[72:75]
    v_exp_f32 v39, v39
    v_mfma_f32_16x16x32_bf16 v[40:43], a[180:183], a[164:167], v[40:43]
    v_mfma_f32_16x16x32_bf16 v[40:43], a[184:187], a[168:171], v[40:43]
    v_cvt_pk_bf16_f32 v26, v36, v37
    v_cvt_pk_bf16_f32 v27, v38, v39
    v_mfma_f32_16x16x32_bf16 v[40:43], a[188:191], a[172:175], v[40:43]
    v_mfma_f32_16x16x32_bf16 v[44:47], a[192:195], a[160:163], v[72:75]
    v_add_f32 v22, v22, v32
    v_mfma_f32_16x16x32_bf16 v[44:47], a[196:199], a[164:167], v[44:47]
    v_add_f32 v22, v22, v33
    v_mfma_f32_16x16x32_bf16 v[44:47], a[200:203], a[168:171], v[44:47]
    v_add_f32 v22, v22, v34
    v_mfma_f32_16x16x32_bf16 v[44:47], a[204:207], a[172:175], v[44:47]
    v_add_f32 v22, v22, v35
    v_mfma_f32_16x16x32_bf16 a[0:3], a[208:211], v[24:27], a[0:3]
    v_exp_f32 v40, v40
    v_mfma_f32_16x16x32_bf16 a[4:7], a[212:215], v[24:27], a[4:7]
    v_exp_f32 v41, v41
    v_mfma_f32_16x16x32_bf16 a[8:11], a[216:219], v[24:27], a[8:11]
    v_exp_f32 v42, v42
    v_mfma_f32_16x16x32_bf16 a[12:15], a[220:223], v[24:27], a[12:15]
    v_exp_f32 v43, v43
    v_mfma_f32_16x16x32_bf16 a[16:19], a[224:227], v[24:27], a[16:19]
    v_add_f32 v22, v22, v36
    v_add_f32 v22, v22, v37
    v_mfma_f32_16x16x32_bf16 a[20:23], a[228:231], v[24:27], a[20:23]
    v_exp_f32 v44, v44
    v_mfma_f32_16x16x32_bf16 a[24:27], a[232:235], v[24:27], a[24:27]
    v_exp_f32 v45, v45
    v_mfma_f32_16x16x32_bf16 a[28:31], a[236:239], v[24:27], a[28:31]
    v_add_f32 v22, v22, v38
    v_add_f32 v22, v22, v39
    v_cvt_pk_bf16_f32 v28, v40, v41
    v_cvt_pk_bf16_f32 v29, v42, v43
    v_exp_f32 v46, v46
    v_exp_f32 v47, v47
    v_add_f32 v23, v23, v40
    v_add_f32 v23, v23, v41
    v_cvt_pk_bf16_f32 v30, v44, v45
    v_cvt_pk_bf16_f32 v31, v46, v47
    v_add_f32 v23, v23, v42
    v_add_f32 v23, v23, v43
    v_add_f32 v23, v23, v44
    v_add_f32 v23, v23, v45
    v_add_f32 v23, v23, v46
    v_add_f32 v23, v23, v47
    v_mfma_f32_16x16x32_bf16 a[32:35], a[208:211], v[28:31], a[32:35]
    v_mfma_f32_16x16x32_bf16 a[36:39], a[212:215], v[28:31], a[36:39]
    v_mfma_f32_16x16x32_bf16 a[40:43], a[216:219], v[28:31], a[40:43]
    v_mfma_f32_16x16x32_bf16 a[44:47], a[220:223], v[28:31], a[44:47]
    v_mfma_f32_16x16x32_bf16 a[48:51], a[224:227], v[28:31], a[48:51]
    v_mfma_f32_16x16x32_bf16 a[52:55], a[228:231], v[28:31], a[52:55]
    v_mfma_f32_16x16x32_bf16 a[56:59], a[232:235], v[28:31], a[56:59]
    v_mfma_f32_16x16x32_bf16 a[60:63], a[236:239], v[28:31], a[60:63]
    v_mov_b32 v32, v17
    v_mov_b32 v34, v18
    v_mov_b32 v36, v19
    v_mov_b32 v38, v20
    v_mov_b32 v40, v21
    v_mov_b32 v42, v22
    v_mov_b32 v44, v23
    v_permlane16_swap_b32 v17, v32
    v_permlane16_swap_b32 v18, v34
    v_permlane16_swap_b32 v19, v36
    v_permlane16_swap_b32 v20, v38
    v_permlane16_swap_b32 v21, v40
    v_permlane16_swap_b32 v22, v42
    v_permlane16_swap_b32 v23, v44
    v_add_f32 v17, v17, v32
    v_add_f32 v18, v18, v34
    v_add_f32 v19, v19, v36
    v_add_f32 v20, v20, v38
    v_add_f32 v21, v21, v40
    v_add_f32 v22, v22, v42
    v_add_f32 v23, v23, v44
    v_mov_b32 v32, v17
    v_mov_b32 v34, v18
    v_mov_b32 v36, v19
    v_mov_b32 v38, v20
    v_mov_b32 v40, v21
    v_mov_b32 v42, v22
    v_mov_b32 v44, v23
    v_permlane32_swap_b32 v17, v32
    v_permlane32_swap_b32 v18, v34
    v_permlane32_swap_b32 v19, v36
    v_permlane32_swap_b32 v20, v38
    v_permlane32_swap_b32 v21, v40
    v_permlane32_swap_b32 v22, v42
    v_permlane32_swap_b32 v23, v44
    v_add_f32 v17, v17, v32
    v_add_f32 v18, v18, v34
    v_add_f32 v19, v19, v36
    v_add_f32 v20, v20, v38
    v_add_f32 v21, v21, v40
    v_add_f32 v22, v22, v42
    v_add_f32 v23, v23, v44
    s_mov_b32 s64, 0x2f800000
    s_mov_b32 s65, 0x4f800000
    s_mov_b64 s[66:67], 0
    v_cmp_nle_f32 vcc, s64, v17
    v_cmp_nge_f32 s[98:99], s65, v17
    v_rcp_f32 v32, v17
    s_or_b64 s[66:67], s[66:67], vcc
    s_or_b64 s[66:67], s[66:67], s[98:99]
    v_cmp_nle_f32 vcc, s64, v18
    v_cmp_nge_f32 s[98:99], s65, v18
    v_rcp_f32 v34, v18
    s_or_b64 s[66:67], s[66:67], vcc
    s_or_b64 s[66:67], s[66:67], s[98:99]
    v_cmp_nle_f32 vcc, s64, v19
    v_cmp_nge_f32 s[98:99], s65, v19
    v_rcp_f32 v36, v19
    s_or_b64 s[66:67], s[66:67], vcc
    s_or_b64 s[66:67], s[66:67], s[98:99]
    v_cmp_nle_f32 vcc, s64, v20
    v_cmp_nge_f32 s[98:99], s65, v20
    v_rcp_f32 v38, v20
    s_or_b64 s[66:67], s[66:67], vcc
    s_or_b64 s[66:67], s[66:67], s[98:99]
    v_cmp_nle_f32 vcc, s64, v21
    v_cmp_nge_f32 s[98:99], s65, v21
    v_rcp_f32 v40, v21
    s_or_b64 s[66:67], s[66:67], vcc
    s_or_b64 s[66:67], s[66:67], s[98:99]
    v_cmp_nle_f32 vcc, s64, v22
    v_cmp_nge_f32 s[98:99], s65, v22
    v_rcp_f32 v42, v22
    s_or_b64 s[66:67], s[66:67], vcc
    s_or_b64 s[66:67], s[66:67], s[98:99]
    v_cmp_nle_f32 vcc, s64, v23
    v_cmp_nge_f32 s[98:99], s65, v23
    v_rcp_f32 v44, v23
    s_or_b64 s[66:67], s[66:67], vcc
    s_or_b64 s[66:67], s[66:67], s[98:99]
    s_or_b32 s64, s66, s67
    s_lshl_b32 s65, s24, 2
    s_add_u32 s65, s65, 32768
    v_mov_b32 v48, s65
    v_mov_b32 v49, s64
    v_mov_b32 v50, 32768
    ds_write_b32 v48, v49
    s_waitcnt lgkmcnt(0)
    s_barrier
    ds_read_b128 v[52:55], v50
    v_and_b32 v24, 63, v0
    v_lshlrev_b32 v17, 4, v24
    v_add_u32 v18, 4096, v17
    s_waitcnt lgkmcnt(0)
    v_or_b32 v52, v52, v53
    v_or3_b32 v52, v52, v54, v55
    s_nop 0
    v_readfirstlane_b32 s64, v52
    s_nop 1
    s_cmp_eq_u32 s64, 0
    s_cbranch_scc1 L_store
    s_cmp_eq_u32 s35, 0
    s_cbranch_scc1 L_maxpass
L_store:
    v_accvgpr_read_b32 v48, a0
    v_accvgpr_read_b32 v49, a1
    v_accvgpr_read_b32 v50, a2
    v_accvgpr_read_b32 v51, a3
    v_accvgpr_read_b32 v52, a4
    v_accvgpr_read_b32 v53, a5
    v_accvgpr_read_b32 v54, a6
    v_accvgpr_read_b32 v55, a7
    v_accvgpr_read_b32 v56, a8
    v_accvgpr_read_b32 v57, a9
    v_accvgpr_read_b32 v58, a10
    v_accvgpr_read_b32 v59, a11
    v_accvgpr_read_b32 v60, a12
    v_accvgpr_read_b32 v61, a13
    v_accvgpr_read_b32 v62, a14
    v_accvgpr_read_b32 v63, a15
    v_accvgpr_read_b32 v64, a16
    v_accvgpr_read_b32 v65, a17
    v_accvgpr_read_b32 v66, a18
    v_accvgpr_read_b32 v67, a19
    v_accvgpr_read_b32 v68, a20
    v_accvgpr_read_b32 v69, a21
    v_accvgpr_read_b32 v70, a22
    v_accvgpr_read_b32 v71, a23
    v_accvgpr_read_b32 v72, a24
    v_accvgpr_read_b32 v73, a25
    v_accvgpr_read_b32 v74, a26
    v_accvgpr_read_b32 v75, a27
    v_accvgpr_read_b32 v76, a28
    v_accvgpr_read_b32 v77, a29
    v_accvgpr_read_b32 v78, a30
    v_accvgpr_read_b32 v79, a31
    v_pk_mul_f32 v[48:49], v[48:49], v[42:43] op_sel_hi:[1,0]
    v_pk_mul_f32 v[50:51], v[50:51], v[42:43] op_sel_hi:[1,0]
    v_pk_mul_f32 v[52:53], v[52:53], v[42:43] op_sel_hi:[1,0]
    v_pk_mul_f32 v[54:55], v[54:55], v[42:43] op_sel_hi:[1,0]
    v_pk_mul_f32 v[56:57], v[56:57], v[42:43] op_sel_hi:[1,0]
    v_pk_mul_f32 v[58:59], v[58:59], v[42:43] op_sel_hi:[1,0]
    v_pk_mul_f32 v[60:61], v[60:61], v[42:43] op_sel_hi:[1,0]
    v_pk_mul_f32 v[62:63], v[62:63], v[42:43] op_sel_hi:[1,0]
    v_pk_mul_f32 v[64:65], v[64:65], v[42:43] op_sel_hi:[1,0]
    v_pk_mul_f32 v[66:67], v[66:67], v[42:43] op_sel_hi:[1,0]
    v_pk_mul_f32 v[68:69], v[68:69], v[42:43] op_sel_hi:[1,0]
    v_pk_mul_f32 v[70:71], v[70:71], v[42:43] op_sel_hi:[1,0]
    v_pk_mul_f32 v[72:73], v[72:73], v[42:43] op_sel_hi:[1,0]
    v_pk_mul_f32 v[74:75], v[74:75], v[42:43] op_sel_hi:[1,0]
    v_pk_mul_f32 v[76:77], v[76:77], v[42:43] op_sel_hi:[1,0]
    v_pk_mul_f32 v[78:79], v[78:79], v[42:43] op_sel_hi:[1,0]
    v_cvt_pk_bf16_f32 v48, v48, v49
    v_cvt_pk_bf16_f32 v49, v50, v51
    v_cvt_pk_bf16_f32 v50, v52, v53
    v_cvt_pk_bf16_f32 v51, v54, v55
    s_mov_b32 s64, 4096
    buffer_store_dwordx4 v[48:51], v17, s[20:23], s64 offen offset:1024 sc1
    v_cvt_pk_bf16_f32 v56, v56, v57
    v_cvt_pk_bf16_f32 v57, v58, v59
    v_cvt_pk_bf16_f32 v58, v60, v61
    v_cvt_pk_bf16_f32 v59, v62, v63
    s_mov_b32 s65, 12288
    buffer_store_dwordx4 v[56:59], v17, s[20:23], s65 offen sc1
    v_cvt_pk_bf16_f32 v64, v64, v65
    v_cvt_pk_bf16_f32 v65, v66, v67
    v_cvt_pk_bf16_f32 v66, v68, v69
    v_cvt_pk_bf16_f32 v67, v70, v71
    s_mov_b32 s64, 16384
    buffer_store_dwordx4 v[64:67], v17, s[20:23], s64 offen offset:3072 sc1
    v_cvt_pk_bf16_f32 v72, v72, v73
    v_cvt_pk_bf16_f32 v73, v74, v75
    v_cvt_pk_bf16_f32 v74, v76, v77
    v_cvt_pk_bf16_f32 v75, v78, v79
    s_mov_b32 s65, 24576
    buffer_store_dwordx4 v[72:75], v17, s[20:23], s65 offen offset:2048 sc1
    v_pk_mul_f32 v[96:97], v[96:97], v[32:33] op_sel_hi:[1,0]
    v_pk_mul_f32 v[98:99], v[98:99], v[32:33] op_sel_hi:[1,0]
    v_pk_mul_f32 v[100:101], v[100:101], v[32:33] op_sel_hi:[1,0]
    v_pk_mul_f32 v[102:103], v[102:103], v[32:33] op_sel_hi:[1,0]
    v_pk_mul_f32 v[104:105], v[104:105], v[32:33] op_sel_hi:[1,0]
    v_pk_mul_f32 v[106:107], v[106:107], v[32:33] op_sel_hi:[1,0]
    v_pk_mul_f32 v[108:109], v[108:109], v[32:33] op_sel_hi:[1,0]
    v_pk_mul_f32 v[110:111], v[110:111], v[32:33] op_sel_hi:[1,0]
    v_pk_mul_f32 v[112:113], v[112:113], v[32:33] op_sel_hi:[1,0]
    v_pk_mul_f32 v[114:115], v[114:115], v[32:33] op_sel_hi:[1,0]
    v_pk_mul_f32 v[116:117], v[116:117], v[32:33] op_sel_hi:[1,0]
    v_pk_mul_f32 v[118:119], v[118:119], v[32:33] op_sel_hi:[1,0]
    v_pk_mul_f32 v[120:121], v[120:121], v[32:33] op_sel_hi:[1,0]
    v_pk_mul_f32 v[122:123], v[122:123], v[32:33] op_sel_hi:[1,0]
    v_pk_mul_f32 v[124:125], v[124:125], v[32:33] op_sel_hi:[1,0]
    v_pk_mul_f32 v[126:127], v[126:127], v[32:33] op_sel_hi:[1,0]
    v_cvt_pk_bf16_f32 v96, v96, v97
    v_cvt_pk_bf16_f32 v97, v98, v99
    v_cvt_pk_bf16_f32 v98, v100, v101
    v_cvt_pk_bf16_f32 v99, v102, v103
    s_mov_b32 s64, 0
    buffer_store_dwordx4 v[96:99], v17, s[20:23], s64 offen sc1
    v_cvt_pk_bf16_f32 v104, v104, v105
    v_cvt_pk_bf16_f32 v105, v106, v107
    v_cvt_pk_bf16_f32 v106, v108, v109
    v_cvt_pk_bf16_f32 v107, v110, v111
    s_mov_b32 s65, 4096
    buffer_store_dwordx4 v[104:107], v17, s[20:23], s65 offen offset:3072 sc1
    v_cvt_pk_bf16_f32 v112, v112, v113
    v_cvt_pk_bf16_f32 v113, v114, v115
    v_cvt_pk_bf16_f32 v114, v116, v117
    v_cvt_pk_bf16_f32 v115, v118, v119
    s_mov_b32 s64, 12288
    buffer_store_dwordx4 v[112:115], v17, s[20:23], s64 offen offset:2048 sc1
    v_cvt_pk_bf16_f32 v120, v120, v121
    v_cvt_pk_bf16_f32 v121, v122, v123
    v_cvt_pk_bf16_f32 v122, v124, v125
    v_cvt_pk_bf16_f32 v123, v126, v127
    s_mov_b32 s65, 20480
    buffer_store_dwordx4 v[120:123], v17, s[20:23], s65 offen offset:1024 sc1
    v_accvgpr_read_b32 v48, a32
    v_accvgpr_read_b32 v49, a33
    v_accvgpr_read_b32 v50, a34
    v_accvgpr_read_b32 v51, a35
    v_accvgpr_read_b32 v52, a36
    v_accvgpr_read_b32 v53, a37
    v_accvgpr_read_b32 v54, a38
    v_accvgpr_read_b32 v55, a39
    v_accvgpr_read_b32 v56, a40
    v_accvgpr_read_b32 v57, a41
    v_accvgpr_read_b32 v58, a42
    v_accvgpr_read_b32 v59, a43
    v_accvgpr_read_b32 v60, a44
    v_accvgpr_read_b32 v61, a45
    v_accvgpr_read_b32 v62, a46
    v_accvgpr_read_b32 v63, a47
    v_accvgpr_read_b32 v64, a48
    v_accvgpr_read_b32 v65, a49
    v_accvgpr_read_b32 v66, a50
    v_accvgpr_read_b32 v67, a51
    v_accvgpr_read_b32 v68, a52
    v_accvgpr_read_b32 v69, a53
    v_accvgpr_read_b32 v70, a54
    v_accvgpr_read_b32 v71, a55
    v_accvgpr_read_b32 v72, a56
    v_accvgpr_read_b32 v73, a57
    v_accvgpr_read_b32 v74, a58
    v_accvgpr_read_b32 v75, a59
    v_accvgpr_read_b32 v76, a60
    v_accvgpr_read_b32 v77, a61
    v_accvgpr_read_b32 v78, a62
    v_accvgpr_read_b32 v79, a63
    v_pk_mul_f32 v[48:49], v[48:49], v[44:45] op_sel_hi:[1,0]
    v_pk_mul_f32 v[50:51], v[50:51], v[44:45] op_sel_hi:[1,0]
    v_pk_mul_f32 v[52:53], v[52:53], v[44:45] op_sel_hi:[1,0]
    v_pk_mul_f32 v[54:55], v[54:55], v[44:45] op_sel_hi:[1,0]
    v_pk_mul_f32 v[56:57], v[56:57], v[44:45] op_sel_hi:[1,0]
    v_pk_mul_f32 v[58:59], v[58:59], v[44:45] op_sel_hi:[1,0]
    v_pk_mul_f32 v[60:61], v[60:61], v[44:45] op_sel_hi:[1,0]
    v_pk_mul_f32 v[62:63], v[62:63], v[44:45] op_sel_hi:[1,0]
    v_pk_mul_f32 v[64:65], v[64:65], v[44:45] op_sel_hi:[1,0]
    v_pk_mul_f32 v[66:67], v[66:67], v[44:45] op_sel_hi:[1,0]
    v_pk_mul_f32 v[68:69], v[68:69], v[44:45] op_sel_hi:[1,0]
    v_pk_mul_f32 v[70:71], v[70:71], v[44:45] op_sel_hi:[1,0]
    v_pk_mul_f32 v[72:73], v[72:73], v[44:45] op_sel_hi:[1,0]
    v_pk_mul_f32 v[74:75], v[74:75], v[44:45] op_sel_hi:[1,0]
    v_pk_mul_f32 v[76:77], v[76:77], v[44:45] op_sel_hi:[1,0]
    v_pk_mul_f32 v[78:79], v[78:79], v[44:45] op_sel_hi:[1,0]
    v_cvt_pk_bf16_f32 v48, v48, v49
    v_cvt_pk_bf16_f32 v49, v50, v51
    v_cvt_pk_bf16_f32 v50, v52, v53
    v_cvt_pk_bf16_f32 v51, v54, v55
    s_mov_b32 s64, 4096
    buffer_store_dwordx4 v[48:51], v17, s[20:23], s64 offen offset:2048 sc1
    v_cvt_pk_bf16_f32 v56, v56, v57
    v_cvt_pk_bf16_f32 v57, v58, v59
    v_cvt_pk_bf16_f32 v58, v60, v61
    v_cvt_pk_bf16_f32 v59, v62, v63
    s_mov_b32 s65, 12288
    buffer_store_dwordx4 v[56:59], v17, s[20:23], s65 offen offset:1024 sc1
    v_cvt_pk_bf16_f32 v64, v64, v65
    v_cvt_pk_bf16_f32 v65, v66, v67
    v_cvt_pk_bf16_f32 v66, v68, v69
    v_cvt_pk_bf16_f32 v67, v70, v71
    s_mov_b32 s64, 20480
    buffer_store_dwordx4 v[64:67], v17, s[20:23], s64 offen sc1
    v_cvt_pk_bf16_f32 v72, v72, v73
    v_cvt_pk_bf16_f32 v73, v74, v75
    v_cvt_pk_bf16_f32 v74, v76, v77
    v_cvt_pk_bf16_f32 v75, v78, v79
    s_mov_b32 s65, 24576
    buffer_store_dwordx4 v[72:75], v17, s[20:23], s65 offen offset:3072 sc1
    v_pk_mul_f32 v[128:129], v[128:129], v[34:35] op_sel_hi:[1,0]
    v_pk_mul_f32 v[130:131], v[130:131], v[34:35] op_sel_hi:[1,0]
    v_pk_mul_f32 v[132:133], v[132:133], v[34:35] op_sel_hi:[1,0]
    v_pk_mul_f32 v[134:135], v[134:135], v[34:35] op_sel_hi:[1,0]
    v_pk_mul_f32 v[136:137], v[136:137], v[34:35] op_sel_hi:[1,0]
    v_pk_mul_f32 v[138:139], v[138:139], v[34:35] op_sel_hi:[1,0]
    v_pk_mul_f32 v[140:141], v[140:141], v[34:35] op_sel_hi:[1,0]
    v_pk_mul_f32 v[142:143], v[142:143], v[34:35] op_sel_hi:[1,0]
    v_pk_mul_f32 v[144:145], v[144:145], v[34:35] op_sel_hi:[1,0]
    v_pk_mul_f32 v[146:147], v[146:147], v[34:35] op_sel_hi:[1,0]
    v_pk_mul_f32 v[148:149], v[148:149], v[34:35] op_sel_hi:[1,0]
    v_pk_mul_f32 v[150:151], v[150:151], v[34:35] op_sel_hi:[1,0]
    v_pk_mul_f32 v[152:153], v[152:153], v[34:35] op_sel_hi:[1,0]
    v_pk_mul_f32 v[154:155], v[154:155], v[34:35] op_sel_hi:[1,0]
    v_pk_mul_f32 v[156:157], v[156:157], v[34:35] op_sel_hi:[1,0]
    v_pk_mul_f32 v[158:159], v[158:159], v[34:35] op_sel_hi:[1,0]
    v_cvt_pk_bf16_f32 v128, v128, v129
    v_cvt_pk_bf16_f32 v129, v130, v131
    v_cvt_pk_bf16_f32 v130, v132, v133
    v_cvt_pk_bf16_f32 v131, v134, v135
    s_mov_b32 s64, 0
    buffer_store_dwordx4 v[128:131], v17, s[20:23], s64 offen offset:1024 sc1
    v_cvt_pk_bf16_f32 v136, v136, v137
    v_cvt_pk_bf16_f32 v137, v138, v139
    v_cvt_pk_bf16_f32 v138, v140, v141
    v_cvt_pk_bf16_f32 v139, v142, v143
    s_mov_b32 s65, 8192
    buffer_store_dwordx4 v[136:139], v17, s[20:23], s65 offen sc1
    v_cvt_pk_bf16_f32 v144, v144, v145
    v_cvt_pk_bf16_f32 v145, v146, v147
    v_cvt_pk_bf16_f32 v146, v148, v149
    v_cvt_pk_bf16_f32 v147, v150, v151
    s_mov_b32 s64, 12288
    buffer_store_dwordx4 v[144:147], v17, s[20:23], s64 offen offset:3072 sc1
    v_cvt_pk_bf16_f32 v152, v152, v153
    v_cvt_pk_bf16_f32 v153, v154, v155
    v_cvt_pk_bf16_f32 v154, v156, v157
    v_cvt_pk_bf16_f32 v155, v158, v159
    s_mov_b32 s65, 20480
    buffer_store_dwordx4 v[152:155], v17, s[20:23], s65 offen offset:2048 sc1
    v_pk_mul_f32 v[160:161], v[160:161], v[36:37] op_sel_hi:[1,0]
    v_pk_mul_f32 v[162:163], v[162:163], v[36:37] op_sel_hi:[1,0]
    v_pk_mul_f32 v[164:165], v[164:165], v[36:37] op_sel_hi:[1,0]
    v_pk_mul_f32 v[166:167], v[166:167], v[36:37] op_sel_hi:[1,0]
    v_pk_mul_f32 v[168:169], v[168:169], v[36:37] op_sel_hi:[1,0]
    v_pk_mul_f32 v[170:171], v[170:171], v[36:37] op_sel_hi:[1,0]
    v_pk_mul_f32 v[172:173], v[172:173], v[36:37] op_sel_hi:[1,0]
    v_pk_mul_f32 v[174:175], v[174:175], v[36:37] op_sel_hi:[1,0]
    v_pk_mul_f32 v[176:177], v[176:177], v[36:37] op_sel_hi:[1,0]
    v_pk_mul_f32 v[178:179], v[178:179], v[36:37] op_sel_hi:[1,0]
    v_pk_mul_f32 v[180:181], v[180:181], v[36:37] op_sel_hi:[1,0]
    v_pk_mul_f32 v[182:183], v[182:183], v[36:37] op_sel_hi:[1,0]
    v_pk_mul_f32 v[184:185], v[184:185], v[36:37] op_sel_hi:[1,0]
    v_pk_mul_f32 v[186:187], v[186:187], v[36:37] op_sel_hi:[1,0]
    v_pk_mul_f32 v[188:189], v[188:189], v[36:37] op_sel_hi:[1,0]
    v_pk_mul_f32 v[190:191], v[190:191], v[36:37] op_sel_hi:[1,0]
    v_cvt_pk_bf16_f32 v160, v160, v161
    v_cvt_pk_bf16_f32 v161, v162, v163
    v_cvt_pk_bf16_f32 v162, v164, v165
    v_cvt_pk_bf16_f32 v163, v166, v167
    s_mov_b32 s64, 0
    buffer_store_dwordx4 v[160:163], v17, s[20:23], s64 offen offset:2048 sc1
    v_cvt_pk_bf16_f32 v168, v168, v169
    v_cvt_pk_bf16_f32 v169, v170, v171
    v_cvt_pk_bf16_f32 v170, v172, v173
    v_cvt_pk_bf16_f32 v171, v174, v175
    s_mov_b32 s65, 8192
    buffer_store_dwordx4 v[168:171], v17, s[20:23], s65 offen offset:1024 sc1
    v_cvt_pk_bf16_f32 v176, v176, v177
    v_cvt_pk_bf16_f32 v177, v178, v179
    v_cvt_pk_bf16_f32 v178, v180, v181
    v_cvt_pk_bf16_f32 v179, v182, v183
    s_mov_b32 s64, 16384
    buffer_store_dwordx4 v[176:179], v17, s[20:23], s64 offen sc1
    v_cvt_pk_bf16_f32 v184, v184, v185
    v_cvt_pk_bf16_f32 v185, v186, v187
    v_cvt_pk_bf16_f32 v186, v188, v189
    v_cvt_pk_bf16_f32 v187, v190, v191
    s_mov_b32 s65, 20480
    buffer_store_dwordx4 v[184:187], v17, s[20:23], s65 offen offset:3072 sc1
    v_pk_mul_f32 v[192:193], v[192:193], v[38:39] op_sel_hi:[1,0]
    v_pk_mul_f32 v[194:195], v[194:195], v[38:39] op_sel_hi:[1,0]
    v_pk_mul_f32 v[196:197], v[196:197], v[38:39] op_sel_hi:[1,0]
    v_pk_mul_f32 v[198:199], v[198:199], v[38:39] op_sel_hi:[1,0]
    v_pk_mul_f32 v[200:201], v[200:201], v[38:39] op_sel_hi:[1,0]
    v_pk_mul_f32 v[202:203], v[202:203], v[38:39] op_sel_hi:[1,0]
    v_pk_mul_f32 v[204:205], v[204:205], v[38:39] op_sel_hi:[1,0]
    v_pk_mul_f32 v[206:207], v[206:207], v[38:39] op_sel_hi:[1,0]
    v_pk_mul_f32 v[208:209], v[208:209], v[38:39] op_sel_hi:[1,0]
    v_pk_mul_f32 v[210:211], v[210:211], v[38:39] op_sel_hi:[1,0]
    v_pk_mul_f32 v[212:213], v[212:213], v[38:39] op_sel_hi:[1,0]
    v_pk_mul_f32 v[214:215], v[214:215], v[38:39] op_sel_hi:[1,0]
    v_pk_mul_f32 v[216:217], v[216:217], v[38:39] op_sel_hi:[1,0]
    v_pk_mul_f32 v[218:219], v[218:219], v[38:39] op_sel_hi:[1,0]
    v_pk_mul_f32 v[220:221], v[220:221], v[38:39] op_sel_hi:[1,0]
    v_pk_mul_f32 v[222:223], v[222:223], v[38:39] op_sel_hi:[1,0]
    v_cvt_pk_bf16_f32 v192, v192, v193
    v_cvt_pk_bf16_f32 v193, v194, v195
    v_cvt_pk_bf16_f32 v194, v196, v197
    v_cvt_pk_bf16_f32 v195, v198, v199
    s_mov_b32 s64, 0
    buffer_store_dwordx4 v[192:195], v17, s[20:23], s64 offen offset:3072 sc1
    v_cvt_pk_bf16_f32 v200, v200, v201
    v_cvt_pk_bf16_f32 v201, v202, v203
    v_cvt_pk_bf16_f32 v202, v204, v205
    v_cvt_pk_bf16_f32 v203, v206, v207
    s_mov_b32 s65, 8192
    buffer_store_dwordx4 v[200:203], v17, s[20:23], s65 offen offset:2048 sc1
    v_cvt_pk_bf16_f32 v208, v208, v209
    v_cvt_pk_bf16_f32 v209, v210, v211
    v_cvt_pk_bf16_f32 v210, v212, v213
    v_cvt_pk_bf16_f32 v211, v214, v215
    s_mov_b32 s64, 16384
    buffer_store_dwordx4 v[208:211], v17, s[20:23], s64 offen offset:1024 sc1
    v_cvt_pk_bf16_f32 v216, v216, v217
    v_cvt_pk_bf16_f32 v217, v218, v219
    v_cvt_pk_bf16_f32 v218, v220, v221
    v_cvt_pk_bf16_f32 v219, v222, v223
    s_mov_b32 s65, 24576
    buffer_store_dwordx4 v[216:219], v17, s[20:23], s65 offen sc1
    v_pk_mul_f32 v[224:225], v[224:225], v[40:41] op_sel_hi:[1,0]
    v_pk_mul_f32 v[226:227], v[226:227], v[40:41] op_sel_hi:[1,0]
    v_pk_mul_f32 v[228:229], v[228:229], v[40:41] op_sel_hi:[1,0]
    v_pk_mul_f32 v[230:231], v[230:231], v[40:41] op_sel_hi:[1,0]
    v_pk_mul_f32 v[232:233], v[232:233], v[40:41] op_sel_hi:[1,0]
    v_pk_mul_f32 v[234:235], v[234:235], v[40:41] op_sel_hi:[1,0]
    v_pk_mul_f32 v[236:237], v[236:237], v[40:41] op_sel_hi:[1,0]
    v_pk_mul_f32 v[238:239], v[238:239], v[40:41] op_sel_hi:[1,0]
    v_pk_mul_f32 v[240:241], v[240:241], v[40:41] op_sel_hi:[1,0]
    v_pk_mul_f32 v[242:243], v[242:243], v[40:41] op_sel_hi:[1,0]
    v_pk_mul_f32 v[244:245], v[244:245], v[40:41] op_sel_hi:[1,0]
    v_pk_mul_f32 v[246:247], v[246:247], v[40:41] op_sel_hi:[1,0]
    v_pk_mul_f32 v[248:249], v[248:249], v[40:41] op_sel_hi:[1,0]
    v_pk_mul_f32 v[250:251], v[250:251], v[40:41] op_sel_hi:[1,0]
    v_pk_mul_f32 v[252:253], v[252:253], v[40:41] op_sel_hi:[1,0]
    v_pk_mul_f32 v[254:255], v[254:255], v[40:41] op_sel_hi:[1,0]
    v_cvt_pk_bf16_f32 v224, v224, v225
    v_cvt_pk_bf16_f32 v225, v226, v227
    v_cvt_pk_bf16_f32 v226, v228, v229
    v_cvt_pk_bf16_f32 v227, v230, v231
    s_mov_b32 s64, 4096
    buffer_store_dwordx4 v[224:227], v17, s[20:23], s64 offen sc1
    v_cvt_pk_bf16_f32 v232, v232, v233
    v_cvt_pk_bf16_f32 v233, v234, v235
    v_cvt_pk_bf16_f32 v234, v236, v237
    v_cvt_pk_bf16_f32 v235, v238, v239
    s_mov_b32 s65, 8192
    buffer_store_dwordx4 v[232:235], v17, s[20:23], s65 offen offset:3072 sc1
    v_cvt_pk_bf16_f32 v240, v240, v241
    v_cvt_pk_bf16_f32 v241, v242, v243
    v_cvt_pk_bf16_f32 v242, v244, v245
    v_cvt_pk_bf16_f32 v243, v246, v247
    s_mov_b32 s64, 16384
    buffer_store_dwordx4 v[240:243], v17, s[20:23], s64 offen offset:2048 sc1
    v_cvt_pk_bf16_f32 v248, v248, v249
    v_cvt_pk_bf16_f32 v249, v250, v251
    v_cvt_pk_bf16_f32 v250, v252, v253
    v_cvt_pk_bf16_f32 v251, v254, v255
    s_mov_b32 s65, 24576
    buffer_store_dwordx4 v[248:251], v17, s[20:23], s65 offen offset:1024 sc1
    v_mov_b32 v29, 0
    v_mov_b32 v30, s71
    s_waitcnt vmcnt(0)
    s_barrier
    s_cmp_lg_u32 s24, 0
    s_cbranch_scc1 L_noflag
    s_mov_b64 exec, 1
    buffer_store_dword v30, v29, s[16:19], s78 offen sc1
    s_mov_b64 exec, -1
L_noflag:
    s_and_b32 s67, s74, 1
    s_lshr_b32 s68, s74, 1
    v_and_b32 v25, 15, v24
    v_lshrrev_b32 v26, 4, v24
    v_lshlrev_b32 v29, 11, v26
    v_lshlrev_b32 v30, 1, v26
    v_xor_b32 v30, v30, v25
    v_lshlrev_b32 v30, 4, v30
    v_xor_b32 v31, 128, v30
    v_add_u32 v9, v29, v30
    v_add_u32 v9, 0, v9
    v_add_u32 v10, v29, v31
    v_add_u32 v10, 7168, v10
    v_add_u32 v11, v29, v30
    v_add_u32 v11, 14336, v11
    v_add_u32 v12, v29, v31
    v_add_u32 v12, 21504, v12
    v_add_u32 v13, v29, v30
    v_add_u32 v13, 32768, v13
    v_add_u32 v14, v29, v31
    v_add_u32 v14, 39936, v14
    v_add_u32 v15, v29, v30
    v_add_u32 v15, 47104, v15
    v_add_u32 v16, v29, v31
    v_add_u32 v16, 54272, v16
    s_lshl_b32 s64, s24, 21
    s_lshl_b32 s65, s68, 8
    s_add_u32 s64, s64, s65
    s_sub_u32 s66, 2097152, s65
    s_add_u32 s8, s44, s64
    s_addc_u32 s9, s45, 0
    s_mov_b32 s10, s66
    s_mov_b32 s11, 0x20000
    s_mov_b32 s28, 0
    s_add_u32 m0, s33, 0
    s_nop 0
    buffer_load_dwordx4 v9, s[8:11], s28 offen lds
    buffer_load_dwordx4 v10, s[8:11], s28 offen offset:1024 lds
    buffer_load_dwordx4 v11, s[8:11], s28 offen offset:2048 lds
    buffer_load_dwordx4 v12, s[8:11], s28 offen offset:3072 lds
    s_add_u32 m0, s33, 4096
    s_nop 0
    buffer_load_dwordx4 v13, s[8:11], s28 offen lds
    buffer_load_dwordx4 v14, s[8:11], s28 offen offset:1024 lds
    buffer_load_dwordx4 v15, s[8:11], s28 offen offset:2048 lds
    buffer_load_dwordx4 v16, s[8:11], s28 offen offset:3072 lds
    s_add_u32 s28, s28, 65536
    s_add_u32 m0, s33, 8192
    s_nop 0
    buffer_load_dwordx4 v9, s[8:11], s28 offen lds
    buffer_load_dwordx4 v10, s[8:11], s28 offen offset:1024 lds
    buffer_load_dwordx4 v11, s[8:11], s28 offen offset:2048 lds
    buffer_load_dwordx4 v12, s[8:11], s28 offen offset:3072 lds
    s_add_u32 m0, s33, 12288
    s_nop 0
    buffer_load_dwordx4 v13, s[8:11], s28 offen lds
    buffer_load_dwordx4 v14, s[8:11], s28 offen offset:1024 lds
    buffer_load_dwordx4 v15, s[8:11], s28 offen offset:2048 lds
    buffer_load_dwordx4 v16, s[8:11], s28 offen offset:3072 lds
    s_add_u32 s28, s28, 65536
    s_lshl_b32 s64, s72, 3
    s_add_u32 s64, s64, s73
    s_lshl_b32 s66, s64, 1
    s_add_u32 s66, s66, s67
    s_lshl_b32 s66, s66, 2
    s_add_u32 s66, s66, s24
    s_mul_i32 s66, s66, 229376
    s_add_u32 s4, s60, s66
    s_addc_u32 s5, s61, 0
    s_mov_b32 s6, 229376
    s_mov_b32 s7, 0x20000
    s_mov_b32 s27, 0
    s_lshl_b32 s64, s64, 11
    s_lshl_b32 s65, s24, 9
    s_add_u32 s64, s64, s65
    s_add_u32 s78, s64, 4096
    s_mul_i32 s64, s73, 224
    s_mul_i32 s65, s67, 112
    s_add_u32 s64, s64, s65
    s_lshl_b32 s64, s64, 12
    s_lshl_b32 s65, s72, 11
    s_add_u32 s64, s64, s65
    s_lshl_b32 s65, s68, 8
    s_add_u32 s64, s64, s65
    s_add_u32 s20, s56, s64
    s_addc_u32 s21, s57, 0
    s_mov_b32 s22, 454912
    s_mov_b32 s23, 0x20000
    v_and_b32 v29, 1, v26
    v_lshlrev_b32 v29, 1, v29
    v_lshrrev_b32 v30, 1, v26
    v_or_b32 v29, v29, v30
    v_lshlrev_b32 v29, 4, v29
    v_lshl_add_u32 v29, v25, 12, v29
    s_lshl_b32 s64, s24, 6
    v_add_u32 v23, s64, v29
    v_bfe_u32 v27, v24, 2, 2
    v_and_b32 v28, 3, v24
    v_lshl_add_u32 v29, v26, 2, v27
    v_lshlrev_b32 v29, 8, v29
    v_lshl_add_u32 v29, v28, 3, v29
    v_add_u32 v29, s33, v29
    v_and_b32 v26, 1, v26
    v_lshl_add_u32 v26, v26, 2, v27
    s_lshl_b32 s64, s24, 1
    v_xor_b32 v26, s64, v26
    v_lshlrev_b32 v26, 5, v26
    v_xor_b32 v1, 0, v26
    v_add_u32 v1, v29, v1
    v_xor_b32 v2, 32, v26
    v_add_u32 v2, v29, v2
    v_xor_b32 v3, 64, v26
    v_add_u32 v3, v29, v3
    v_xor_b32 v4, 96, v26
    v_add_u32 v4, v29, v4
    v_xor_b32 v5, 128, v26
    v_add_u32 v5, v29, v5
    v_xor_b32 v6, 160, v26
    v_add_u32 v6, v29, v6
    v_xor_b32 v7, 192, v26
    v_add_u32 v7, v29, v7
    v_xor_b32 v8, 224, v26
    v_add_u32 v8, v29, v8
    s_xor_b32 s64, s24, 0
    s_mul_i32 s64, s64, 40960
    v_add_u32 v19, s64, v17
    s_xor_b32 s64, s24, 1
    s_mul_i32 s64, s64, 40960
    v_add_u32 v20, s64, v17
    s_xor_b32 s64, s24, 2
    s_mul_i32 s64, s64, 40960
    v_add_u32 v21, s64, v17
    s_xor_b32 s64, s24, 3
    s_mul_i32 s64, s64, 40960
    v_add_u32 v22, s64, v17
    v_lshlrev_b32 v29, 7, v28
    s_mov_b32 s34, 0x200000
    v_mov_b64 v[32:33], 0
    v_mov_b64 v[34:35], 0
    v_mov_b64 v[36:37], 0
    v_mov_b64 v[38:39], 0
    v_mov_b64 v[40:41], 0
    v_mov_b64 v[42:43], 0
    v_mov_b64 v[44:45], 0
    v_mov_b64 v[46:47], 0
    v_mov_b64 v[48:49], 0
    v_mov_b64 v[50:51], 0
    v_mov_b64 v[52:53], 0
    v_mov_b64 v[54:55], 0
    v_mov_b64 v[56:57], 0
    v_mov_b64 v[58:59], 0
    v_mov_b64 v[60:61], 0
    v_mov_b64 v[62:63], 0
    v_mov_b64 v[64:65], 0
    v_mov_b64 v[66:67], 0
    v_mov_b64 v[68:69], 0
    v_mov_b64 v[70:71], 0
    v_mov_b64 v[72:73], 0
    v_mov_b64 v[74:75], 0
    v_mov_b64 v[76:77], 0
    v_mov_b64 v[78:79], 0
    v_mov_b64 v[80:81], 0
    v_mov_b64 v[82:83], 0
    v_mov_b64 v[84:85], 0
    v_mov_b64 v[86:87], 0
    v_mov_b64 v[88:89], 0
    v_mov_b64 v[90:91], 0
    v_mov_b64 v[92:93], 0
    v_mov_b64 v[94:95], 0
    v_mov_b64 v[96:97], 0
    v_mov_b64 v[98:99], 0
    v_mov_b64 v[100:101], 0
    v_mov_b64 v[102:103], 0
    v_mov_b64 v[104:105], 0
    v_mov_b64 v[106:107], 0
    v_mov_b64 v[108:109], 0
    v_mov_b64 v[110:111], 0
    v_mov_b64 v[112:113], 0
    v_mov_b64 v[114:115], 0
    v_mov_b64 v[116:117], 0
    v_mov_b64 v[118:119], 0
    v_mov_b64 v[120:121], 0
    v_mov_b64 v[122:123], 0
    v_mov_b64 v[124:125], 0
    v_mov_b64 v[126:127], 0
    v_mov_b64 v[128:129], 0
    v_mov_b64 v[130:131], 0
    v_mov_b64 v[132:133], 0
    v_mov_b64 v[134:135], 0
    v_mov_b64 v[136:137], 0
    v_mov_b64 v[138:139], 0
    v_mov_b64 v[140:141], 0
    v_mov_b64 v[142:143], 0
    v_mov_b64 v[144:145], 0
    v_mov_b64 v[146:147], 0
    v_mov_b64 v[148:149], 0
    v_mov_b64 v[150:151], 0
    v_mov_b64 v[152:153], 0
    v_mov_b64 v[154:155], 0
    v_mov_b64 v[156:157], 0
    v_mov_b64 v[158:159], 0
    v_mov_b64 v[160:161], 0
    v_mov_b64 v[162:163], 0
    v_mov_b64 v[164:165], 0
    v_mov_b64 v[166:167], 0
    v_mov_b64 v[168:169], 0
    v_mov_b64 v[170:171], 0
    v_mov_b64 v[172:173], 0
    v_mov_b64 v[174:175], 0
    v_mov_b64 v[176:177], 0
    v_mov_b64 v[178:179], 0
    v_mov_b64 v[180:181], 0
    v_mov_b64 v[182:183], 0
    v_mov_b64 v[184:185], 0
    v_mov_b64 v[186:187], 0
    v_mov_b64 v[188:189], 0
    v_mov_b64 v[190:191], 0
    v_mov_b64 v[192:193], 0
    v_mov_b64 v[194:195], 0
    v_mov_b64 v[196:197], 0
    v_mov_b64 v[198:199], 0
    v_mov_b64 v[200:201], 0
    v_mov_b64 v[202:203], 0
    v_mov_b64 v[204:205], 0
    v_mov_b64 v[206:207], 0
    v_mov_b64 v[208:209], 0
    v_mov_b64 v[210:211], 0
    v_mov_b64 v[212:213], 0
    v_mov_b64 v[214:215], 0
    v_mov_b64 v[216:217], 0
    v_mov_b64 v[218:219], 0
    v_mov_b64 v[220:221], 0
    v_mov_b64 v[222:223], 0
    v_mov_b64 v[224:225], 0
    v_mov_b64 v[226:227], 0
    v_mov_b64 v[228:229], 0
    v_mov_b64 v[230:231], 0
    v_mov_b64 v[232:233], 0
    v_mov_b64 v[234:235], 0
    v_mov_b64 v[236:237], 0
    v_mov_b64 v[238:239], 0
    v_mov_b64 v[240:241], 0
    v_mov_b64 v[242:243], 0
    v_mov_b64 v[244:245], 0
    v_mov_b64 v[246:247], 0
    v_mov_b64 v[248:249], 0
    v_mov_b64 v[250:251], 0
    v_mov_b64 v[252:253], 0
    v_mov_b64 v[254:255], 0
    s_waitcnt vmcnt(8)
    ds_read_b64_tr_b16 a[0:1], v1
    ds_read_b64_tr_b16 a[2:3], v1 offset:4096
    ds_read_b64_tr_b16 a[4:5], v2
    ds_read_b64_tr_b16 a[6:7], v2 offset:4096
    ds_read_b64_tr_b16 a[8:9], v3
    ds_read_b64_tr_b16 a[10:11], v3 offset:4096
    ds_read_b64_tr_b16 a[12:13], v4
    ds_read_b64_tr_b16 a[14:15], v4 offset:4096
    ds_read_b64_tr_b16 a[16:17], v5
    ds_read_b64_tr_b16 a[18:19], v5 offset:4096
    ds_read_b64_tr_b16 a[20:21], v6
    ds_read_b64_tr_b16 a[22:23], v6 offset:4096
    ds_read_b64_tr_b16 a[24:25], v7
    ds_read_b64_tr_b16 a[26:27], v7 offset:4096
    ds_read_b64_tr_b16 a[28:29], v8
    ds_read_b64_tr_b16 a[30:31], v8 offset:4096
L_poll:
    buffer_load_dword v30, v29, s[16:19], s78 offen sc1
    s_waitcnt vmcnt(0) lgkmcnt(0)
    v_cmp_ne_u32 vcc, s71, v30
    s_sub_u32 s34, s34, 1
    s_cmp_eq_u32 s34, 0
    s_cbranch_scc1 L_go
    s_cbranch_vccz L_go
    s_sleep 1
    s_branch L_poll
L_go:
    buffer_load_dwordx4 a[32:35], v17, s[4:7], s27 offen sc1
    buffer_load_dwordx4 a[36:39], v17, s[4:7], s27 offen offset:1024 sc1
    buffer_load_dwordx4 a[40:43], v17, s[4:7], s27 offen offset:2048 sc1
    buffer_load_dwordx4 a[44:47], v17, s[4:7], s27 offen offset:3072 sc1
    buffer_load_dwordx4 a[48:51], v18, s[4:7], s27 offen sc1
    buffer_load_dwordx4 a[52:55], v18, s[4:7], s27 offen offset:1024 sc1
    buffer_load_dwordx4 a[56:59], v18, s[4:7], s27 offen offset:2048 sc1
    s_add_u32 s27, s27, 7168
    buffer_load_dwordx4 a[60:63], v17, s[4:7], s27 offen sc1
    buffer_load_dwordx4 a[64:67], v17, s[4:7], s27 offen offset:1024 sc1
    buffer_load_dwordx4 a[68:71], v17, s[4:7], s27 offen offset:2048 sc1
    buffer_load_dwordx4 a[72:75], v17, s[4:7], s27 offen offset:3072 sc1
    buffer_load_dwordx4 a[76:79], v18, s[4:7], s27 offen sc1
    buffer_load_dwordx4 a[80:83], v18, s[4:7], s27 offen offset:1024 sc1
    buffer_load_dwordx4 a[84:87], v18, s[4:7], s27 offen offset:2048 sc1
    s_add_u32 s27, s27, 7168
    s_add_u32 m0, s33, 16384
    s_nop 0
    buffer_load_dwordx4 v9, s[8:11], s28 offen lds
    buffer_load_dwordx4 v10, s[8:11], s28 offen offset:1024 lds
    buffer_load_dwordx4 v11, s[8:11], s28 offen offset:2048 lds
    buffer_load_dwordx4 v12, s[8:11], s28 offen offset:3072 lds
    s_add_u32 m0, s33, 20480
    s_nop 0
    buffer_load_dwordx4 v13, s[8:11], s28 offen lds
    buffer_load_dwordx4 v14, s[8:11], s28 offen offset:1024 lds
    buffer_load_dwordx4 v15, s[8:11], s28 offen offset:2048 lds
    buffer_load_dwordx4 v16, s[8:11], s28 offen offset:3072 lds
    s_add_u32 s28, s28, 65536
    buffer_load_dwordx4 a[88:91], v17, s[4:7], s27 offen sc1
    buffer_load_dwordx4 a[92:95], v17, s[4:7], s27 offen offset:1024 sc1
    buffer_load_dwordx4 a[96:99], v17, s[4:7], s27 offen offset:2048 sc1
    buffer_load_dwordx4 a[100:103], v17, s[4:7], s27 offen offset:3072 sc1
    buffer_load_dwordx4 a[104:107], v18, s[4:7], s27 offen sc1
    buffer_load_dwordx4 a[108:111], v18, s[4:7], s27 offen offset:1024 sc1
    buffer_load_dwordx4 a[112:115], v18, s[4:7], s27 offen offset:2048 sc1
    s_add_u32 s27, s27, 7168
    s_add_u32 m0, s33, 24576
    s_nop 0
    buffer_load_dwordx4 v9, s[8:11], s28 offen lds
    buffer_load_dwordx4 v10, s[8:11], s28 offen offset:1024 lds
    buffer_load_dwordx4 v11, s[8:11], s28 offen offset:2048 lds
    buffer_load_dwordx4 v12, s[8:11], s28 offen offset:3072 lds
    s_add_u32 m0, s33, 28672
    s_nop 0
    buffer_load_dwordx4 v13, s[8:11], s28 offen lds
    buffer_load_dwordx4 v14, s[8:11], s28 offen offset:1024 lds
    buffer_load_dwordx4 v15, s[8:11], s28 offen offset:2048 lds
    buffer_load_dwordx4 v16, s[8:11], s28 offen offset:3072 lds
    s_add_u32 s28, s28, 65536
    s_mov_b32 s34, 7
L_op:
    s_waitcnt vmcnt(36) lgkmcnt(14)
    v_mfma_f32_16x16x32_bf16 v[32:35], a[0:3], a[32:35], v[32:35]
    s_waitcnt vmcnt(35)
    v_mfma_f32_16x16x32_bf16 v[36:39], a[0:3], a[36:39], v[36:39]
    s_waitcnt vmcnt(34)
    v_mfma_f32_16x16x32_bf16 v[40:43], a[0:3], a[40:43], v[40:43]
    s_waitcnt vmcnt(33)
    v_mfma_f32_16x16x32_bf16 v[44:47], a[0:3], a[44:47], v[44:47]
    s_waitcnt vmcnt(32)
    v_mfma_f32_16x16x32_bf16 v[48:51], a[0:3], a[48:51], v[48:51]
    s_waitcnt vmcnt(31)
    s_waitcnt lgkmcnt(0)
    v_mfma_f32_16x16x32_bf16 v[52:55], a[0:3], a[52:55], v[52:55]
    s_waitcnt vmcnt(30)
    v_mfma_f32_16x16x32_bf16 v[56:59], a[0:3], a[56:59], v[56:59]
    ds_read_b64_tr_b16 a[0:1], v1 offset:8192
    ds_read_b64_tr_b16 a[2:3], v1 offset:12288
    v_mfma_f32_16x16x32_bf16 v[60:63], a[4:7], a[32:35], v[60:63]
    buffer_load_dwordx4 a[116:119], v17, s[4:7], s27 offen sc1
    v_mfma_f32_16x16x32_bf16 v[64:67], a[4:7], a[36:39], v[64:67]
    v_mfma_f32_16x16x32_bf16 v[68:71], a[4:7], a[40:43], v[68:71]
    buffer_load_dwordx4 a[120:123], v17, s[4:7], s27 offen offset:1024 sc1
    v_mfma_f32_16x16x32_bf16 v[72:75], a[4:7], a[44:47], v[72:75]
    v_mfma_f32_16x16x32_bf16 v[76:79], a[4:7], a[48:51], v[76:79]
    v_mfma_f32_16x16x32_bf16 v[80:83], a[4:7], a[52:55], v[80:83]
    buffer_load_dwordx4 a[124:127], v17, s[4:7], s27 offen offset:2048 sc1
    v_mfma_f32_16x16x32_bf16 v[84:87], a[4:7], a[56:59], v[84:87]
    ds_read_b64_tr_b16 a[4:5], v2 offset:8192
    ds_read_b64_tr_b16 a[6:7], v2 offset:12288
    v_mfma_f32_16x16x32_bf16 v[88:91], a[8:11], a[32:35], v[88:91]
    v_mfma_f32_16x16x32_bf16 v[92:95], a[8:11], a[36:39], v[92:95]
    buffer_load_dwordx4 a[128:131], v17, s[4:7], s27 offen offset:3072 sc1
    v_mfma_f32_16x16x32_bf16 v[96:99], a[8:11], a[40:43], v[96:99]
    v_mfma_f32_16x16x32_bf16 v[100:103], a[8:11], a[44:47], v[100:103]
    v_mfma_f32_16x16x32_bf16 v[104:107], a[8:11], a[48:51], v[104:107]
    buffer_load_dwordx4 a[132:135], v18, s[4:7], s27 offen sc1
    v_mfma_f32_16x16x32_bf16 v[108:111], a[8:11], a[52:55], v[108:111]
    v_mfma_f32_16x16x32_bf16 v[112:115], a[8:11], a[56:59], v[112:115]
    ds_read_b64_tr_b16 a[8:9], v3 offset:8192
    ds_read_b64_tr_b16 a[10:11], v3 offset:12288
    v_mfma_f32_16x16x32_bf16 v[116:119], a[12:15], a[32:35], v[116:119]
    v_mfma_f32_16x16x32_bf16 v[120:123], a[12:15], a[36:39], v[120:123]
    buffer_load_dwordx4 a[136:139], v18, s[4:7], s27 offen offset:1024 sc1
    v_mfma_f32_16x16x32_bf16 v[124:127], a[12:15], a[40:43], v[124:127]
    v_mfma_f32_16x16x32_bf16 v[128:131], a[12:15], a[44:47], v[128:131]
    buffer_load_dwordx4 a[140:143], v18, s[4:7], s27 offen offset:2048 sc1
    v_mfma_f32_16x16x32_bf16 v[132:135], a[12:15], a[48:51], v[132:135]
    v_mfma_f32_16x16x32_bf16 v[136:139], a[12:15], a[52:55], v[136:139]
    v_mfma_f32_16x16x32_bf16 v[140:143], a[12:15], a[56:59], v[140:143]
    s_add_u32 s27, s27, 7168
    s_add_u32 m0, s33, 0
    ds_read_b64_tr_b16 a[12:13], v4 offset:8192
    ds_read_b64_tr_b16 a[14:15], v4 offset:12288
    v_mfma_f32_16x16x32_bf16 v[144:147], a[16:19], a[32:35], v[144:147]
    buffer_load_dwordx4 v9, s[8:11], s28 offen lds
    v_mfma_f32_16x16x32_bf16 v[148:151], a[16:19], a[36:39], v[148:151]
    v_mfma_f32_16x16x32_bf16 v[152:155], a[16:19], a[40:43], v[152:155]
    buffer_load_dwordx4 v10, s[8:11], s28 offen offset:1024 lds
    v_mfma_f32_16x16x32_bf16 v[156:159], a[16:19], a[44:47], v[156:159]
    v_mfma_f32_16x16x32_bf16 v[160:163], a[16:19], a[48:51], v[160:163]
    v_mfma_f32_16x16x32_bf16 v[164:167], a[16:19], a[52:55], v[164:167]
    buffer_load_dwordx4 v11, s[8:11], s28 offen offset:2048 lds
    v_mfma_f32_16x16x32_bf16 v[168:171], a[16:19], a[56:59], v[168:171]
    ds_read_b64_tr_b16 a[16:17], v5 offset:8192
    ds_read_b64_tr_b16 a[18:19], v5 offset:12288
    v_mfma_f32_16x16x32_bf16 v[172:175], a[20:23], a[32:35], v[172:175]
    v_mfma_f32_16x16x32_bf16 v[176:179], a[20:23], a[36:39], v[176:179]
    v_mfma_f32_16x16x32_bf16 v[180:183], a[20:23], a[40:43], v[180:183]
    buffer_load_dwordx4 v12, s[8:11], s28 offen offset:3072 lds
    v_mfma_f32_16x16x32_bf16 v[184:187], a[20:23], a[44:47], v[184:187]
    s_add_u32 m0, s33, 4096
    v_mfma_f32_16x16x32_bf16 v[188:191], a[20:23], a[48:51], v[188:191]
    buffer_load_dwordx4 v13, s[8:11], s28 offen lds
    v_mfma_f32_16x16x32_bf16 v[192:195], a[20:23], a[52:55], v[192:195]
    v_mfma_f32_16x16x32_bf16 v[196:199], a[20:23], a[56:59], v[196:199]
    ds_read_b64_tr_b16 a[20:21], v6 offset:8192
    ds_read_b64_tr_b16 a[22:23], v6 offset:12288
    v_mfma_f32_16x16x32_bf16 v[200:203], a[24:27], a[32:35], v[200:203]
    v_mfma_f32_16x16x32_bf16 v[204:207], a[24:27], a[36:39], v[204:207]
    buffer_load_dwordx4 v14, s[8:11], s28 offen offset:1024 lds
    v_mfma_f32_16x16x32_bf16 v[208:211], a[24:27], a[40:43], v[208:211]
    v_mfma_f32_16x16x32_bf16 v[212:215], a[24:27], a[44:47], v[212:215]
    buffer_load_dwordx4 v15, s[8:11], s28 offen offset:2048 lds
    v_mfma_f32_16x16x32_bf16 v[216:219], a[24:27], a[48:51], v[216:219]
    v_mfma_f32_16x16x32_bf16 v[220:223], a[24:27], a[52:55], v[220:223]
    v_mfma_f32_16x16x32_bf16 v[224:227], a[24:27], a[56:59], v[224:227]
    ds_read_b64_tr_b16 a[24:25], v7 offset:8192
    ds_read_b64_tr_b16 a[26:27], v7 offset:12288
    v_mfma_f32_16x16x32_bf16 v[228:231], a[28:31], a[32:35], v[228:231]
    buffer_load_dwordx4 v16, s[8:11], s28 offen offset:3072 lds
    v_mfma_f32_16x16x32_bf16 v[232:235], a[28:31], a[36:39], v[232:235]
    s_add_u32 s28, s28, 65536
    v_mfma_f32_16x16x32_bf16 v[236:239], a[28:31], a[40:43], v[236:239]
    v_mfma_f32_16x16x32_bf16 v[240:243], a[28:31], a[44:47], v[240:243]
    v_mfma_f32_16x16x32_bf16 v[244:247], a[28:31], a[48:51], v[244:247]
    v_mfma_f32_16x16x32_bf16 v[248:251], a[28:31], a[52:55], v[248:251]
    v_mfma_f32_16x16x32_bf16 v[252:255], a[28:31], a[56:59], v[252:255]
    s_waitcnt vmcnt(44) lgkmcnt(12)
    ds_read_b64_tr_b16 a[28:29], v8 offset:8192
    ds_read_b64_tr_b16 a[30:31], v8 offset:12288
    v_mfma_f32_16x16x32_bf16 v[32:35], a[0:3], a[60:63], v[32:35]
    s_waitcnt vmcnt(43)
    v_mfma_f32_16x16x32_bf16 v[36:39], a[0:3], a[64:67], v[36:39]
    s_waitcnt vmcnt(42)
    v_mfma_f32_16x16x32_bf16 v[40:43], a[0:3], a[68:71], v[40:43]
    s_waitcnt vmcnt(41)
    v_mfma_f32_16x16x32_bf16 v[44:47], a[0:3], a[72:75], v[44:47]
    s_waitcnt vmcnt(40)
    v_mfma_f32_16x16x32_bf16 v[48:51], a[0:3], a[76:79], v[48:51]
    s_waitcnt vmcnt(39)
    s_waitcnt lgkmcnt(0)
    v_mfma_f32_16x16x32_bf16 v[52:55], a[0:3], a[80:83], v[52:55]
    s_waitcnt vmcnt(30)
    v_mfma_f32_16x16x32_bf16 v[56:59], a[0:3], a[84:87], v[56:59]
    ds_read_b64_tr_b16 a[0:1], v1 offset:16384
    ds_read_b64_tr_b16 a[2:3], v1 offset:20480
    v_mfma_f32_16x16x32_bf16 v[60:63], a[4:7], a[60:63], v[60:63]
    buffer_load_dwordx4 a[32:35], v17, s[4:7], s27 offen sc1
    v_mfma_f32_16x16x32_bf16 v[64:67], a[4:7], a[64:67], v[64:67]
    v_mfma_f32_16x16x32_bf16 v[68:71], a[4:7], a[68:71], v[68:71]
    buffer_load_dwordx4 a[36:39], v17, s[4:7], s27 offen offset:1024 sc1
    v_mfma_f32_16x16x32_bf16 v[72:75], a[4:7], a[72:75], v[72:75]
    v_mfma_f32_16x16x32_bf16 v[76:79], a[4:7], a[76:79], v[76:79]
    v_mfma_f32_16x16x32_bf16 v[80:83], a[4:7], a[80:83], v[80:83]
    buffer_load_dwordx4 a[40:43], v17, s[4:7], s27 offen offset:2048 sc1
    v_mfma_f32_16x16x32_bf16 v[84:87], a[4:7], a[84:87], v[84:87]
    ds_read_b64_tr_b16 a[4:5], v2 offset:16384
    ds_read_b64_tr_b16 a[6:7], v2 offset:20480
    v_mfma_f32_16x16x32_bf16 v[88:91], a[8:11], a[60:63], v[88:91]
    v_mfma_f32_16x16x32_bf16 v[92:95], a[8:11], a[64:67], v[92:95]
    buffer_load_dwordx4 a[44:47], v17, s[4:7], s27 offen offset:3072 sc1
    v_mfma_f32_16x16x32_bf16 v[96:99], a[8:11], a[68:71], v[96:99]
    v_mfma_f32_16x16x32_bf16 v[100:103], a[8:11], a[72:75], v[100:103]
    v_mfma_f32_16x16x32_bf16 v[104:107], a[8:11], a[76:79], v[104:107]
    buffer_load_dwordx4 a[48:51], v18, s[4:7], s27 offen sc1
    v_mfma_f32_16x16x32_bf16 v[108:111], a[8:11], a[80:83], v[108:111]
    v_mfma_f32_16x16x32_bf16 v[112:115], a[8:11], a[84:87], v[112:115]
    ds_read_b64_tr_b16 a[8:9], v3 offset:16384
    ds_read_b64_tr_b16 a[10:11], v3 offset:20480
    v_mfma_f32_16x16x32_bf16 v[116:119], a[12:15], a[60:63], v[116:119]
    v_mfma_f32_16x16x32_bf16 v[120:123], a[12:15], a[64:67], v[120:123]
    buffer_load_dwordx4 a[52:55], v18, s[4:7], s27 offen offset:1024 sc1
    v_mfma_f32_16x16x32_bf16 v[124:127], a[12:15], a[68:71], v[124:127]
    v_mfma_f32_16x16x32_bf16 v[128:131], a[12:15], a[72:75], v[128:131]
    buffer_load_dwordx4 a[56:59], v18, s[4:7], s27 offen offset:2048 sc1
    v_mfma_f32_16x16x32_bf16 v[132:135], a[12:15], a[76:79], v[132:135]
    v_mfma_f32_16x16x32_bf16 v[136:139], a[12:15], a[80:83], v[136:139]
    v_mfma_f32_16x16x32_bf16 v[140:143], a[12:15], a[84:87], v[140:143]
    s_add_u32 s27, s27, 7168
    s_add_u32 m0, s33, 8192
    ds_read_b64_tr_b16 a[12:13], v4 offset:16384
    ds_read_b64_tr_b16 a[14:15], v4 offset:20480
    v_mfma_f32_16x16x32_bf16 v[144:147], a[16:19], a[60:63], v[144:147]
    buffer_load_dwordx4 v9, s[8:11], s28 offen lds
    v_mfma_f32_16x16x32_bf16 v[148:151], a[16:19], a[64:67], v[148:151]
    v_mfma_f32_16x16x32_bf16 v[152:155], a[16:19], a[68:71], v[152:155]
    buffer_load_dwordx4 v10, s[8:11], s28 offen offset:1024 lds
    v_mfma_f32_16x16x32_bf16 v[156:159], a[16:19], a[72:75], v[156:159]
    v_mfma_f32_16x16x32_bf16 v[160:163], a[16:19], a[76:79], v[160:163]
    v_mfma_f32_16x16x32_bf16 v[164:167], a[16:19], a[80:83], v[164:167]
    buffer_load_dwordx4 v11, s[8:11], s28 offen offset:2048 lds
    v_mfma_f32_16x16x32_bf16 v[168:171], a[16:19], a[84:87], v[168:171]
    ds_read_b64_tr_b16 a[16:17], v5 offset:16384
    ds_read_b64_tr_b16 a[18:19], v5 offset:20480
    v_mfma_f32_16x16x32_bf16 v[172:175], a[20:23], a[60:63], v[172:175]
    v_mfma_f32_16x16x32_bf16 v[176:179], a[20:23], a[64:67], v[176:179]
    v_mfma_f32_16x16x32_bf16 v[180:183], a[20:23], a[68:71], v[180:183]
    buffer_load_dwordx4 v12, s[8:11], s28 offen offset:3072 lds
    v_mfma_f32_16x16x32_bf16 v[184:187], a[20:23], a[72:75], v[184:187]
    s_add_u32 m0, s33, 12288
    v_mfma_f32_16x16x32_bf16 v[188:191], a[20:23], a[76:79], v[188:191]
    buffer_load_dwordx4 v13, s[8:11], s28 offen lds
    v_mfma_f32_16x16x32_bf16 v[192:195], a[20:23], a[80:83], v[192:195]
    v_mfma_f32_16x16x32_bf16 v[196:199], a[20:23], a[84:87], v[196:199]
    ds_read_b64_tr_b16 a[20:21], v6 offset:16384
    ds_read_b64_tr_b16 a[22:23], v6 offset:20480
    v_mfma_f32_16x16x32_bf16 v[200:203], a[24:27], a[60:63], v[200:203]
    v_mfma_f32_16x16x32_bf16 v[204:207], a[24:27], a[64:67], v[204:207]
    buffer_load_dwordx4 v14, s[8:11], s28 offen offset:1024 lds
    v_mfma_f32_16x16x32_bf16 v[208:211], a[24:27], a[68:71], v[208:211]
    v_mfma_f32_16x16x32_bf16 v[212:215], a[24:27], a[72:75], v[212:215]
    buffer_load_dwordx4 v15, s[8:11], s28 offen offset:2048 lds
    v_mfma_f32_16x16x32_bf16 v[216:219], a[24:27], a[76:79], v[216:219]
    v_mfma_f32_16x16x32_bf16 v[220:223], a[24:27], a[80:83], v[220:223]
    v_mfma_f32_16x16x32_bf16 v[224:227], a[24:27], a[84:87], v[224:227]
    ds_read_b64_tr_b16 a[24:25], v7 offset:16384
    ds_read_b64_tr_b16 a[26:27], v7 offset:20480
    v_mfma_f32_16x16x32_bf16 v[228:231], a[28:31], a[60:63], v[228:231]
    buffer_load_dwordx4 v16, s[8:11], s28 offen offset:3072 lds
    v_mfma_f32_16x16x32_bf16 v[232:235], a[28:31], a[64:67], v[232:235]
    s_add_u32 s28, s28, 65536
    v_mfma_f32_16x16x32_bf16 v[236:239], a[28:31], a[68:71], v[236:239]
    v_mfma_f32_16x16x32_bf16 v[240:243], a[28:31], a[72:75], v[240:243]
    v_mfma_f32_16x16x32_bf16 v[244:247], a[28:31], a[76:79], v[244:247]
    v_mfma_f32_16x16x32_bf16 v[248:251], a[28:31], a[80:83], v[248:251]
    v_mfma_f32_16x16x32_bf16 v[252:255], a[28:31], a[84:87], v[252:255]
    s_waitcnt vmcnt(44) lgkmcnt(12)
    ds_read_b64_tr_b16 a[28:29], v8 offset:16384
    ds_read_b64_tr_b16 a[30:31], v8 offset:20480
    v_mfma_f32_16x16x32_bf16 v[32:35], a[0:3], a[88:91], v[32:35]
    s_waitcnt vmcnt(43)
    v_mfma_f32_16x16x32_bf16 v[36:39], a[0:3], a[92:95], v[36:39]
    s_waitcnt vmcnt(42)
    v_mfma_f32_16x16x32_bf16 v[40:43], a[0:3], a[96:99], v[40:43]
    s_waitcnt vmcnt(41)
    v_mfma_f32_16x16x32_bf16 v[44:47], a[0:3], a[100:103], v[44:47]
    s_waitcnt vmcnt(40)
    v_mfma_f32_16x16x32_bf16 v[48:51], a[0:3], a[104:107], v[48:51]
    s_waitcnt vmcnt(39)
    s_waitcnt lgkmcnt(0)
    v_mfma_f32_16x16x32_bf16 v[52:55], a[0:3], a[108:111], v[52:55]
    s_waitcnt vmcnt(30)
    v_mfma_f32_16x16x32_bf16 v[56:59], a[0:3], a[112:115], v[56:59]
    ds_read_b64_tr_b16 a[0:1], v1 offset:24576
    ds_read_b64_tr_b16 a[2:3], v1 offset:28672
    v_mfma_f32_16x16x32_bf16 v[60:63], a[4:7], a[88:91], v[60:63]
    buffer_load_dwordx4 a[60:63], v17, s[4:7], s27 offen sc1
    v_mfma_f32_16x16x32_bf16 v[64:67], a[4:7], a[92:95], v[64:67]
    v_mfma_f32_16x16x32_bf16 v[68:71], a[4:7], a[96:99], v[68:71]
    buffer_load_dwordx4 a[64:67], v17, s[4:7], s27 offen offset:1024 sc1
    v_mfma_f32_16x16x32_bf16 v[72:75], a[4:7], a[100:103], v[72:75]
    v_mfma_f32_16x16x32_bf16 v[76:79], a[4:7], a[104:107], v[76:79]
    v_mfma_f32_16x16x32_bf16 v[80:83], a[4:7], a[108:111], v[80:83]
    buffer_load_dwordx4 a[68:71], v17, s[4:7], s27 offen offset:2048 sc1
    v_mfma_f32_16x16x32_bf16 v[84:87], a[4:7], a[112:115], v[84:87]
    ds_read_b64_tr_b16 a[4:5], v2 offset:24576
    ds_read_b64_tr_b16 a[6:7], v2 offset:28672
    v_mfma_f32_16x16x32_bf16 v[88:91], a[8:11], a[88:91], v[88:91]
    v_mfma_f32_16x16x32_bf16 v[92:95], a[8:11], a[92:95], v[92:95]
    buffer_load_dwordx4 a[72:75], v17, s[4:7], s27 offen offset:3072 sc1
    v_mfma_f32_16x16x32_bf16 v[96:99], a[8:11], a[96:99], v[96:99]
    v_mfma_f32_16x16x32_bf16 v[100:103], a[8:11], a[100:103], v[100:103]
    v_mfma_f32_16x16x32_bf16 v[104:107], a[8:11], a[104:107], v[104:107]
    buffer_load_dwordx4 a[76:79], v18, s[4:7], s27 offen sc1
    v_mfma_f32_16x16x32_bf16 v[108:111], a[8:11], a[108:111], v[108:111]
    v_mfma_f32_16x16x32_bf16 v[112:115], a[8:11], a[112:115], v[112:115]
    ds_read_b64_tr_b16 a[8:9], v3 offset:24576
    ds_read_b64_tr_b16 a[10:11], v3 offset:28672
    v_mfma_f32_16x16x32_bf16 v[116:119], a[12:15], a[88:91], v[116:119]
    v_mfma_f32_16x16x32_bf16 v[120:123], a[12:15], a[92:95], v[120:123]
    buffer_load_dwordx4 a[80:83], v18, s[4:7], s27 offen offset:1024 sc1
    v_mfma_f32_16x16x32_bf16 v[124:127], a[12:15], a[96:99], v[124:127]
    v_mfma_f32_16x16x32_bf16 v[128:131], a[12:15], a[100:103], v[128:131]
    buffer_load_dwordx4 a[84:87], v18, s[4:7], s27 offen offset:2048 sc1
    v_mfma_f32_16x16x32_bf16 v[132:135], a[12:15], a[104:107], v[132:135]
    v_mfma_f32_16x16x32_bf16 v[136:139], a[12:15], a[108:111], v[136:139]
    v_mfma_f32_16x16x32_bf16 v[140:143], a[12:15], a[112:115], v[140:143]
    s_add_u32 s27, s27, 7168
    s_add_u32 m0, s33, 16384
    ds_read_b64_tr_b16 a[12:13], v4 offset:24576
    ds_read_b64_tr_b16 a[14:15], v4 offset:28672
    v_mfma_f32_16x16x32_bf16 v[144:147], a[16:19], a[88:91], v[144:147]
    buffer_load_dwordx4 v9, s[8:11], s28 offen lds
    v_mfma_f32_16x16x32_bf16 v[148:151], a[16:19], a[92:95], v[148:151]
    v_mfma_f32_16x16x32_bf16 v[152:155], a[16:19], a[96:99], v[152:155]
    buffer_load_dwordx4 v10, s[8:11], s28 offen offset:1024 lds
    v_mfma_f32_16x16x32_bf16 v[156:159], a[16:19], a[100:103], v[156:159]
    v_mfma_f32_16x16x32_bf16 v[160:163], a[16:19], a[104:107], v[160:163]
    v_mfma_f32_16x16x32_bf16 v[164:167], a[16:19], a[108:111], v[164:167]
    buffer_load_dwordx4 v11, s[8:11], s28 offen offset:2048 lds
    v_mfma_f32_16x16x32_bf16 v[168:171], a[16:19], a[112:115], v[168:171]
    ds_read_b64_tr_b16 a[16:17], v5 offset:24576
    ds_read_b64_tr_b16 a[18:19], v5 offset:28672
    v_mfma_f32_16x16x32_bf16 v[172:175], a[20:23], a[88:91], v[172:175]
    v_mfma_f32_16x16x32_bf16 v[176:179], a[20:23], a[92:95], v[176:179]
    v_mfma_f32_16x16x32_bf16 v[180:183], a[20:23], a[96:99], v[180:183]
    buffer_load_dwordx4 v12, s[8:11], s28 offen offset:3072 lds
    v_mfma_f32_16x16x32_bf16 v[184:187], a[20:23], a[100:103], v[184:187]
    s_add_u32 m0, s33, 20480
    v_mfma_f32_16x16x32_bf16 v[188:191], a[20:23], a[104:107], v[188:191]
    buffer_load_dwordx4 v13, s[8:11], s28 offen lds
    v_mfma_f32_16x16x32_bf16 v[192:195], a[20:23], a[108:111], v[192:195]
    v_mfma_f32_16x16x32_bf16 v[196:199], a[20:23], a[112:115], v[196:199]
    ds_read_b64_tr_b16 a[20:21], v6 offset:24576
    ds_read_b64_tr_b16 a[22:23], v6 offset:28672
    v_mfma_f32_16x16x32_bf16 v[200:203], a[24:27], a[88:91], v[200:203]
    v_mfma_f32_16x16x32_bf16 v[204:207], a[24:27], a[92:95], v[204:207]
    buffer_load_dwordx4 v14, s[8:11], s28 offen offset:1024 lds
    v_mfma_f32_16x16x32_bf16 v[208:211], a[24:27], a[96:99], v[208:211]
    v_mfma_f32_16x16x32_bf16 v[212:215], a[24:27], a[100:103], v[212:215]
    buffer_load_dwordx4 v15, s[8:11], s28 offen offset:2048 lds
    v_mfma_f32_16x16x32_bf16 v[216:219], a[24:27], a[104:107], v[216:219]
    v_mfma_f32_16x16x32_bf16 v[220:223], a[24:27], a[108:111], v[220:223]
    v_mfma_f32_16x16x32_bf16 v[224:227], a[24:27], a[112:115], v[224:227]
    ds_read_b64_tr_b16 a[24:25], v7 offset:24576
    ds_read_b64_tr_b16 a[26:27], v7 offset:28672
    v_mfma_f32_16x16x32_bf16 v[228:231], a[28:31], a[88:91], v[228:231]
    buffer_load_dwordx4 v16, s[8:11], s28 offen offset:3072 lds
    v_mfma_f32_16x16x32_bf16 v[232:235], a[28:31], a[92:95], v[232:235]
    s_add_u32 s28, s28, 65536
    v_mfma_f32_16x16x32_bf16 v[236:239], a[28:31], a[96:99], v[236:239]
    v_mfma_f32_16x16x32_bf16 v[240:243], a[28:31], a[100:103], v[240:243]
    v_mfma_f32_16x16x32_bf16 v[244:247], a[28:31], a[104:107], v[244:247]
    v_mfma_f32_16x16x32_bf16 v[248:251], a[28:31], a[108:111], v[248:251]
    v_mfma_f32_16x16x32_bf16 v[252:255], a[28:31], a[112:115], v[252:255]
    s_waitcnt vmcnt(44) lgkmcnt(12)
    ds_read_b64_tr_b16 a[28:29], v8 offset:24576
    ds_read_b64_tr_b16 a[30:31], v8 offset:28672
    v_mfma_f32_16x16x32_bf16 v[32:35], a[0:3], a[116:119], v[32:35]
    s_waitcnt vmcnt(43)
    v_mfma_f32_16x16x32_bf16 v[36:39], a[0:3], a[120:123], v[36:39]
    s_waitcnt vmcnt(42)
    v_mfma_f32_16x16x32_bf16 v[40:43], a[0:3], a[124:127], v[40:43]
    s_waitcnt vmcnt(41)
    v_mfma_f32_16x16x32_bf16 v[44:47], a[0:3], a[128:131], v[44:47]
    s_waitcnt vmcnt(40)
    v_mfma_f32_16x16x32_bf16 v[48:51], a[0:3], a[132:135], v[48:51]
    s_waitcnt vmcnt(39)
    s_waitcnt lgkmcnt(0)
    v_mfma_f32_16x16x32_bf16 v[52:55], a[0:3], a[136:139], v[52:55]
    s_waitcnt vmcnt(30)
    v_mfma_f32_16x16x32_bf16 v[56:59], a[0:3], a[140:143], v[56:59]
    ds_read_b64_tr_b16 a[0:1], v1
    ds_read_b64_tr_b16 a[2:3], v1 offset:4096
    v_mfma_f32_16x16x32_bf16 v[60:63], a[4:7], a[116:119], v[60:63]
    buffer_load_dwordx4 a[88:91], v17, s[4:7], s27 offen sc1
    v_mfma_f32_16x16x32_bf16 v[64:67], a[4:7], a[120:123], v[64:67]
    v_mfma_f32_16x16x32_bf16 v[68:71], a[4:7], a[124:127], v[68:71]
    buffer_load_dwordx4 a[92:95], v17, s[4:7], s27 offen offset:1024 sc1
    v_mfma_f32_16x16x32_bf16 v[72:75], a[4:7], a[128:131], v[72:75]
    v_mfma_f32_16x16x32_bf16 v[76:79], a[4:7], a[132:135], v[76:79]
    v_mfma_f32_16x16x32_bf16 v[80:83], a[4:7], a[136:139], v[80:83]
    buffer_load_dwordx4 a[96:99], v17, s[4:7], s27 offen offset:2048 sc1
    v_mfma_f32_16x16x32_bf16 v[84:87], a[4:7], a[140:143], v[84:87]
    ds_read_b64_tr_b16 a[4:5], v2
    ds_read_b64_tr_b16 a[6:7], v2 offset:4096
    v_mfma_f32_16x16x32_bf16 v[88:91], a[8:11], a[116:119], v[88:91]
    v_mfma_f32_16x16x32_bf16 v[92:95], a[8:11], a[120:123], v[92:95]
    buffer_load_dwordx4 a[100:103], v17, s[4:7], s27 offen offset:3072 sc1
    v_mfma_f32_16x16x32_bf16 v[96:99], a[8:11], a[124:127], v[96:99]
    v_mfma_f32_16x16x32_bf16 v[100:103], a[8:11], a[128:131], v[100:103]
    v_mfma_f32_16x16x32_bf16 v[104:107], a[8:11], a[132:135], v[104:107]
    buffer_load_dwordx4 a[104:107], v18, s[4:7], s27 offen sc1
    v_mfma_f32_16x16x32_bf16 v[108:111], a[8:11], a[136:139], v[108:111]
    v_mfma_f32_16x16x32_bf16 v[112:115], a[8:11], a[140:143], v[112:115]
    ds_read_b64_tr_b16 a[8:9], v3
    ds_read_b64_tr_b16 a[10:11], v3 offset:4096
    v_mfma_f32_16x16x32_bf16 v[116:119], a[12:15], a[116:119], v[116:119]
    v_mfma_f32_16x16x32_bf16 v[120:123], a[12:15], a[120:123], v[120:123]
    buffer_load_dwordx4 a[108:111], v18, s[4:7], s27 offen offset:1024 sc1
    v_mfma_f32_16x16x32_bf16 v[124:127], a[12:15], a[124:127], v[124:127]
    v_mfma_f32_16x16x32_bf16 v[128:131], a[12:15], a[128:131], v[128:131]
    buffer_load_dwordx4 a[112:115], v18, s[4:7], s27 offen offset:2048 sc1
    v_mfma_f32_16x16x32_bf16 v[132:135], a[12:15], a[132:135], v[132:135]
    v_mfma_f32_16x16x32_bf16 v[136:139], a[12:15], a[136:139], v[136:139]
    v_mfma_f32_16x16x32_bf16 v[140:143], a[12:15], a[140:143], v[140:143]
    s_add_u32 s27, s27, 7168
    s_add_u32 m0, s33, 24576
    ds_read_b64_tr_b16 a[12:13], v4
    ds_read_b64_tr_b16 a[14:15], v4 offset:4096
    v_mfma_f32_16x16x32_bf16 v[144:147], a[16:19], a[116:119], v[144:147]
    buffer_load_dwordx4 v9, s[8:11], s28 offen lds
    v_mfma_f32_16x16x32_bf16 v[148:151], a[16:19], a[120:123], v[148:151]
    v_mfma_f32_16x16x32_bf16 v[152:155], a[16:19], a[124:127], v[152:155]
    buffer_load_dwordx4 v10, s[8:11], s28 offen offset:1024 lds
    v_mfma_f32_16x16x32_bf16 v[156:159], a[16:19], a[128:131], v[156:159]
    v_mfma_f32_16x16x32_bf16 v[160:163], a[16:19], a[132:135], v[160:163]
    v_mfma_f32_16x16x32_bf16 v[164:167], a[16:19], a[136:139], v[164:167]
    buffer_load_dwordx4 v11, s[8:11], s28 offen offset:2048 lds
    v_mfma_f32_16x16x32_bf16 v[168:171], a[16:19], a[140:143], v[168:171]
    ds_read_b64_tr_b16 a[16:17], v5
    ds_read_b64_tr_b16 a[18:19], v5 offset:4096
    v_mfma_f32_16x16x32_bf16 v[172:175], a[20:23], a[116:119], v[172:175]
    v_mfma_f32_16x16x32_bf16 v[176:179], a[20:23], a[120:123], v[176:179]
    v_mfma_f32_16x16x32_bf16 v[180:183], a[20:23], a[124:127], v[180:183]
    buffer_load_dwordx4 v12, s[8:11], s28 offen offset:3072 lds
    v_mfma_f32_16x16x32_bf16 v[184:187], a[20:23], a[128:131], v[184:187]
    s_add_u32 m0, s33, 28672
    v_mfma_f32_16x16x32_bf16 v[188:191], a[20:23], a[132:135], v[188:191]
    buffer_load_dwordx4 v13, s[8:11], s28 offen lds
    v_mfma_f32_16x16x32_bf16 v[192:195], a[20:23], a[136:139], v[192:195]
    v_mfma_f32_16x16x32_bf16 v[196:199], a[20:23], a[140:143], v[196:199]
    ds_read_b64_tr_b16 a[20:21], v6
    ds_read_b64_tr_b16 a[22:23], v6 offset:4096
    v_mfma_f32_16x16x32_bf16 v[200:203], a[24:27], a[116:119], v[200:203]
    v_mfma_f32_16x16x32_bf16 v[204:207], a[24:27], a[120:123], v[204:207]
    buffer_load_dwordx4 v14, s[8:11], s28 offen offset:1024 lds
    v_mfma_f32_16x16x32_bf16 v[208:211], a[24:27], a[124:127], v[208:211]
    v_mfma_f32_16x16x32_bf16 v[212:215], a[24:27], a[128:131], v[212:215]
    buffer_load_dwordx4 v15, s[8:11], s28 offen offset:2048 lds
    v_mfma_f32_16x16x32_bf16 v[216:219], a[24:27], a[132:135], v[216:219]
    v_mfma_f32_16x16x32_bf16 v[220:223], a[24:27], a[136:139], v[220:223]
    v_mfma_f32_16x16x32_bf16 v[224:227], a[24:27], a[140:143], v[224:227]
    ds_read_b64_tr_b16 a[24:25], v7
    ds_read_b64_tr_b16 a[26:27], v7 offset:4096
    v_mfma_f32_16x16x32_bf16 v[228:231], a[28:31], a[116:119], v[228:231]
    buffer_load_dwordx4 v16, s[8:11], s28 offen offset:3072 lds
    v_mfma_f32_16x16x32_bf16 v[232:235], a[28:31], a[120:123], v[232:235]
    s_add_u32 s28, s28, 65536
    v_mfma_f32_16x16x32_bf16 v[236:239], a[28:31], a[124:127], v[236:239]
    v_mfma_f32_16x16x32_bf16 v[240:243], a[28:31], a[128:131], v[240:243]
    v_mfma_f32_16x16x32_bf16 v[244:247], a[28:31], a[132:135], v[244:247]
    v_mfma_f32_16x16x32_bf16 v[248:251], a[28:31], a[136:139], v[248:251]
    v_mfma_f32_16x16x32_bf16 v[252:255], a[28:31], a[140:143], v[252:255]
    ds_read_b64_tr_b16 a[28:29], v8
    ds_read_b64_tr_b16 a[30:31], v8 offset:4096
    s_sub_u32 s34, s34, 1
    s_cmp_lg_u32 s34, 0
    s_cbranch_scc1 L_op
    s_waitcnt vmcnt(44) lgkmcnt(14)
    v_mfma_f32_16x16x32_bf16 v[32:35], a[0:3], a[32:35], v[32:35]
    s_waitcnt vmcnt(43)
    v_mfma_f32_16x16x32_bf16 v[36:39], a[0:3], a[36:39], v[36:39]
    s_waitcnt vmcnt(42)
    v_mfma_f32_16x16x32_bf16 v[40:43], a[0:3], a[40:43], v[40:43]
    s_waitcnt vmcnt(41)
    v_mfma_f32_16x16x32_bf16 v[44:47], a[0:3], a[44:47], v[44:47]
    s_waitcnt vmcnt(40)
    v_mfma_f32_16x16x32_bf16 v[48:51], a[0:3], a[48:51], v[48:51]
    s_waitcnt vmcnt(39)
    v_mfma_f32_16x16x32_bf16 v[52:55], a[0:3], a[52:55], v[52:55]
    s_waitcnt vmcnt(30)
    v_mfma_f32_16x16x32_bf16 v[56:59], a[0:3], a[56:59], v[56:59]
    s_waitcnt lgkmcnt(12)
    ds_read_b64_tr_b16 a[0:1], v1 offset:8192
    ds_read_b64_tr_b16 a[2:3], v1 offset:12288
    v_mfma_f32_16x16x32_bf16 v[60:63], a[4:7], a[32:35], v[60:63]
    buffer_load_dwordx4 a[116:119], v17, s[4:7], s27 offen sc1
    v_mfma_f32_16x16x32_bf16 v[64:67], a[4:7], a[36:39], v[64:67]
    v_mfma_f32_16x16x32_bf16 v[68:71], a[4:7], a[40:43], v[68:71]
    v_mfma_f32_16x16x32_bf16 v[72:75], a[4:7], a[44:47], v[72:75]
    v_mfma_f32_16x16x32_bf16 v[76:79], a[4:7], a[48:51], v[76:79]
    v_mfma_f32_16x16x32_bf16 v[80:83], a[4:7], a[52:55], v[80:83]
    buffer_load_dwordx4 a[120:123], v17, s[4:7], s27 offen offset:1024 sc1
    v_mfma_f32_16x16x32_bf16 v[84:87], a[4:7], a[56:59], v[84:87]
    s_waitcnt lgkmcnt(12)
    ds_read_b64_tr_b16 a[4:5], v2 offset:8192
    ds_read_b64_tr_b16 a[6:7], v2 offset:12288
    v_mfma_f32_16x16x32_bf16 v[88:91], a[8:11], a[32:35], v[88:91]
    v_mfma_f32_16x16x32_bf16 v[92:95], a[8:11], a[36:39], v[92:95]
    v_mfma_f32_16x16x32_bf16 v[96:99], a[8:11], a[40:43], v[96:99]
    v_mfma_f32_16x16x32_bf16 v[100:103], a[8:11], a[44:47], v[100:103]
    v_mfma_f32_16x16x32_bf16 v[104:107], a[8:11], a[48:51], v[104:107]
    v_mfma_f32_16x16x32_bf16 v[108:111], a[8:11], a[52:55], v[108:111]
    buffer_load_dwordx4 a[124:127], v17, s[4:7], s27 offen offset:2048 sc1
    v_mfma_f32_16x16x32_bf16 v[112:115], a[8:11], a[56:59], v[112:115]
    s_waitcnt lgkmcnt(12)
    ds_read_b64_tr_b16 a[8:9], v3 offset:8192
    ds_read_b64_tr_b16 a[10:11], v3 offset:12288
    v_mfma_f32_16x16x32_bf16 v[116:119], a[12:15], a[32:35], v[116:119]
    v_mfma_f32_16x16x32_bf16 v[120:123], a[12:15], a[36:39], v[120:123]
    v_mfma_f32_16x16x32_bf16 v[124:127], a[12:15], a[40:43], v[124:127]
    v_mfma_f32_16x16x32_bf16 v[128:131], a[12:15], a[44:47], v[128:131]
    v_mfma_f32_16x16x32_bf16 v[132:135], a[12:15], a[48:51], v[132:135]
    buffer_load_dwordx4 a[128:131], v17, s[4:7], s27 offen offset:3072 sc1
    v_mfma_f32_16x16x32_bf16 v[136:139], a[12:15], a[52:55], v[136:139]
    v_mfma_f32_16x16x32_bf16 v[140:143], a[12:15], a[56:59], v[140:143]
    s_waitcnt lgkmcnt(12)
    ds_read_b64_tr_b16 a[12:13], v4 offset:8192
    ds_read_b64_tr_b16 a[14:15], v4 offset:12288
    v_mfma_f32_16x16x32_bf16 v[144:147], a[16:19], a[32:35], v[144:147]
    v_mfma_f32_16x16x32_bf16 v[148:151], a[16:19], a[36:39], v[148:151]
    v_mfma_f32_16x16x32_bf16 v[152:155], a[16:19], a[40:43], v[152:155]
    v_mfma_f32_16x16x32_bf16 v[156:159], a[16:19], a[44:47], v[156:159]
    v_mfma_f32_16x16x32_bf16 v[160:163], a[16:19], a[48:51], v[160:163]
    buffer_load_dwordx4 a[132:135], v18, s[4:7], s27 offen sc1
    v_mfma_f32_16x16x32_bf16 v[164:167], a[16:19], a[52:55], v[164:167]
    v_mfma_f32_16x16x32_bf16 v[168:171], a[16:19], a[56:59], v[168:171]
    s_waitcnt lgkmcnt(12)
    ds_read_b64_tr_b16 a[16:17], v5 offset:8192
    ds_read_b64_tr_b16 a[18:19], v5 offset:12288
    v_mfma_f32_16x16x32_bf16 v[172:175], a[20:23], a[32:35], v[172:175]
    v_mfma_f32_16x16x32_bf16 v[176:179], a[20:23], a[36:39], v[176:179]
    v_mfma_f32_16x16x32_bf16 v[180:183], a[20:23], a[40:43], v[180:183]
    v_mfma_f32_16x16x32_bf16 v[184:187], a[20:23], a[44:47], v[184:187]
    buffer_load_dwordx4 a[136:139], v18, s[4:7], s27 offen offset:1024 sc1
    v_mfma_f32_16x16x32_bf16 v[188:191], a[20:23], a[48:51], v[188:191]
    v_mfma_f32_16x16x32_bf16 v[192:195], a[20:23], a[52:55], v[192:195]
    v_mfma_f32_16x16x32_bf16 v[196:199], a[20:23], a[56:59], v[196:199]
    s_waitcnt lgkmcnt(12)
    ds_read_b64_tr_b16 a[20:21], v6 offset:8192
    ds_read_b64_tr_b16 a[22:23], v6 offset:12288
    v_mfma_f32_16x16x32_bf16 v[200:203], a[24:27], a[32:35], v[200:203]
    v_mfma_f32_16x16x32_bf16 v[204:207], a[24:27], a[36:39], v[204:207]
    v_mfma_f32_16x16x32_bf16 v[208:211], a[24:27], a[40:43], v[208:211]
    v_mfma_f32_16x16x32_bf16 v[212:215], a[24:27], a[44:47], v[212:215]
    buffer_load_dwordx4 a[140:143], v18, s[4:7], s27 offen offset:2048 sc1
    v_mfma_f32_16x16x32_bf16 v[216:219], a[24:27], a[48:51], v[216:219]
    s_add_u32 s27, s27, 7168
    v_mfma_f32_16x16x32_bf16 v[220:223], a[24:27], a[52:55], v[220:223]
    v_mfma_f32_16x16x32_bf16 v[224:227], a[24:27], a[56:59], v[224:227]
    s_waitcnt lgkmcnt(12)
    ds_read_b64_tr_b16 a[24:25], v7 offset:8192
    ds_read_b64_tr_b16 a[26:27], v7 offset:12288
    v_mfma_f32_16x16x32_bf16 v[228:231], a[28:31], a[32:35], v[228:231]
    v_mfma_f32_16x16x32_bf16 v[232:235], a[28:31], a[36:39], v[232:235]
    v_mfma_f32_16x16x32_bf16 v[236:239], a[28:31], a[40:43], v[236:239]
    v_mfma_f32_16x16x32_bf16 v[240:243], a[28:31], a[44:47], v[240:243]
    v_mfma_f32_16x16x32_bf16 v[244:247], a[28:31], a[48:51], v[244:247]
    v_mfma_f32_16x16x32_bf16 v[248:251], a[28:31], a[52:55], v[248:251]
    v_mfma_f32_16x16x32_bf16 v[252:255], a[28:31], a[56:59], v[252:255]
    s_waitcnt vmcnt(36) lgkmcnt(12)
    ds_read_b64_tr_b16 a[28:29], v8 offset:8192
    ds_read_b64_tr_b16 a[30:31], v8 offset:12288
    v_mfma_f32_16x16x32_bf16 v[32:35], a[0:3], a[60:63], v[32:35]
    s_waitcnt vmcnt(35)
    v_mfma_f32_16x16x32_bf16 v[36:39], a[0:3], a[64:67], v[36:39]
    s_waitcnt vmcnt(34)
    v_mfma_f32_16x16x32_bf16 v[40:43], a[0:3], a[68:71], v[40:43]
    s_waitcnt vmcnt(33)
    v_mfma_f32_16x16x32_bf16 v[44:47], a[0:3], a[72:75], v[44:47]
    s_waitcnt vmcnt(32)
    v_mfma_f32_16x16x32_bf16 v[48:51], a[0:3], a[76:79], v[48:51]
    s_waitcnt vmcnt(31)
    v_mfma_f32_16x16x32_bf16 v[52:55], a[0:3], a[80:83], v[52:55]
    s_waitcnt vmcnt(7)
    v_mfma_f32_16x16x32_bf16 v[56:59], a[0:3], a[84:87], v[56:59]
    s_waitcnt lgkmcnt(12)
    ds_read_b64_tr_b16 a[0:1], v1 offset:16384
    ds_read_b64_tr_b16 a[2:3], v1 offset:20480
    v_mfma_f32_16x16x32_bf16 v[60:63], a[4:7], a[60:63], v[60:63]
    v_mfma_f32_16x16x32_bf16 v[64:67], a[4:7], a[64:67], v[64:67]
    v_mfma_f32_16x16x32_bf16 v[68:71], a[4:7], a[68:71], v[68:71]
    ds_read_b64_tr_b16 a[144:145], v1 offset:24576
    ds_read_b64_tr_b16 a[146:147], v1 offset:28672
    v_mfma_f32_16x16x32_bf16 v[72:75], a[4:7], a[72:75], v[72:75]
    v_mfma_f32_16x16x32_bf16 v[76:79], a[4:7], a[76:79], v[76:79]
    v_mfma_f32_16x16x32_bf16 v[80:83], a[4:7], a[80:83], v[80:83]
    v_mfma_f32_16x16x32_bf16 v[84:87], a[4:7], a[84:87], v[84:87]
    s_waitcnt lgkmcnt(14)
    ds_read_b64_tr_b16 a[4:5], v2 offset:16384
    ds_read_b64_tr_b16 a[6:7], v2 offset:20480
    v_mfma_f32_16x16x32_bf16 v[88:91], a[8:11], a[60:63], v[88:91]
    v_mfma_f32_16x16x32_bf16 v[92:95], a[8:11], a[64:67], v[92:95]
    v_mfma_f32_16x16x32_bf16 v[96:99], a[8:11], a[68:71], v[96:99]
    ds_read_b64_tr_b16 a[148:149], v2 offset:24576
    ds_read_b64_tr_b16 a[150:151], v2 offset:28672
    v_mfma_f32_16x16x32_bf16 v[100:103], a[8:11], a[72:75], v[100:103]
    v_mfma_f32_16x16x32_bf16 v[104:107], a[8:11], a[76:79], v[104:107]
    v_mfma_f32_16x16x32_bf16 v[108:111], a[8:11], a[80:83], v[108:111]
    v_mfma_f32_16x16x32_bf16 v[112:115], a[8:11], a[84:87], v[112:115]
    s_waitcnt lgkmcnt(15)
    ds_read_b64_tr_b16 a[8:9], v3 offset:16384
    ds_read_b64_tr_b16 a[10:11], v3 offset:20480
    v_mfma_f32_16x16x32_bf16 v[116:119], a[12:15], a[60:63], v[116:119]
    v_mfma_f32_16x16x32_bf16 v[120:123], a[12:15], a[64:67], v[120:123]
    v_mfma_f32_16x16x32_bf16 v[124:127], a[12:15], a[68:71], v[124:127]
    ds_read_b64_tr_b16 a[152:153], v3 offset:24576
    ds_read_b64_tr_b16 a[154:155], v3 offset:28672
    v_mfma_f32_16x16x32_bf16 v[128:131], a[12:15], a[72:75], v[128:131]
    v_mfma_f32_16x16x32_bf16 v[132:135], a[12:15], a[76:79], v[132:135]
    v_mfma_f32_16x16x32_bf16 v[136:139], a[12:15], a[80:83], v[136:139]
    v_mfma_f32_16x16x32_bf16 v[140:143], a[12:15], a[84:87], v[140:143]
    s_waitcnt lgkmcnt(15)
    ds_read_b64_tr_b16 a[12:13], v4 offset:16384
    ds_read_b64_tr_b16 a[14:15], v4 offset:20480
    v_mfma_f32_16x16x32_bf16 v[144:147], a[16:19], a[60:63], v[144:147]
    v_mfma_f32_16x16x32_bf16 v[148:151], a[16:19], a[64:67], v[148:151]
    v_mfma_f32_16x16x32_bf16 v[152:155], a[16:19], a[68:71], v[152:155]
    ds_read_b64_tr_b16 a[156:157], v4 offset:24576
    ds_read_b64_tr_b16 a[158:159], v4 offset:28672
    v_mfma_f32_16x16x32_bf16 v[156:159], a[16:19], a[72:75], v[156:159]
    v_mfma_f32_16x16x32_bf16 v[160:163], a[16:19], a[76:79], v[160:163]
    v_mfma_f32_16x16x32_bf16 v[164:167], a[16:19], a[80:83], v[164:167]
    v_mfma_f32_16x16x32_bf16 v[168:171], a[16:19], a[84:87], v[168:171]
    ds_read_b64_tr_b16 a[16:17], v5 offset:16384
    ds_read_b64_tr_b16 a[18:19], v5 offset:20480
    v_mfma_f32_16x16x32_bf16 v[172:175], a[20:23], a[60:63], v[172:175]
    v_mfma_f32_16x16x32_bf16 v[176:179], a[20:23], a[64:67], v[176:179]
    v_mfma_f32_16x16x32_bf16 v[180:183], a[20:23], a[68:71], v[180:183]
    ds_read_b64_tr_b16 a[160:161], v5 offset:24576
    ds_read_b64_tr_b16 a[162:163], v5 offset:28672
    v_mfma_f32_16x16x32_bf16 v[184:187], a[20:23], a[72:75], v[184:187]
    v_mfma_f32_16x16x32_bf16 v[188:191], a[20:23], a[76:79], v[188:191]
    v_mfma_f32_16x16x32_bf16 v[192:195], a[20:23], a[80:83], v[192:195]
    v_mfma_f32_16x16x32_bf16 v[196:199], a[20:23], a[84:87], v[196:199]
    s_waitcnt lgkmcnt(15)
    ds_read_b64_tr_b16 a[20:21], v6 offset:16384
    ds_read_b64_tr_b16 a[22:23], v6 offset:20480
    v_mfma_f32_16x16x32_bf16 v[200:203], a[24:27], a[60:63], v[200:203]
    v_mfma_f32_16x16x32_bf16 v[204:207], a[24:27], a[64:67], v[204:207]
    v_mfma_f32_16x16x32_bf16 v[208:211], a[24:27], a[68:71], v[208:211]
    ds_read_b64_tr_b16 a[164:165], v6 offset:24576
    ds_read_b64_tr_b16 a[166:167], v6 offset:28672
    v_mfma_f32_16x16x32_bf16 v[212:215], a[24:27], a[72:75], v[212:215]
    v_mfma_f32_16x16x32_bf16 v[216:219], a[24:27], a[76:79], v[216:219]
    v_mfma_f32_16x16x32_bf16 v[220:223], a[24:27], a[80:83], v[220:223]
    v_mfma_f32_16x16x32_bf16 v[224:227], a[24:27], a[84:87], v[224:227]
    ds_read_b64_tr_b16 a[24:25], v7 offset:16384
    ds_read_b64_tr_b16 a[26:27], v7 offset:20480
    v_mfma_f32_16x16x32_bf16 v[228:231], a[28:31], a[60:63], v[228:231]
    v_mfma_f32_16x16x32_bf16 v[232:235], a[28:31], a[64:67], v[232:235]
    v_mfma_f32_16x16x32_bf16 v[236:239], a[28:31], a[68:71], v[236:239]
    ds_read_b64_tr_b16 a[168:169], v7 offset:24576
    ds_read_b64_tr_b16 a[170:171], v7 offset:28672
    v_mfma_f32_16x16x32_bf16 v[240:243], a[28:31], a[72:75], v[240:243]
    v_mfma_f32_16x16x32_bf16 v[244:247], a[28:31], a[76:79], v[244:247]
    ds_read_b64_tr_b16 a[172:173], v8 offset:24576
    ds_read_b64_tr_b16 a[174:175], v8 offset:28672
    v_mfma_f32_16x16x32_bf16 v[248:251], a[28:31], a[80:83], v[248:251]
    v_mfma_f32_16x16x32_bf16 v[252:255], a[28:31], a[84:87], v[252:255]
    s_waitcnt lgkmcnt(15)
    ds_read_b64_tr_b16 a[28:29], v8 offset:16384
    ds_read_b64_tr_b16 a[30:31], v8 offset:20480
    v_mfma_f32_16x16x32_bf16 v[88:91], a[8:11], a[88:91], v[88:91]
    s_waitcnt vmcnt(6)
    v_mfma_f32_16x16x32_bf16 v[88:91], a[152:155], a[116:119], v[88:91]
    v_mfma_f32_16x16x32_bf16 v[92:95], a[8:11], a[92:95], v[92:95]
    s_waitcnt vmcnt(5)
    v_mfma_f32_16x16x32_bf16 v[92:95], a[152:155], a[120:123], v[92:95]
    v_mfma_f32_16x16x32_bf16 v[96:99], a[8:11], a[96:99], v[96:99]
    s_waitcnt vmcnt(4)
    s_waitcnt lgkmcnt(0)
    v_mfma_f32_16x16x32_bf16 v[96:99], a[152:155], a[124:127], v[96:99]
    v_mfma_f32_16x16x32_bf16 v[100:103], a[8:11], a[100:103], v[100:103]
    s_waitcnt vmcnt(3)
    v_mfma_f32_16x16x32_bf16 v[100:103], a[152:155], a[128:131], v[100:103]
    v_mfma_f32_16x16x32_bf16 v[104:107], a[8:11], a[104:107], v[104:107]
    s_waitcnt vmcnt(2)
    ds_write_b128 v19, v[88:91]
    v_mfma_f32_16x16x32_bf16 v[104:107], a[152:155], a[132:135], v[104:107]
    v_mfma_f32_16x16x32_bf16 v[108:111], a[8:11], a[108:111], v[108:111]
    s_waitcnt vmcnt(1)
    v_mfma_f32_16x16x32_bf16 v[108:111], a[152:155], a[136:139], v[108:111]
    ds_write_b128 v19, v[92:95] offset:1024
    v_mfma_f32_16x16x32_bf16 v[112:115], a[8:11], a[112:115], v[112:115]
    s_waitcnt vmcnt(0)
    v_mfma_f32_16x16x32_bf16 v[112:115], a[152:155], a[140:143], v[112:115]
    v_mfma_f32_16x16x32_bf16 v[116:119], a[12:15], a[88:91], v[116:119]
    ds_write_b128 v19, v[96:99] offset:2048
    v_mfma_f32_16x16x32_bf16 v[116:119], a[156:159], a[116:119], v[116:119]
    v_mfma_f32_16x16x32_bf16 v[120:123], a[12:15], a[92:95], v[120:123]
    v_mfma_f32_16x16x32_bf16 v[120:123], a[156:159], a[120:123], v[120:123]
    ds_write_b128 v19, v[100:103] offset:3072
    v_mfma_f32_16x16x32_bf16 v[124:127], a[12:15], a[96:99], v[124:127]
    v_mfma_f32_16x16x32_bf16 v[124:127], a[156:159], a[124:127], v[124:127]
    v_mfma_f32_16x16x32_bf16 v[128:131], a[12:15], a[100:103], v[128:131]
    ds_write_b128 v19, v[104:107] offset:4096
    v_mfma_f32_16x16x32_bf16 v[128:131], a[156:159], a[128:131], v[128:131]
    v_mfma_f32_16x16x32_bf16 v[132:135], a[12:15], a[104:107], v[132:135]
    v_mfma_f32_16x16x32_bf16 v[132:135], a[156:159], a[132:135], v[132:135]
    ds_write_b128 v19, v[108:111] offset:5120
    v_mfma_f32_16x16x32_bf16 v[136:139], a[12:15], a[108:111], v[136:139]
    v_mfma_f32_16x16x32_bf16 v[136:139], a[156:159], a[136:139], v[136:139]
    v_mfma_f32_16x16x32_bf16 v[140:143], a[12:15], a[112:115], v[140:143]
    ds_write_b128 v19, v[112:115] offset:6144
    v_mfma_f32_16x16x32_bf16 v[140:143], a[156:159], a[140:143], v[140:143]
    v_mfma_f32_16x16x32_bf16 v[144:147], a[16:19], a[88:91], v[144:147]
    v_mfma_f32_16x16x32_bf16 v[144:147], a[160:163], a[116:119], v[144:147]
    ds_write_b128 v19, v[116:119] offset:7168
    v_mfma_f32_16x16x32_bf16 v[148:151], a[16:19], a[92:95], v[148:151]
    v_mfma_f32_16x16x32_bf16 v[148:151], a[160:163], a[120:123], v[148:151]
    v_mfma_f32_16x16x32_bf16 v[152:155], a[16:19], a[96:99], v[152:155]
    ds_write_b128 v19, v[120:123] offset:8192
    v_mfma_f32_16x16x32_bf16 v[152:155], a[160:163], a[124:127], v[152:155]
    v_mfma_f32_16x16x32_bf16 v[156:159], a[16:19], a[100:103], v[156:159]
    v_mfma_f32_16x16x32_bf16 v[156:159], a[160:163], a[128:131], v[156:159]
    ds_write_b128 v19, v[124:127] offset:9216
    v_mfma_f32_16x16x32_bf16 v[160:163], a[16:19], a[104:107], v[160:163]
    v_mfma_f32_16x16x32_bf16 v[160:163], a[160:163], a[132:135], v[160:163]
    v_mfma_f32_16x16x32_bf16 v[164:167], a[16:19], a[108:111], v[164:167]
    ds_write_b128 v19, v[128:131] offset:10240
    v_mfma_f32_16x16x32_bf16 v[164:167], a[160:163], a[136:139], v[164:167]
    v_mfma_f32_16x16x32_bf16 v[168:171], a[16:19], a[112:115], v[168:171]
    v_mfma_f32_16x16x32_bf16 v[168:171], a[160:163], a[140:143], v[168:171]
    ds_write_b128 v19, v[132:135] offset:11264
    v_mfma_f32_16x16x32_bf16 v[172:175], a[20:23], a[88:91], v[172:175]
    v_mfma_f32_16x16x32_bf16 v[172:175], a[164:167], a[116:119], v[172:175]
    v_mfma_f32_16x16x32_bf16 v[176:179], a[20:23], a[92:95], v[176:179]
    ds_write_b128 v19, v[136:139] offset:12288
    v_mfma_f32_16x16x32_bf16 v[176:179], a[164:167], a[120:123], v[176:179]
    v_mfma_f32_16x16x32_bf16 v[180:183], a[20:23], a[96:99], v[180:183]
    v_mfma_f32_16x16x32_bf16 v[180:183], a[164:167], a[124:127], v[180:183]
    ds_write_b128 v19, v[140:143] offset:13312
    v_mfma_f32_16x16x32_bf16 v[184:187], a[20:23], a[100:103], v[184:187]
    v_mfma_f32_16x16x32_bf16 v[184:187], a[164:167], a[128:131], v[184:187]
    v_mfma_f32_16x16x32_bf16 v[188:191], a[20:23], a[104:107], v[188:191]
    ds_write_b128 v19, v[144:147] offset:14336
    v_mfma_f32_16x16x32_bf16 v[188:191], a[164:167], a[132:135], v[188:191]
    v_mfma_f32_16x16x32_bf16 v[192:195], a[20:23], a[108:111], v[192:195]
    v_mfma_f32_16x16x32_bf16 v[192:195], a[164:167], a[136:139], v[192:195]
    ds_write_b128 v19, v[148:151] offset:15360
    v_mfma_f32_16x16x32_bf16 v[196:199], a[20:23], a[112:115], v[196:199]
    v_mfma_f32_16x16x32_bf16 v[196:199], a[164:167], a[140:143], v[196:199]
    v_mfma_f32_16x16x32_bf16 v[200:203], a[24:27], a[88:91], v[200:203]
    ds_write_b128 v19, v[152:155] offset:16384
    v_mfma_f32_16x16x32_bf16 v[200:203], a[168:171], a[116:119], v[200:203]
    v_mfma_f32_16x16x32_bf16 v[204:207], a[24:27], a[92:95], v[204:207]
    v_mfma_f32_16x16x32_bf16 v[204:207], a[168:171], a[120:123], v[204:207]
    ds_write_b128 v19, v[156:159] offset:17408
    v_mfma_f32_16x16x32_bf16 v[208:211], a[24:27], a[96:99], v[208:211]
    v_mfma_f32_16x16x32_bf16 v[208:211], a[168:171], a[124:127], v[208:211]
    v_mfma_f32_16x16x32_bf16 v[212:215], a[24:27], a[100:103], v[212:215]
    ds_write_b128 v19, v[160:163] offset:18432
    v_mfma_f32_16x16x32_bf16 v[212:215], a[168:171], a[128:131], v[212:215]
    v_mfma_f32_16x16x32_bf16 v[216:219], a[24:27], a[104:107], v[216:219]
    v_mfma_f32_16x16x32_bf16 v[216:219], a[168:171], a[132:135], v[216:219]
    ds_write_b128 v19, v[164:167] offset:19456
    v_mfma_f32_16x16x32_bf16 v[220:223], a[24:27], a[108:111], v[220:223]
    v_mfma_f32_16x16x32_bf16 v[220:223], a[168:171], a[136:139], v[220:223]
    v_mfma_f32_16x16x32_bf16 v[224:227], a[24:27], a[112:115], v[224:227]
    ds_write_b128 v19, v[168:171] offset:20480
    v_mfma_f32_16x16x32_bf16 v[224:227], a[168:171], a[140:143], v[224:227]
    v_mfma_f32_16x16x32_bf16 v[228:231], a[28:31], a[88:91], v[228:231]
    v_mfma_f32_16x16x32_bf16 v[228:231], a[172:175], a[116:119], v[228:231]
    ds_write_b128 v19, v[172:175] offset:21504
    v_mfma_f32_16x16x32_bf16 v[232:235], a[28:31], a[92:95], v[232:235]
    v_mfma_f32_16x16x32_bf16 v[232:235], a[172:175], a[120:123], v[232:235]
    v_mfma_f32_16x16x32_bf16 v[236:239], a[28:31], a[96:99], v[236:239]
    ds_write_b128 v19, v[176:179] offset:22528
    v_mfma_f32_16x16x32_bf16 v[236:239], a[172:175], a[124:127], v[236:239]
    v_mfma_f32_16x16x32_bf16 v[240:243], a[28:31], a[100:103], v[240:243]
    v_mfma_f32_16x16x32_bf16 v[240:243], a[172:175], a[128:131], v[240:243]
    ds_write_b128 v19, v[180:183] offset:23552
    v_mfma_f32_16x16x32_bf16 v[244:247], a[28:31], a[104:107], v[244:247]
    v_mfma_f32_16x16x32_bf16 v[244:247], a[172:175], a[132:135], v[244:247]
    v_mfma_f32_16x16x32_bf16 v[248:251], a[28:31], a[108:111], v[248:251]
    ds_write_b128 v19, v[184:187] offset:24576
    v_mfma_f32_16x16x32_bf16 v[248:251], a[172:175], a[136:139], v[248:251]
    v_mfma_f32_16x16x32_bf16 v[252:255], a[28:31], a[112:115], v[252:255]
    v_mfma_f32_16x16x32_bf16 v[252:255], a[172:175], a[140:143], v[252:255]
    ds_write_b128 v19, v[188:191] offset:25600
    v_mfma_f32_16x16x32_bf16 v[32:35], a[0:3], a[88:91], v[32:35]
    v_mfma_f32_16x16x32_bf16 v[32:35], a[144:147], a[116:119], v[32:35]
    v_mfma_f32_16x16x32_bf16 v[36:39], a[0:3], a[92:95], v[36:39]
    ds_write_b128 v19, v[192:195] offset:26624
    v_mfma_f32_16x16x32_bf16 v[36:39], a[144:147], a[120:123], v[36:39]
    v_mfma_f32_16x16x32_bf16 v[40:43], a[0:3], a[96:99], v[40:43]
    v_mfma_f32_16x16x32_bf16 v[40:43], a[144:147], a[124:127], v[40:43]
    ds_write_b128 v19, v[196:199] offset:27648
    v_mfma_f32_16x16x32_bf16 v[44:47], a[0:3], a[100:103], v[44:47]
    v_mfma_f32_16x16x32_bf16 v[44:47], a[144:147], a[128:131], v[44:47]
    v_mfma_f32_16x16x32_bf16 v[48:51], a[0:3], a[104:107], v[48:51]
    ds_write_b128 v19, v[200:203] offset:28672
    v_mfma_f32_16x16x32_bf16 v[48:51], a[144:147], a[132:135], v[48:51]
    v_mfma_f32_16x16x32_bf16 v[52:55], a[0:3], a[108:111], v[52:55]
    v_mfma_f32_16x16x32_bf16 v[52:55], a[144:147], a[136:139], v[52:55]
    ds_write_b128 v19, v[204:207] offset:29696
    v_mfma_f32_16x16x32_bf16 v[56:59], a[0:3], a[112:115], v[56:59]
    v_mfma_f32_16x16x32_bf16 v[56:59], a[144:147], a[140:143], v[56:59]
    v_mfma_f32_16x16x32_bf16 v[60:63], a[4:7], a[88:91], v[60:63]
    ds_write_b128 v19, v[208:211] offset:30720
    v_mfma_f32_16x16x32_bf16 v[60:63], a[148:151], a[116:119], v[60:63]
    v_mfma_f32_16x16x32_bf16 v[64:67], a[4:7], a[92:95], v[64:67]
    v_mfma_f32_16x16x32_bf16 v[64:67], a[148:151], a[120:123], v[64:67]
    ds_write_b128 v19, v[212:215] offset:31744
    v_mfma_f32_16x16x32_bf16 v[68:71], a[4:7], a[96:99], v[68:71]
    v_mfma_f32_16x16x32_bf16 v[68:71], a[148:151], a[124:127], v[68:71]
    v_mfma_f32_16x16x32_bf16 v[72:75], a[4:7], a[100:103], v[72:75]
    ds_write_b128 v19, v[216:219] offset:32768
    v_mfma_f32_16x16x32_bf16 v[72:75], a[148:151], a[128:131], v[72:75]
    v_mfma_f32_16x16x32_bf16 v[76:79], a[4:7], a[104:107], v[76:79]
    v_mfma_f32_16x16x32_bf16 v[76:79], a[148:151], a[132:135], v[76:79]
    ds_write_b128 v19, v[220:223] offset:33792
    v_mfma_f32_16x16x32_bf16 v[80:83], a[4:7], a[108:111], v[80:83]
    v_mfma_f32_16x16x32_bf16 v[80:83], a[148:151], a[136:139], v[80:83]
    v_mfma_f32_16x16x32_bf16 v[84:87], a[4:7], a[112:115], v[84:87]
    ds_write_b128 v19, v[224:227] offset:34816
    v_mfma_f32_16x16x32_bf16 v[84:87], a[148:151], a[140:143], v[84:87]
    ds_write_b128 v19, v[228:231] offset:35840
    ds_write_b128 v19, v[232:235] offset:36864
    ds_write_b128 v19, v[236:239] offset:37888
    ds_write_b128 v19, v[240:243] offset:38912
    ds_write_b128 v19, v[244:247] offset:39936
    s_waitcnt lgkmcnt(0)
    s_barrier
    ds_read_b128 v[88:91], v20
    ds_read_b128 v[92:95], v20 offset:1024
    ds_read_b128 v[96:99], v20 offset:2048
    ds_read_b128 v[100:103], v20 offset:3072
    ds_read_b128 v[104:107], v20 offset:4096
    ds_read_b128 v[108:111], v20 offset:5120
    ds_read_b128 v[112:115], v20 offset:6144
    ds_read_b128 v[116:119], v20 offset:7168
    ds_read_b128 v[120:123], v20 offset:8192
    ds_read_b128 v[124:127], v20 offset:9216
    ds_read_b128 v[128:131], v20 offset:10240
    ds_read_b128 v[132:135], v20 offset:11264
    ds_read_b128 v[136:139], v20 offset:12288
    ds_read_b128 v[140:143], v20 offset:13312
    ds_read_b128 v[144:147], v21 offset:14336
    ds_read_b128 v[148:151], v21 offset:15360
    ds_read_b128 v[152:155], v21 offset:16384
    ds_read_b128 v[156:159], v21 offset:17408
    ds_read_b128 v[160:163], v21 offset:18432
    ds_read_b128 v[164:167], v21 offset:19456
    ds_read_b128 v[168:171], v21 offset:20480
    ds_read_b128 v[172:175], v21 offset:21504
    ds_read_b128 v[176:179], v21 offset:22528
    ds_read_b128 v[180:183], v21 offset:23552
    ds_read_b128 v[184:187], v21 offset:24576
    ds_read_b128 v[188:191], v21 offset:25600
    ds_read_b128 v[192:195], v21 offset:26624
    ds_read_b128 v[196:199], v21 offset:27648
    ds_read_b128 v[200:203], v22 offset:28672
    ds_read_b128 v[204:207], v22 offset:29696
    ds_read_b128 v[208:211], v22 offset:30720
    ds_read_b128 v[212:215], v22 offset:31744
    ds_read_b128 v[216:219], v22 offset:32768
    ds_read_b128 v[220:223], v22 offset:33792
    ds_read_b128 v[224:227], v22 offset:34816
    ds_read_b128 v[228:231], v22 offset:35840
    ds_read_b128 v[232:235], v22 offset:36864
    ds_read_b128 v[236:239], v22 offset:37888
    ds_read_b128 v[240:243], v22 offset:38912
    ds_read_b128 v[244:247], v22 offset:39936
    s_waitcnt lgkmcnt(15)
    v_add_f32 v32, v32, v88
    v_add_f32 v33, v33, v89
    v_add_f32 v34, v34, v90
    v_add_f32 v35, v35, v91
    v_add_f32 v36, v36, v92
    v_add_f32 v37, v37, v93
    v_add_f32 v38, v38, v94
    v_add_f32 v39, v39, v95
    ds_write_b128 v20, v[248:251]
    ds_write_b128 v20, v[252:255] offset:1024
    v_add_f32 v40, v40, v96
    v_add_f32 v41, v41, v97
    v_add_f32 v42, v42, v98
    v_add_f32 v43, v43, v99
    v_add_f32 v44, v44, v100
    v_add_f32 v45, v45, v101
    v_add_f32 v46, v46, v102
    v_add_f32 v47, v47, v103
    v_add_f32 v48, v48, v104
    v_add_f32 v49, v49, v105
    v_add_f32 v50, v50, v106
    v_add_f32 v51, v51, v107
    v_add_f32 v52, v52, v108
    v_add_f32 v53, v53, v109
    v_add_f32 v54, v54, v110
    v_add_f32 v55, v55, v111
    v_add_f32 v56, v56, v112
    v_add_f32 v57, v57, v113
    v_add_f32 v58, v58, v114
    v_add_f32 v59, v59, v115
    v_add_f32 v60, v60, v116
    v_add_f32 v61, v61, v117
    v_add_f32 v62, v62, v118
    v_add_f32 v63, v63, v119
    v_add_f32 v64, v64, v120
    v_add_f32 v65, v65, v121
    v_add_f32 v66, v66, v122
    v_add_f32 v67, v67, v123
    v_add_f32 v68, v68, v124
    v_add_f32 v69, v69, v125
    v_add_f32 v70, v70, v126
    v_add_f32 v71, v71, v127
    v_add_f32 v72, v72, v128
    v_add_f32 v73, v73, v129
    v_add_f32 v74, v74, v130
    v_add_f32 v75, v75, v131
    v_add_f32 v76, v76, v132
    v_add_f32 v77, v77, v133
    v_add_f32 v78, v78, v134
    v_add_f32 v79, v79, v135
    v_add_f32 v80, v80, v136
    v_add_f32 v81, v81, v137
    v_add_f32 v82, v82, v138
    v_add_f32 v83, v83, v139
    v_add_f32 v84, v84, v140
    v_add_f32 v85, v85, v141
    v_add_f32 v86, v86, v142
    v_add_f32 v87, v87, v143
    v_add_f32 v32, v32, v144
    v_add_f32 v33, v33, v145
    v_add_f32 v34, v34, v146
    v_add_f32 v35, v35, v147
    v_add_f32 v36, v36, v148
    v_add_f32 v37, v37, v149
    v_add_f32 v38, v38, v150
    v_add_f32 v39, v39, v151
    v_add_f32 v40, v40, v152
    v_add_f32 v41, v41, v153
    v_add_f32 v42, v42, v154
    v_add_f32 v43, v43, v155
    v_add_f32 v44, v44, v156
    v_add_f32 v45, v45, v157
    v_add_f32 v46, v46, v158
    v_add_f32 v47, v47, v159
    v_add_f32 v48, v48, v160
    v_add_f32 v49, v49, v161
    v_add_f32 v50, v50, v162
    v_add_f32 v51, v51, v163
    v_add_f32 v52, v52, v164
    v_add_f32 v53, v53, v165
    v_add_f32 v54, v54, v166
    v_add_f32 v55, v55, v167
    v_add_f32 v56, v56, v168
    v_add_f32 v57, v57, v169
    v_add_f32 v58, v58, v170
    v_add_f32 v59, v59, v171
    v_add_f32 v60, v60, v172
    v_add_f32 v61, v61, v173
    v_add_f32 v62, v62, v174
    v_add_f32 v63, v63, v175
    v_add_f32 v64, v64, v176
    v_add_f32 v65, v65, v177
    v_add_f32 v66, v66, v178
    v_add_f32 v67, v67, v179
    v_add_f32 v68, v68, v180
    v_add_f32 v69, v69, v181
    v_add_f32 v70, v70, v182
    v_add_f32 v71, v71, v183
    v_add_f32 v72, v72, v184
    v_add_f32 v73, v73, v185
    v_add_f32 v74, v74, v186
    v_add_f32 v75, v75, v187
    s_waitcnt lgkmcnt(15)
    v_add_f32 v76, v76, v188
    v_add_f32 v77, v77, v189
    v_add_f32 v78, v78, v190
    v_add_f32 v79, v79, v191
    v_add_f32 v80, v80, v192
    v_add_f32 v81, v81, v193
    v_add_f32 v82, v82, v194
    v_add_f32 v83, v83, v195
    s_waitcnt lgkmcnt(14)
    v_add_f32 v84, v84, v196
    v_add_f32 v85, v85, v197
    v_add_f32 v86, v86, v198
    v_add_f32 v87, v87, v199
    s_waitcnt lgkmcnt(13)
    v_add_f32 v32, v32, v200
    v_add_f32 v33, v33, v201
    v_add_f32 v34, v34, v202
    v_add_f32 v35, v35, v203
    s_waitcnt lgkmcnt(12)
    v_add_f32 v36, v36, v204
    v_add_f32 v37, v37, v205
    v_add_f32 v38, v38, v206
    v_add_f32 v39, v39, v207
    s_waitcnt lgkmcnt(11)
    v_add_f32 v40, v40, v208
    v_add_f32 v41, v41, v209
    v_add_f32 v42, v42, v210
    v_add_f32 v43, v43, v211
    s_waitcnt lgkmcnt(10)
    v_add_f32 v44, v44, v212
    v_add_f32 v45, v45, v213
    v_add_f32 v46, v46, v214
    v_add_f32 v47, v47, v215
    s_waitcnt lgkmcnt(9)
    v_add_f32 v48, v48, v216
    v_add_f32 v49, v49, v217
    v_add_f32 v50, v50, v218
    v_add_f32 v51, v51, v219
    s_waitcnt lgkmcnt(8)
    v_add_f32 v52, v52, v220
    v_add_f32 v53, v53, v221
    v_add_f32 v54, v54, v222
    v_add_f32 v55, v55, v223
    s_waitcnt lgkmcnt(7)
    v_add_f32 v56, v56, v224
    v_add_f32 v57, v57, v225
    v_add_f32 v58, v58, v226
    v_add_f32 v59, v59, v227
    s_waitcnt lgkmcnt(6)
    v_add_f32 v60, v60, v228
    v_add_f32 v61, v61, v229
    v_add_f32 v62, v62, v230
    v_add_f32 v63, v63, v231
    s_waitcnt lgkmcnt(5)
    v_add_f32 v64, v64, v232
    v_add_f32 v65, v65, v233
    v_add_f32 v66, v66, v234
    v_add_f32 v67, v67, v235
    s_waitcnt lgkmcnt(4)
    v_add_f32 v68, v68, v236
    v_add_f32 v69, v69, v237
    v_add_f32 v70, v70, v238
    v_add_f32 v71, v71, v239
    s_waitcnt lgkmcnt(3)
    v_add_f32 v72, v72, v240
    v_add_f32 v73, v73, v241
    v_add_f32 v74, v74, v242
    v_add_f32 v75, v75, v243
    s_waitcnt lgkmcnt(2)
    v_add_f32 v76, v76, v244
    v_add_f32 v77, v77, v245
    v_add_f32 v78, v78, v246
    v_add_f32 v79, v79, v247
    s_waitcnt lgkmcnt(0)
    s_barrier
    ds_read_b128 v[248:251], v21
    ds_read_b128 v[252:255], v21 offset:1024
    v_cvt_pk_bf16_f32 v88, v32, v33
    v_cvt_pk_bf16_f32 v89, v34, v35
    v_cvt_pk_bf16_f32 v90, v60, v61
    v_cvt_pk_bf16_f32 v91, v62, v63
    v_cvt_pk_bf16_f32 v92, v36, v37
    v_cvt_pk_bf16_f32 v93, v38, v39
    v_cvt_pk_bf16_f32 v94, v64, v65
    v_cvt_pk_bf16_f32 v95, v66, v67
    v_cvt_pk_bf16_f32 v96, v40, v41
    v_cvt_pk_bf16_f32 v97, v42, v43
    v_cvt_pk_bf16_f32 v98, v68, v69
    v_cvt_pk_bf16_f32 v99, v70, v71
    v_cvt_pk_bf16_f32 v100, v44, v45
    v_cvt_pk_bf16_f32 v101, v46, v47
    v_cvt_pk_bf16_f32 v102, v72, v73
    v_cvt_pk_bf16_f32 v103, v74, v75
    v_cvt_pk_bf16_f32 v104, v48, v49
    v_cvt_pk_bf16_f32 v105, v50, v51
    v_cvt_pk_bf16_f32 v106, v76, v77
    v_cvt_pk_bf16_f32 v107, v78, v79
    v_permlane16_swap_b32 v88, v90
    v_permlane16_swap_b32 v89, v91
    s_mov_b32 s64, 0
    buffer_store_dwordx4 v[88:91], v23, s[20:23], s64 offen
    v_permlane16_swap_b32 v92, v94
    v_permlane16_swap_b32 v93, v95
    s_mov_b32 s65, 65536
    buffer_store_dwordx4 v[92:95], v23, s[20:23], s65 offen
    v_permlane16_swap_b32 v96, v98
    v_permlane16_swap_b32 v97, v99
    s_mov_b32 s64, 131072
    buffer_store_dwordx4 v[96:99], v23, s[20:23], s64 offen
    v_permlane16_swap_b32 v100, v102
    v_permlane16_swap_b32 v101, v103
    s_mov_b32 s65, 196608
    buffer_store_dwordx4 v[100:103], v23, s[20:23], s65 offen
    v_permlane16_swap_b32 v104, v106
    v_permlane16_swap_b32 v105, v107
    s_mov_b32 s64, 262144
    buffer_store_dwordx4 v[104:107], v23, s[20:23], s64 offen
    s_waitcnt lgkmcnt(1)
    v_add_f32 v80, v80, v248
    v_add_f32 v81, v81, v249
    v_add_f32 v82, v82, v250
    v_add_f32 v83, v83, v251
    s_waitcnt lgkmcnt(0)
    v_add_f32 v84, v84, v252
    v_add_f32 v85, v85, v253
    v_add_f32 v86, v86, v254
    v_add_f32 v87, v87, v255
    v_cvt_pk_bf16_f32 v108, v52, v53
    v_cvt_pk_bf16_f32 v109, v54, v55
    v_cvt_pk_bf16_f32 v110, v80, v81
    v_cvt_pk_bf16_f32 v111, v82, v83
    v_cvt_pk_bf16_f32 v112, v56, v57
    v_cvt_pk_bf16_f32 v113, v58, v59
    v_cvt_pk_bf16_f32 v114, v84, v85
    v_cvt_pk_bf16_f32 v115, v86, v87
    v_permlane16_swap_b32 v108, v110
    v_permlane16_swap_b32 v109, v111
    s_mov_b32 s65, 327680
    buffer_store_dwordx4 v[108:111], v23, s[20:23], s65 offen
    v_permlane16_swap_b32 v112, v114
    v_permlane16_swap_b32 v113, v115
    s_mov_b32 s64, 393216
    buffer_store_dwordx4 v[112:115], v23, s[20:23], s64 offen
L_end:
    s_endpgm
L_maxpass:
    s_mov_b32 s35, 1
    s_mov_b32 s34, 32
    s_mov_b32 s29, 0
    s_barrier
    v_mov_b32 v17, 0xff800000
    v_mov_b32 v18, 0xff800000
    v_mov_b32 v19, 0xff800000
    v_mov_b32 v20, 0xff800000
    v_mov_b32 v21, 0xff800000
    v_mov_b32 v22, 0xff800000
    v_mov_b32 v23, 0xff800000
L_maxl:
    s_add_u32 m0, s32, 0
    s_nop 0
    buffer_load_dwordx4 v13, s[12:15], s29 offen nt lds
    s_add_u32 s29, s29, s75
    s_add_u32 m0, s32, 1024
    s_nop 0
    buffer_load_dwordx4 v14, s[12:15], s29 offen nt lds
    s_add_u32 s29, s29, s75
    s_add_u32 m0, s32, 2048
    s_nop 0
    buffer_load_dwordx4 v13, s[12:15], s29 offen nt lds
    s_add_u32 s29, s29, s75
    s_add_u32 m0, s32, 3072
    s_nop 0
    buffer_load_dwordx4 v14, s[12:15], s29 offen nt lds
    s_add_u32 s29, s29, s75
    s_add_u32 m0, s32, 4096
    s_nop 0
    buffer_load_dwordx4 v13, s[12:15], s29 offen nt lds
    s_add_u32 s29, s29, s75
    s_add_u32 m0, s32, 5120
    s_nop 0
    buffer_load_dwordx4 v14, s[12:15], s29 offen nt lds
    s_add_u32 s29, s29, s75
    s_add_u32 m0, s32, 6144
    s_nop 0
    buffer_load_dwordx4 v13, s[12:15], s29 offen nt lds
    s_add_u32 s29, s29, s75
    s_add_u32 m0, s32, 7168
    s_nop 0
    buffer_load_dwordx4 v14, s[12:15], s29 offen nt lds
    s_add_u32 s29, s29, s75
    s_waitcnt vmcnt(0) lgkmcnt(0)
    s_barrier
    ds_read_b128 a[176:179], v1
    ds_read_b128 a[180:183], v2
    ds_read_b128 a[184:187], v3
    ds_read_b128 a[188:191], v4
    ds_read_b128 a[192:195], v1 offset:4096
    ds_read_b128 a[196:199], v2 offset:4096
    ds_read_b128 a[200:203], v3 offset:4096
    ds_read_b128 a[204:207], v4 offset:4096
    s_waitcnt lgkmcnt(0)
    s_barrier
    v_mfma_f32_16x16x32_bf16 v[32:35], a[176:179], a[64:67], 0
    v_mfma_f32_16x16x32_bf16 v[32:35], a[180:183], a[68:71], v[32:35]
    v_mfma_f32_16x16x32_bf16 v[32:35], a[184:187], a[72:75], v[32:35]
    v_mfma_f32_16x16x32_bf16 v[32:35], a[188:191], a[76:79], v[32:35]
    v_mfma_f32_16x16x32_bf16 v[36:39], a[192:195], a[64:67], 0
    v_mfma_f32_16x16x32_bf16 v[36:39], a[196:199], a[68:71], v[36:39]
    v_mfma_f32_16x16x32_bf16 v[36:39], a[200:203], a[72:75], v[36:39]
    v_mfma_f32_16x16x32_bf16 v[36:39], a[204:207], a[76:79], v[36:39]
    s_nop 3
    v_max3_f32 v17, v17, v32, v33
    v_max3_f32 v17, v17, v34, v35
    s_nop 1
    v_max3_f32 v17, v17, v36, v37
    v_max3_f32 v17, v17, v38, v39
    v_mfma_f32_16x16x32_bf16 v[40:43], a[176:179], a[80:83], 0
    v_mfma_f32_16x16x32_bf16 v[40:43], a[180:183], a[84:87], v[40:43]
    v_mfma_f32_16x16x32_bf16 v[40:43], a[184:187], a[88:91], v[40:43]
    v_mfma_f32_16x16x32_bf16 v[40:43], a[188:191], a[92:95], v[40:43]
    v_mfma_f32_16x16x32_bf16 v[44:47], a[192:195], a[80:83], 0
    v_mfma_f32_16x16x32_bf16 v[44:47], a[196:199], a[84:87], v[44:47]
    v_mfma_f32_16x16x32_bf16 v[44:47], a[200:203], a[88:91], v[44:47]
    v_mfma_f32_16x16x32_bf16 v[44:47], a[204:207], a[92:95], v[44:47]
    s_nop 3
    v_max3_f32 v18, v18, v40, v41
    v_max3_f32 v18, v18, v42, v43
    s_nop 1
    v_max3_f32 v18, v18, v44, v45
    v_max3_f32 v18, v18, v46, v47
    v_mfma_f32_16x16x32_bf16 v[32:35], a[176:179], a[96:99], 0
    v_mfma_f32_16x16x32_bf16 v[32:35], a[180:183], a[100:103], v[32:35]
    v_mfma_f32_16x16x32_bf16 v[32:35], a[184:187], a[104:107], v[32:35]
    v_mfma_f32_16x16x32_bf16 v[32:35], a[188:191], a[108:111], v[32:35]
    v_mfma_f32_16x16x32_bf16 v[36:39], a[192:195], a[96:99], 0
    v_mfma_f32_16x16x32_bf16 v[36:39], a[196:199], a[100:103], v[36:39]
    v_mfma_f32_16x16x32_bf16 v[36:39], a[200:203], a[104:107], v[36:39]
    v_mfma_f32_16x16x32_bf16 v[36:39], a[204:207], a[108:111], v[36:39]
    s_nop 3
    v_max3_f32 v19, v19, v32, v33
    v_max3_f32 v19, v19, v34, v35
    s_nop 1
    v_max3_f32 v19, v19, v36, v37
    v_max3_f32 v19, v19, v38, v39
    v_mfma_f32_16x16x32_bf16 v[40:43], a[176:179], a[112:115], 0
    v_mfma_f32_16x16x32_bf16 v[40:43], a[180:183], a[116:119], v[40:43]
    v_mfma_f32_16x16x32_bf16 v[40:43], a[184:187], a[120:123], v[40:43]
    v_mfma_f32_16x16x32_bf16 v[40:43], a[188:191], a[124:127], v[40:43]
    v_mfma_f32_16x16x32_bf16 v[44:47], a[192:195], a[112:115], 0
    v_mfma_f32_16x16x32_bf16 v[44:47], a[196:199], a[116:119], v[44:47]
    v_mfma_f32_16x16x32_bf16 v[44:47], a[200:203], a[120:123], v[44:47]
    v_mfma_f32_16x16x32_bf16 v[44:47], a[204:207], a[124:127], v[44:47]
    s_nop 3
    v_max3_f32 v20, v20, v40, v41
    v_max3_f32 v20, v20, v42, v43
    s_nop 1
    v_max3_f32 v20, v20, v44, v45
    v_max3_f32 v20, v20, v46, v47
    v_mfma_f32_16x16x32_bf16 v[32:35], a[176:179], a[128:131], 0
    v_mfma_f32_16x16x32_bf16 v[32:35], a[180:183], a[132:135], v[32:35]
    v_mfma_f32_16x16x32_bf16 v[32:35], a[184:187], a[136:139], v[32:35]
    v_mfma_f32_16x16x32_bf16 v[32:35], a[188:191], a[140:143], v[32:35]
    v_mfma_f32_16x16x32_bf16 v[36:39], a[192:195], a[128:131], 0
    v_mfma_f32_16x16x32_bf16 v[36:39], a[196:199], a[132:135], v[36:39]
    v_mfma_f32_16x16x32_bf16 v[36:39], a[200:203], a[136:139], v[36:39]
    v_mfma_f32_16x16x32_bf16 v[36:39], a[204:207], a[140:143], v[36:39]
    s_nop 3
    v_max3_f32 v21, v21, v32, v33
    v_max3_f32 v21, v21, v34, v35
    s_nop 1
    v_max3_f32 v21, v21, v36, v37
    v_max3_f32 v21, v21, v38, v39
    v_mfma_f32_16x16x32_bf16 v[40:43], a[176:179], a[144:147], 0
    v_mfma_f32_16x16x32_bf16 v[40:43], a[180:183], a[148:151], v[40:43]
    v_mfma_f32_16x16x32_bf16 v[40:43], a[184:187], a[152:155], v[40:43]
    v_mfma_f32_16x16x32_bf16 v[40:43], a[188:191], a[156:159], v[40:43]
    v_mfma_f32_16x16x32_bf16 v[44:47], a[192:195], a[144:147], 0
    v_mfma_f32_16x16x32_bf16 v[44:47], a[196:199], a[148:151], v[44:47]
    v_mfma_f32_16x16x32_bf16 v[44:47], a[200:203], a[152:155], v[44:47]
    v_mfma_f32_16x16x32_bf16 v[44:47], a[204:207], a[156:159], v[44:47]
    s_nop 3
    v_max3_f32 v22, v22, v40, v41
    v_max3_f32 v22, v22, v42, v43
    s_nop 1
    v_max3_f32 v22, v22, v44, v45
    v_max3_f32 v22, v22, v46, v47
    v_mfma_f32_16x16x32_bf16 v[32:35], a[176:179], a[160:163], 0
    v_mfma_f32_16x16x32_bf16 v[32:35], a[180:183], a[164:167], v[32:35]
    v_mfma_f32_16x16x32_bf16 v[32:35], a[184:187], a[168:171], v[32:35]
    v_mfma_f32_16x16x32_bf16 v[32:35], a[188:191], a[172:175], v[32:35]
    v_mfma_f32_16x16x32_bf16 v[36:39], a[192:195], a[160:163], 0
    v_mfma_f32_16x16x32_bf16 v[36:39], a[196:199], a[164:167], v[36:39]
    v_mfma_f32_16x16x32_bf16 v[36:39], a[200:203], a[168:171], v[36:39]
    v_mfma_f32_16x16x32_bf16 v[36:39], a[204:207], a[172:175], v[36:39]
    s_nop 3
    v_max3_f32 v23, v23, v32, v33
    v_max3_f32 v23, v23, v34, v35
    s_nop 1
    v_max3_f32 v23, v23, v36, v37
    v_max3_f32 v23, v23, v38, v39
    s_sub_u32 s34, s34, 1
    s_cmp_lg_u32 s34, 0
    s_cbranch_scc1 L_maxl
    v_mov_b32 v32, v17
    v_mov_b32 v33, v18
    v_mov_b32 v34, v19
    v_mov_b32 v35, v20
    v_mov_b32 v36, v21
    v_mov_b32 v37, v22
    v_mov_b32 v38, v23
    v_permlane16_swap_b32 v17, v32
    v_permlane16_swap_b32 v18, v33
    v_permlane16_swap_b32 v19, v34
    v_permlane16_swap_b32 v20, v35
    v_permlane16_swap_b32 v21, v36
    v_permlane16_swap_b32 v22, v37
    v_permlane16_swap_b32 v23, v38
    v_max_f32 v17, v17, v32
    v_max_f32 v18, v18, v33
    v_max_f32 v19, v19, v34
    v_max_f32 v20, v20, v35
    v_max_f32 v21, v21, v36
    v_max_f32 v22, v22, v37
    v_max_f32 v23, v23, v38
    v_mov_b32 v32, v17
    v_mov_b32 v33, v18
    v_mov_b32 v34, v19
    v_mov_b32 v35, v20
    v_mov_b32 v36, v21
    v_mov_b32 v37, v22
    v_mov_b32 v38, v23
    v_permlane32_swap_b32 v17, v32
    v_permlane32_swap_b32 v18, v33
    v_permlane32_swap_b32 v19, v34
    v_permlane32_swap_b32 v20, v35
    v_permlane32_swap_b32 v21, v36
    v_permlane32_swap_b32 v22, v37
    v_permlane32_swap_b32 v23, v38
    v_max_f32 v17, v17, v32
    v_max_f32 v18, v18, v33
    v_max_f32 v19, v19, v34
    v_max_f32 v20, v20, v35
    v_max_f32 v21, v21, v36
    v_max_f32 v22, v22, v37
    v_max_f32 v23, v23, v38
    v_sub_f32 v48, 0, v17
    v_sub_f32 v49, 0, v17
    v_sub_f32 v50, 0, v17
    v_sub_f32 v51, 0, v17
    v_sub_f32 v52, 0, v18
    v_sub_f32 v53, 0, v18
    v_sub_f32 v54, 0, v18
    v_sub_f32 v55, 0, v18
    v_sub_f32 v56, 0, v19
    v_sub_f32 v57, 0, v19
    v_sub_f32 v58, 0, v19
    v_sub_f32 v59, 0, v19
    v_sub_f32 v60, 0, v20
    v_sub_f32 v61, 0, v20
    v_sub_f32 v62, 0, v20
    v_sub_f32 v63, 0, v20
    v_sub_f32 v64, 0, v21
    v_sub_f32 v65, 0, v21
    v_sub_f32 v66, 0, v21
    v_sub_f32 v67, 0, v21
    v_sub_f32 v68, 0, v22
    v_sub_f32 v69, 0, v22
    v_sub_f32 v70, 0, v22
    v_sub_f32 v71, 0, v22
    v_sub_f32 v72, 0, v23
    v_sub_f32 v73, 0, v23
    v_sub_f32 v74, 0, v23
    v_sub_f32 v75, 0, v23
    s_mov_b32 s29, 0
    s_and_b32 s69, s29, s63
    s_add_u32 m0, s32, s69
    s_nop 0
    buffer_load_dwordx4 v13, s[12:15], s29 offen nt lds
    s_add_u32 s29, s29, s75
    s_and_b32 s69, s29, s63
    s_add_u32 m0, s32, s69
    s_nop 0
    buffer_load_dwordx4 v14, s[12:15], s29 offen nt lds
    s_add_u32 s29, s29, s75
    s_and_b32 s69, s29, s63
    s_add_u32 m0, s32, s69
    s_nop 0
    buffer_load_dwordx4 v13, s[12:15], s29 offen nt lds
    s_add_u32 s29, s29, s75
    s_and_b32 s69, s29, s63
    s_add_u32 m0, s32, s69
    s_nop 0
    buffer_load_dwordx4 v14, s[12:15], s29 offen nt lds
    s_add_u32 s29, s29, s75
    s_and_b32 s69, s29, s63
    s_add_u32 m0, s32, s69
    s_nop 0
    buffer_load_dwordx4 v13, s[12:15], s29 offen nt lds
    s_add_u32 s29, s29, s75
    s_and_b32 s69, s29, s63
    s_add_u32 m0, s32, s69
    s_nop 0
    buffer_load_dwordx4 v14, s[12:15], s29 offen nt lds
    s_add_u32 s29, s29, s75
    s_and_b32 s69, s29, s63
    s_add_u32 m0, s32, s69
    s_nop 0
    buffer_load_dwordx4 v13, s[12:15], s29 offen nt lds
    s_add_u32 s29, s29, s75
    s_and_b32 s69, s29, s63
    s_add_u32 m0, s32, s69
    s_nop 0
    buffer_load_dwordx4 v14, s[12:15], s29 offen nt lds
    s_add_u32 s29, s29, s75
    s_and_b32 s69, s29, s63
    s_add_u32 m0, s32, s69
    s_nop 0
    buffer_load_dwordx4 v13, s[12:15], s29 offen nt lds
    s_add_u32 s29, s29, s75
    s_and_b32 s69, s29, s63
    s_add_u32 m0, s32, s69
    s_nop 0
    buffer_load_dwordx4 v14, s[12:15], s29 offen nt lds
    s_add_u32 s29, s29, s75
    s_and_b32 s69, s29, s63
    s_add_u32 m0, s32, s69
    s_nop 0
    buffer_load_dwordx4 v13, s[12:15], s29 offen nt lds
    s_add_u32 s29, s29, s75
    s_and_b32 s69, s29, s63
    s_add_u32 m0, s32, s69
    s_nop 0
    buffer_load_dwordx4 v14, s[12:15], s29 offen nt lds
    s_add_u32 s29, s29, s75
    s_and_b32 s69, s29, s63
    s_add_u32 m0, s32, s69
    s_nop 0
    buffer_load_dwordx4 v13, s[12:15], s29 offen nt lds
    s_add_u32 s29, s29, s75
    s_and_b32 s69, s29, s63
    s_add_u32 m0, s32, s69
    s_nop 0
    buffer_load_dwordx4 v14, s[12:15], s29 offen nt lds
    s_add_u32 s29, s29, s75
    s_and_b32 s69, s29, s63
    s_add_u32 m0, s32, s69
    s_nop 0
    buffer_load_dwordx4 v13, s[12:15], s29 offen nt lds
    s_add_u32 s29, s29, s75
    s_and_b32 s69, s29, s63
    s_add_u32 m0, s32, s69
    s_nop 0
    buffer_load_dwordx4 v14, s[12:15], s29 offen nt lds
    s_add_u32 s29, s29, s75
    s_and_b32 s69, s29, s63
    s_add_u32 m0, s32, s69
    s_nop 0
    buffer_load_dwordx4 v13, s[12:15], s29 offen nt lds
    s_add_u32 s29, s29, s75
    s_and_b32 s69, s29, s63
    s_add_u32 m0, s32, s69
    s_nop 0
    buffer_load_dwordx4 v14, s[12:15], s29 offen nt lds
    s_add_u32 s29, s29, s75
    s_and_b32 s69, s29, s63
    s_add_u32 m0, s32, s69
    s_nop 0
    buffer_load_dwordx4 v13, s[12:15], s29 offen nt lds
    s_add_u32 s29, s29, s75
    s_and_b32 s69, s29, s63
    s_add_u32 m0, s32, s69
    s_nop 0
    buffer_load_dwordx4 v14, s[12:15], s29 offen nt lds
    s_add_u32 s29, s29, s75
    s_and_b32 s69, s29, s63
    s_add_u32 m0, s32, s69
    s_nop 0
    buffer_load_dwordx4 v13, s[12:15], s29 offen nt lds
    s_add_u32 s29, s29, s75
    s_and_b32 s69, s29, s63
    s_add_u32 m0, s32, s69
    s_nop 0
    buffer_load_dwordx4 v14, s[12:15], s29 offen nt lds
    s_add_u32 s29, s29, s75
    s_and_b32 s69, s29, s63
    s_add_u32 m0, s32, s69
    s_nop 0
    buffer_load_dwordx4 v13, s[12:15], s29 offen nt lds
    s_add_u32 s29, s29, s75
    s_and_b32 s69, s29, s63
    s_add_u32 m0, s32, s69
    s_nop 0
    buffer_load_dwordx4 v14, s[12:15], s29 offen nt lds
    s_add_u32 s29, s29, s75
    s_and_b32 s69, s29, s63
    s_add_u32 m0, s32, s69
    s_nop 0
    buffer_load_dwordx4 v13, s[12:15], s29 offen nt lds
    s_add_u32 s29, s29, s75
    s_and_b32 s69, s29, s63
    s_add_u32 m0, s32, s69
    s_nop 0
    buffer_load_dwordx4 v14, s[12:15], s29 offen nt lds
    s_add_u32 s29, s29, s75
    s_and_b32 s69, s29, s63
    s_add_u32 m0, s32, s69
    s_nop 0
    buffer_load_dwordx4 v13, s[12:15], s29 offen nt lds
    s_add_u32 s29, s29, s75
    s_and_b32 s69, s29, s63
    s_add_u32 m0, s32, s69
    s_nop 0
    buffer_load_dwordx4 v14, s[12:15], s29 offen nt lds
    s_add_u32 s29, s29, s75
    s_and_b32 s69, s29, s63
    s_add_u32 m0, s32, s69
    s_nop 0
    buffer_load_dwordx4 v13, s[12:15], s29 offen nt lds
    s_add_u32 s29, s29, s75
    s_and_b32 s69, s29, s63
    s_add_u32 m0, s32, s69
    s_nop 0
    buffer_load_dwordx4 v14, s[12:15], s29 offen nt lds
    s_add_u32 s29, s29, s75
    s_and_b32 s69, s29, s63
    s_add_u32 m0, s32, s69
    s_nop 0
    buffer_load_dwordx4 v13, s[12:15], s29 offen nt lds
    s_add_u32 s29, s29, s75
    s_and_b32 s69, s29, s63
    s_add_u32 m0, s32, s69
    s_nop 0
    buffer_load_dwordx4 v14, s[12:15], s29 offen nt lds
    s_add_u32 s29, s29, s75
    v_mov_b32 v17, 0
    v_mov_b32 v18, 0
    v_mov_b32 v19, 0
    v_mov_b32 v20, 0
    v_mov_b32 v21, 0
    v_mov_b32 v22, 0
    v_mov_b32 v23, 0
    s_waitcnt vmcnt(24)
    s_barrier
    ds_read_b128 a[176:179], v1
    ds_read_b128 a[180:183], v2
    ds_read_b128 a[184:187], v3
    ds_read_b128 a[188:191], v4
    ds_read_b128 a[192:195], v1 offset:4096
    ds_read_b128 a[196:199], v2 offset:4096
    ds_read_b128 a[200:203], v3 offset:4096
    ds_read_b128 a[204:207], v4 offset:4096
    s_mov_b32 s34, 7
    s_waitcnt lgkmcnt(7)
    v_mfma_f32_16x16x32_bf16 v[32:35], a[176:179], a[64:67], v[48:51]
    s_waitcnt lgkmcnt(6)
    v_mfma_f32_16x16x32_bf16 v[32:35], a[180:183], a[68:71], v[32:35]
    s_waitcnt lgkmcnt(5)
    v_mfma_f32_16x16x32_bf16 v[32:35], a[184:187], a[72:75], v[32:35]
    s_waitcnt lgkmcnt(4)
    v_mfma_f32_16x16x32_bf16 v[32:35], a[188:191], a[76:79], v[32:35]
    s_waitcnt lgkmcnt(3)
    v_mfma_f32_16x16x32_bf16 v[36:39], a[192:195], a[64:67], v[48:51]
    s_waitcnt lgkmcnt(2)
    v_mfma_f32_16x16x32_bf16 v[36:39], a[196:199], a[68:71], v[36:39]
    s_waitcnt lgkmcnt(1)
    v_mfma_f32_16x16x32_bf16 v[36:39], a[200:203], a[72:75], v[36:39]
    s_waitcnt lgkmcnt(0)
    v_mfma_f32_16x16x32_bf16 v[36:39], a[204:207], a[76:79], v[36:39]
    s_branch L_at
.section .rodata,"a"
.p2align 6
.amdhsa_kernel concat_heads__mha_block_cached__mha_block_cached__near_ridge_kernel
  .amdhsa_next_free_vgpr 512
  .amdhsa_next_free_sgpr 102
  .amdhsa_accum_offset 256
  .amdhsa_group_segment_fixed_size 0
  .amdhsa_kernarg_size 104
  .amdhsa_user_sgpr_count 2
  .amdhsa_user_sgpr_kernarg_segment_ptr 1
  .amdhsa_system_sgpr_workgroup_id_x 1
.end_amdhsa_kernel
```
